```python
import torch

def _softmax(x, axis=-1):
    return torch.softmax(x, dim=axis)
def _gelu(x):
    return torch.nn.functional.gelu(x, approximate="tanh")
def _silu(x):
    return torch.nn.functional.silu(x)
def _sigmoid(x):
    return torch.sigmoid(x)
def _layernorm(x, axis=-1, eps=1e-5):
    m = x.mean(dim=axis, keepdim=True)
    v = x.var(dim=axis, keepdim=True, unbiased=False)
    return (x - m) / torch.sqrt(v + eps)
def _scatter_add(tgt, idx, src, axis=0):
    return tgt.clone().index_add_(axis, idx, src)
def _segment_sum(src, seg, n):
    out = torch.zeros((n,) + src.shape[1:], dtype=src.dtype)
    return out.index_add_(0, seg, src)
def _pad(x, pw):
    flat = tuple(v for pair in reversed(pw) for v in pair)
    return torch.nn.functional.pad(x, flat)

kernel_name = 'gated_mix__mha_block__glu_gated_bilinear__prompt'

def setup_inputs():

    _w = (lambda a: (lambda t: t.to(torch.bfloat16) if t.is_floating_point() else t)(torch.as_tensor(a)))
    def _A_setup():
        B, S, D, H = 1, 2048, 640, 32
        return {
            "x": _w((lambda *s: torch.randn(*s, dtype=torch.bfloat16) * 0.05)(B, S, D)),
            "wqkv": _w((lambda *s: torch.randn(*s, dtype=torch.bfloat16) * 0.8)(D, 3 * D)),
            "wo": _w((lambda *s: torch.randn(*s, dtype=torch.bfloat16) * 0.05)(D, D)),
        }
    _A_in = _A_setup()

    def _B_setup():
        B, S, D, F = 1, 2048, 640, 1728
        return {
            "x": _w((lambda *s: torch.randn(*s, dtype=torch.bfloat16) * 0.05)(B, S, D)),
            "w_gate": _w((lambda *s: torch.randn(*s, dtype=torch.bfloat16) * 1.6)(D, F) * (D ** -0.5)),
            "w_up": _w((lambda *s: torch.randn(*s, dtype=torch.bfloat16) * 1.6)(D, F) * (D ** -0.5)),
            "w_down": _w((lambda *s: torch.randn(*s, dtype=torch.bfloat16) * 1.6)(F, D) * (F ** -0.5)),
        }
    _B_in = _B_setup()

    return {
        "A_x": _A_in["x"],
        "A_wqkv": _A_in["wqkv"],
        "A_wo": _A_in["wo"],
        "B_x": _B_in["x"],
        "B_w_gate": _B_in["w_gate"],
        "B_w_up": _B_in["w_up"],
        "B_w_down": _B_in["w_down"],
        "gate_w": _w((lambda *s: torch.randn(*s, dtype=torch.bfloat16) * 0.05)(640) * 16.0),
    }

def reference(A_x, A_wqkv, A_wo, B_x, B_w_gate, B_w_up, B_w_down, gate_w):
    def _A_ref(x, wqkv, wo):
        B, S, D = x.shape
        H = 32
        Dh = D // H
        qkv = (lambda x, *d: x.permute(*d))((x @ wqkv).reshape(B, S, 3, H, Dh), 2, 0, 3, 1, 4)
        q, k, v = qkv[0], qkv[1], qkv[2]
        scores = torch.einsum("bhqd,bhkd->bhqk", q, k) * (Dh ** -0.5)
        p = _softmax(scores, axis=-1)
        o = torch.einsum("bhqk,bhkd->bhqd", p, v)
        return (lambda x, *d: x.permute(*d))(o, 0, 2, 1, 3).reshape(B, S, D) @ wo

    def _B_ref(x, w_gate, w_up, w_down):
        g = torch.einsum("bsd,df->bsf", x, w_gate)
        u = torch.einsum("bsd,df->bsf", x, w_up)
        h = g * u
        return torch.einsum("bsf,fd->bsd", h, w_down)

    x = A_x
    g = _sigmoid((x * gate_w).sum(-1, keepdims=True))
    a = _A_ref(x, A_wqkv, A_wo)
    b = _B_ref(x, B_w_gate, B_w_up, B_w_down)
    return g * a + (1 - g) * b
```

```asm
; @launch grid=(512,1,1) block=(512,1,1) lds=81920
.amdgcn_target "amdgcn-amd-amdhsa--gfx950"
.text
.globl gated_mix__mha_block__glu_gated_bilinear__prompt_kernel
.p2align 8
.type gated_mix__mha_block__glu_gated_bilinear__prompt_kernel,@function
gated_mix__mha_block__glu_gated_bilinear__prompt_kernel:
    s_load_dwordx16 s[4:19], s[0:1], 0
    s_load_dwordx4 s[20:23], s[0:1], 64
    s_load_dwordx2 s[24:25], s[0:1], 80
    v_lshrrev_b32 v1, 6, v0
    v_and_b32 v2, 63, v0
    v_readfirstlane_b32 s26, v1
    s_cmp_ge_u32 s2, 256
    s_cbranch_scc1 Lm_g
    s_setprio 3
    s_cmp_ge_u32 s2, 240
    s_cbranch_scc1 Lq_misc
    s_and_b32 s46, s2, 7
    s_lshr_b32 s47, s2, 3
    s_lshr_b32 s45, s46, 2
    s_lshl_b32 s45, s45, 1
    s_and_b32 s55, s46, 1
    s_add_u32 s45, s45, s55
    s_mul_i32 s57, s45, 30
    s_add_u32 s45, s57, s47
    s_bfe_u32 s58, s46, 0x10001
    s_lshl_b32 s44, s58, 3
    s_and_b32 s55, s45, 7
    s_add_u32 s44, s44, s55
    s_lshr_b32 s45, s45, 3
    s_cmp_lt_u32 s26, 4
    s_cbranch_scc1 Lq_c
    s_add_u32 s55, s44, s45
    s_mul_i32 s56, s55, 21846
    s_lshr_b32 s56, s56, 16
    s_mul_i32 s56, s56, 3
    s_sub_u32 s55, s55, s56
    s_mul_i32 s55, s55, 7
    s_lshr_b32 s55, s55, 1
    s_lshl_b32 s50, s55, 7
    s_mul_i32 s51, s55, 245760
    s_and_b32 s56, s26, 3
    v_lshrrev_b32 v3, 3, v2
    v_lshrrev_b32 v4, 4, v2
    v_and_b32 v5, 7, v2
    v_and_b32 v6, 15, v2
    s_lshl_b32 s46, s44, 7
    s_lshl_b32 s47, s56, 5
    s_add_u32 s46, s46, s47
    v_add_u32 v3, s46, v3
    v_mul_u32_u24 v3, 1280, v3
    v_xor_b32 v5, v5, v4
    v_lshl_add_u32 v16, v5, 4, v3
    v_xor_b32 v5, 4, v5
    v_lshl_add_u32 v17, v5, 4, v3
    v_add_u32 v17, 9216, v17
    v_add_u32 v18, 18432, v16
    v_add_u32 v19, 18432, v17
    v_lshlrev_b32 v7, 2, v4
    v_xor_b32 v7, v7, v6
    s_and_b32 s46, s56, 1
    s_lshl_b32 s46, s46, 1
    v_xor_b32 v7, s46, v7
    v_lshlrev_b32 v7, 4, v7
    s_lshl_b32 s46, s56, 3
    v_add_u32 v8, s46, v4
    v_mul_u32_u24 v8, 3840, v8
    s_lshl_b32 s47, s45, 8
    v_add3_u32 v20, v7, v8, s47
    v_add_u32 v21, 14336, v20
    s_lshl_b32 s48, s56, 12
    s_lshl_b32 s49, s56, 11
    s_add_u32 s49, s49, 49152
    s_waitcnt lgkmcnt(0)
    s_mov_b32 s28, s4
    s_mov_b32 s29, s5
    s_mov_b32 s30, 2621440
    s_mov_b32 s31, 0x00020000
    s_mov_b32 s32, s6
    s_mov_b32 s33, s7
    s_mov_b32 s34, 2457600
    s_mov_b32 s35, 0x00020000
    s_add_u32 m0, s48, 0
    s_nop 0
    buffer_load_dwordx4 v16, s[28:31], s50 offen offset:0 lds
    buffer_load_dwordx4 v17, s[28:31], s50 offen offset:1024 lds
    s_add_u32 m0, s48, 0
    s_nop 0
    buffer_load_dwordx4 v18, s[28:31], s50 offen offset:2048 lds
    buffer_load_dwordx4 v19, s[28:31], s50 offen offset:3072 lds
    s_add_u32 m0, s49, 0
    s_nop 0
    buffer_load_dwordx4 v20, s[32:35], s51 offen offset:0 lds
    buffer_load_dwordx4 v21, s[32:35], s51 offen offset:1024 lds
    s_add_u32 m0, s49, 8192
    s_add_u32 s51, s51, 122880
    s_cmp_eq_u32 s51, 2457600
    s_cmov_b32 s51, 0
    buffer_load_dwordx4 v20, s[32:35], s51 offen offset:0 lds
    buffer_load_dwordx4 v21, s[32:35], s51 offen offset:1024 lds
    s_add_u32 m0, s48, 16384
    s_add_u32 s50, s50, 128
    s_cmp_eq_u32 s50, 1280
    s_cmov_b32 s50, 0
    buffer_load_dwordx4 v16, s[28:31], s50 offen offset:0 lds
    buffer_load_dwordx4 v17, s[28:31], s50 offen offset:1024 lds
    s_add_u32 m0, s48, 16384
    s_nop 0
    buffer_load_dwordx4 v18, s[28:31], s50 offen offset:2048 lds
    buffer_load_dwordx4 v19, s[28:31], s50 offen offset:3072 lds
    s_add_u32 m0, s49, 16384
    s_add_u32 s51, s51, 122880
    s_cmp_eq_u32 s51, 2457600
    s_cmov_b32 s51, 0
    buffer_load_dwordx4 v20, s[32:35], s51 offen offset:0 lds
    buffer_load_dwordx4 v21, s[32:35], s51 offen offset:1024 lds
    s_add_u32 s76, s24, 9502720
    s_addc_u32 s77, s25, 0
    s_mov_b32 s78, 65536
    s_mov_b32 s79, 0x00020000
    s_mov_b32 s84, s22
    s_mov_b32 s85, s23
    s_mov_b32 s86, 256
    s_mov_b32 s87, 0x00020000
    s_waitcnt vmcnt(8)
    s_barrier
    s_add_u32 m0, s49, 24576
    s_add_u32 s51, s51, 122880
    s_cmp_eq_u32 s51, 2457600
    s_cmov_b32 s51, 0
    buffer_load_dwordx4 v20, s[32:35], s51 offen offset:0 lds
    buffer_load_dwordx4 v21, s[32:35], s51 offen offset:1024 lds
    s_add_u32 m0, s48, 32768
    s_add_u32 s50, s50, 128
    s_cmp_eq_u32 s50, 1280
    s_cmov_b32 s50, 0
    buffer_load_dwordx4 v16, s[28:31], s50 offen offset:0 lds
    buffer_load_dwordx4 v17, s[28:31], s50 offen offset:1024 lds
    s_waitcnt vmcnt(10)
    s_barrier
    s_add_u32 m0, s48, 32768
    s_nop 0
    buffer_load_dwordx4 v18, s[28:31], s50 offen offset:2048 lds
    buffer_load_dwordx4 v19, s[28:31], s50 offen offset:3072 lds
    s_add_u32 m0, s49, 0
    s_add_u32 s51, s51, 122880
    s_cmp_eq_u32 s51, 2457600
    s_cmov_b32 s51, 0
    buffer_load_dwordx4 v20, s[32:35], s51 offen offset:0 lds
    buffer_load_dwordx4 v21, s[32:35], s51 offen offset:1024 lds
    s_waitcnt vmcnt(8)
    s_barrier
    s_add_u32 m0, s49, 8192
    s_add_u32 s51, s51, 122880
    s_cmp_eq_u32 s51, 2457600
    s_cmov_b32 s51, 0
    buffer_load_dwordx4 v20, s[32:35], s51 offen offset:0 lds
    buffer_load_dwordx4 v21, s[32:35], s51 offen offset:1024 lds
    s_add_u32 m0, s48, 0
    s_add_u32 s50, s50, 128
    s_cmp_eq_u32 s50, 1280
    s_cmov_b32 s50, 0
    buffer_load_dwordx4 v16, s[28:31], s50 offen offset:0 lds
    buffer_load_dwordx4 v17, s[28:31], s50 offen offset:1024 lds
    s_waitcnt vmcnt(10)
    s_barrier
    s_add_u32 m0, s48, 0
    s_nop 0
    buffer_load_dwordx4 v18, s[28:31], s50 offen offset:2048 lds
    buffer_load_dwordx4 v19, s[28:31], s50 offen offset:3072 lds
    s_add_u32 m0, s49, 16384
    s_add_u32 s51, s51, 122880
    s_cmp_eq_u32 s51, 2457600
    s_cmov_b32 s51, 0
    buffer_load_dwordx4 v20, s[32:35], s51 offen offset:0 lds
    buffer_load_dwordx4 v21, s[32:35], s51 offen offset:1024 lds
    s_waitcnt vmcnt(8)
    s_barrier
    s_add_u32 m0, s49, 24576
    s_add_u32 s51, s51, 122880
    s_cmp_eq_u32 s51, 2457600
    s_cmov_b32 s51, 0
    buffer_load_dwordx4 v20, s[32:35], s51 offen offset:0 lds
    buffer_load_dwordx4 v21, s[32:35], s51 offen offset:1024 lds
    s_add_u32 m0, s48, 16384
    s_add_u32 s50, s50, 128
    s_cmp_eq_u32 s50, 1280
    s_cmov_b32 s50, 0
    buffer_load_dwordx4 v16, s[28:31], s50 offen offset:0 lds
    buffer_load_dwordx4 v17, s[28:31], s50 offen offset:1024 lds
    s_waitcnt vmcnt(10)
    s_barrier
    s_add_u32 m0, s48, 16384
    s_nop 0
    buffer_load_dwordx4 v18, s[28:31], s50 offen offset:2048 lds
    buffer_load_dwordx4 v19, s[28:31], s50 offen offset:3072 lds
    s_add_u32 m0, s49, 0
    s_add_u32 s51, s51, 122880
    s_cmp_eq_u32 s51, 2457600
    s_cmov_b32 s51, 0
    buffer_load_dwordx4 v20, s[32:35], s51 offen offset:0 lds
    buffer_load_dwordx4 v21, s[32:35], s51 offen offset:1024 lds
    s_waitcnt vmcnt(8)
    s_barrier
    s_add_u32 m0, s49, 8192
    s_add_u32 s51, s51, 122880
    s_cmp_eq_u32 s51, 2457600
    s_cmov_b32 s51, 0
    buffer_load_dwordx4 v20, s[32:35], s51 offen offset:0 lds
    buffer_load_dwordx4 v21, s[32:35], s51 offen offset:1024 lds
    s_add_u32 m0, s48, 32768
    s_add_u32 s50, s50, 128
    s_cmp_eq_u32 s50, 1280
    s_cmov_b32 s50, 0
    buffer_load_dwordx4 v16, s[28:31], s50 offen offset:0 lds
    buffer_load_dwordx4 v17, s[28:31], s50 offen offset:1024 lds
    s_waitcnt vmcnt(10)
    s_barrier
    s_add_u32 m0, s48, 32768
    s_nop 0
    buffer_load_dwordx4 v18, s[28:31], s50 offen offset:2048 lds
    buffer_load_dwordx4 v19, s[28:31], s50 offen offset:3072 lds
    s_add_u32 m0, s49, 16384
    s_add_u32 s51, s51, 122880
    s_cmp_eq_u32 s51, 2457600
    s_cmov_b32 s51, 0
    buffer_load_dwordx4 v20, s[32:35], s51 offen offset:0 lds
    buffer_load_dwordx4 v21, s[32:35], s51 offen offset:1024 lds
    s_waitcnt vmcnt(8)
    s_barrier
    s_add_u32 m0, s49, 24576
    s_add_u32 s51, s51, 122880
    s_cmp_eq_u32 s51, 2457600
    s_cmov_b32 s51, 0
    buffer_load_dwordx4 v20, s[32:35], s51 offen offset:0 lds
    buffer_load_dwordx4 v21, s[32:35], s51 offen offset:1024 lds
    s_add_u32 m0, s48, 0
    s_add_u32 s50, s50, 128
    s_cmp_eq_u32 s50, 1280
    s_cmov_b32 s50, 0
    buffer_load_dwordx4 v16, s[28:31], s50 offen offset:0 lds
    buffer_load_dwordx4 v17, s[28:31], s50 offen offset:1024 lds
    s_waitcnt vmcnt(10)
    s_barrier
    s_add_u32 m0, s48, 0
    s_nop 0
    buffer_load_dwordx4 v18, s[28:31], s50 offen offset:2048 lds
    buffer_load_dwordx4 v19, s[28:31], s50 offen offset:3072 lds
    s_add_u32 m0, s49, 0
    s_add_u32 s51, s51, 122880
    s_cmp_eq_u32 s51, 2457600
    s_cmov_b32 s51, 0
    buffer_load_dwordx4 v20, s[32:35], s51 offen offset:0 lds
    buffer_load_dwordx4 v21, s[32:35], s51 offen offset:1024 lds
    s_waitcnt vmcnt(8)
    s_barrier
    s_add_u32 m0, s49, 8192
    s_add_u32 s51, s51, 122880
    s_cmp_eq_u32 s51, 2457600
    s_cmov_b32 s51, 0
    buffer_load_dwordx4 v20, s[32:35], s51 offen offset:0 lds
    buffer_load_dwordx4 v21, s[32:35], s51 offen offset:1024 lds
    s_add_u32 m0, s48, 16384
    s_add_u32 s50, s50, 128
    s_cmp_eq_u32 s50, 1280
    s_cmov_b32 s50, 0
    buffer_load_dwordx4 v16, s[28:31], s50 offen offset:0 lds
    buffer_load_dwordx4 v17, s[28:31], s50 offen offset:1024 lds
    s_waitcnt vmcnt(10)
    s_barrier
    s_add_u32 m0, s48, 16384
    s_nop 0
    buffer_load_dwordx4 v18, s[28:31], s50 offen offset:2048 lds
    buffer_load_dwordx4 v19, s[28:31], s50 offen offset:3072 lds
    s_add_u32 m0, s49, 16384
    s_add_u32 s51, s51, 122880
    s_cmp_eq_u32 s51, 2457600
    s_cmov_b32 s51, 0
    buffer_load_dwordx4 v20, s[32:35], s51 offen offset:0 lds
    buffer_load_dwordx4 v21, s[32:35], s51 offen offset:1024 lds
    s_waitcnt vmcnt(8)
    s_barrier
    s_add_u32 m0, s49, 24576
    s_add_u32 s51, s51, 122880
    s_cmp_eq_u32 s51, 2457600
    s_cmov_b32 s51, 0
    buffer_load_dwordx4 v20, s[32:35], s51 offen offset:0 lds
    buffer_load_dwordx4 v21, s[32:35], s51 offen offset:1024 lds
    s_add_u32 m0, s48, 32768
    s_add_u32 s50, s50, 128
    s_cmp_eq_u32 s50, 1280
    s_cmov_b32 s50, 0
    buffer_load_dwordx4 v16, s[28:31], s50 offen offset:0 lds
    buffer_load_dwordx4 v17, s[28:31], s50 offen offset:1024 lds
    s_waitcnt vmcnt(10)
    s_barrier
    s_add_u32 m0, s48, 32768
    s_nop 0
    buffer_load_dwordx4 v18, s[28:31], s50 offen offset:2048 lds
    buffer_load_dwordx4 v19, s[28:31], s50 offen offset:3072 lds
    s_add_u32 m0, s49, 0
    s_add_u32 s51, s51, 122880
    s_cmp_eq_u32 s51, 2457600
    s_cmov_b32 s51, 0
    buffer_load_dwordx4 v20, s[32:35], s51 offen offset:0 lds
    buffer_load_dwordx4 v21, s[32:35], s51 offen offset:1024 lds
    s_waitcnt vmcnt(8)
    s_barrier
    s_add_u32 m0, s49, 8192
    s_add_u32 s51, s51, 122880
    s_cmp_eq_u32 s51, 2457600
    s_cmov_b32 s51, 0
    buffer_load_dwordx4 v20, s[32:35], s51 offen offset:0 lds
    buffer_load_dwordx4 v21, s[32:35], s51 offen offset:1024 lds
    s_add_u32 m0, s48, 0
    s_add_u32 s50, s50, 128
    s_cmp_eq_u32 s50, 1280
    s_cmov_b32 s50, 0
    buffer_load_dwordx4 v16, s[28:31], s50 offen offset:0 lds
    buffer_load_dwordx4 v17, s[28:31], s50 offen offset:1024 lds
    s_waitcnt vmcnt(10)
    s_barrier
    s_add_u32 m0, s48, 0
    s_nop 0
    buffer_load_dwordx4 v18, s[28:31], s50 offen offset:2048 lds
    buffer_load_dwordx4 v19, s[28:31], s50 offen offset:3072 lds
    s_add_u32 m0, s49, 16384
    s_add_u32 s51, s51, 122880
    s_cmp_eq_u32 s51, 2457600
    s_cmov_b32 s51, 0
    buffer_load_dwordx4 v20, s[32:35], s51 offen offset:0 lds
    buffer_load_dwordx4 v21, s[32:35], s51 offen offset:1024 lds
    s_waitcnt vmcnt(8)
    s_barrier
    s_add_u32 m0, s49, 24576
    s_add_u32 s51, s51, 122880
    s_cmp_eq_u32 s51, 2457600
    s_cmov_b32 s51, 0
    buffer_load_dwordx4 v20, s[32:35], s51 offen offset:0 lds
    buffer_load_dwordx4 v21, s[32:35], s51 offen offset:1024 lds
    s_waitcnt vmcnt(8)
    s_barrier
    s_waitcnt vmcnt(2)
    s_barrier
    s_waitcnt vmcnt(0)
    s_barrier
    s_branch Lq_done
Lq_c:
    s_waitcnt lgkmcnt(0)
    s_add_u32 s76, s24, 9502720
    s_addc_u32 s77, s25, 0
    s_mov_b32 s78, 65536
    s_mov_b32 s79, 0x00020000
    s_mov_b32 s84, s22
    s_mov_b32 s85, s23
    s_mov_b32 s86, 256
    s_mov_b32 s87, 0x00020000
    s_lshr_b32 s52, s26, 1
    s_and_b32 s53, s26, 1
    v_lshrrev_b32 v14, 4, v2
    v_and_b32 v15, 15, v2
    s_lshl_b32 s46, s52, 6
    v_add_u32 v64, s46, v15
    v_bfe_u32 v65, v64, 1, 3
    v_xor_b32 v65, v65, v14
    v_lshlrev_b32 v64, 7, v64
    v_lshl_add_u32 v3, v65, 4, v64
    v_xor_b32 v4, 64, v3
    v_bfe_u32 v64, v2, 2, 2
    v_lshl_add_u32 v65, v14, 3, v64
    v_lshlrev_b32 v65, 8, v65
    s_lshl_b32 s46, s53, 1
    v_xor_b32 v64, s46, v64
    v_lshl_add_u32 v65, v64, 6, v65
    v_and_b32 v64, 1, v14
    v_lshl_add_u32 v65, v64, 5, v65
    v_and_b32 v64, 3, v2
    v_lshl_add_u32 v65, v64, 3, v65
    v_add_u32 v5, 49152, v65
    v_xor_b32 v6, 32, v5
    v_xor_b32 v7, 64, v5
    v_xor_b32 v8, 96, v5
    s_lshl_b32 s55, s44, 2
    s_lshl_b32 s56, s52, 1
    s_add_u32 s55, s55, s56
    s_cmp_ge_u32 s45, 10
    s_cbranch_scc1 Lq_v
    s_cmp_ge_u32 s45, 5
    s_mov_b32 s57, 6291456
    s_cmov_b32 s57, 0
    s_mov_b32 s58, 163840
    s_cmov_b32 s58, 327680
    s_mov_b32 s59, 2560
    s_cmov_b32 s59, 5120
    s_mov_b32 s60, 0x3ea52b5c
    s_cmov_b32 s60, 1.0
    s_mov_b32 s61, 0
    s_cmov_b32 s61, 1280
    s_mov_b32 s62, 0
    s_cmov_b32 s62, 5
    s_sub_u32 s62, s45, s62
    s_lshl_b32 s63, s58, 4
    s_add_u32 s36, s24, s57
    s_addc_u32 s37, s25, 0
    s_mov_b32 s38, s63
    s_mov_b32 s39, 0x00020000
    s_mul_i32 s55, s55, s59
    s_add_u32 s56, s55, s59
    s_lshl_b32 s62, s62, 1
    s_add_u32 s62, s62, s53
    s_lshl_b32 s62, s62, 3
    s_mov_b32 s63, 52429
    v_and_b32 v68, 1, v14
    v_lshrrev_b32 v69, 1, v14
    v_lshl_add_u32 v68, v68, 1, v69
    v_add3_u32 v64, s62, v68, 0
    v_mul_u32_u24 v65, s63, v64
    v_lshrrev_b32 v65, 18, v65
    v_mul_u32_u24 v66, 5, v65
    v_sub_u32 v64, v64, v66
    v_sub_u32 v66, v64, 1
    v_med3_i32 v66, v66, 0, 2
    v_mul_u32_u24 v66, s61, v66
    v_lshl_add_u32 v66, v64, 9, v66
    v_lshl_add_u32 v66, v15, 4, v66
    v_mul_lo_u32 v65, v65, s58
    v_add_u32 v9, v65, v66
    v_add3_u32 v64, s62, v68, 4
    v_mul_u32_u24 v65, s63, v64
    v_lshrrev_b32 v65, 18, v65
    v_mul_u32_u24 v66, 5, v65
    v_sub_u32 v64, v64, v66
    v_sub_u32 v66, v64, 1
    v_med3_i32 v66, v66, 0, 2
    v_mul_u32_u24 v66, s61, v66
    v_lshl_add_u32 v66, v64, 9, v66
    v_lshl_add_u32 v66, v15, 4, v66
    v_mul_lo_u32 v65, v65, s58
    v_add_u32 v10, v65, v66
    v_mov_b32 v12, s60
    v_mov_b32 v13, s60
    s_barrier
    ds_read_b128 v[16:19], v3 offset:0
    ds_read_b128 v[20:23], v3 offset:2048
    ds_read_b128 v[24:27], v3 offset:4096
    ds_read_b128 v[28:31], v3 offset:6144
    ds_read_b64_tr_b16 v[48:49], v5 offset:0
    ds_read_b64_tr_b16 v[50:51], v5 offset:1024
    ds_read_b64_tr_b16 v[52:53], v6 offset:0
    ds_read_b64_tr_b16 v[54:55], v6 offset:1024
    ds_read_b64_tr_b16 v[56:57], v7 offset:0
    ds_read_b64_tr_b16 v[58:59], v7 offset:1024
    ds_read_b64_tr_b16 v[60:61], v8 offset:0
    ds_read_b64_tr_b16 v[62:63], v8 offset:1024
    s_waitcnt lgkmcnt(6)
    v_mfma_f32_16x16x32_bf16 v[64:67], v[48:51], v[16:19], 0
    v_mfma_f32_16x16x32_bf16 v[80:83], v[48:51], v[20:23], 0
    v_mfma_f32_16x16x32_bf16 v[96:99], v[48:51], v[24:27], 0
    v_mfma_f32_16x16x32_bf16 v[112:115], v[48:51], v[28:31], 0
    s_waitcnt lgkmcnt(0)
    s_barrier
    ds_read_b64_tr_b16 v[48:49], v5 offset:8192
    ds_read_b64_tr_b16 v[50:51], v5 offset:9216
    v_mfma_f32_16x16x32_bf16 v[68:71], v[52:55], v[16:19], 0
    ds_read_b128 v[32:35], v4 offset:0
    v_mfma_f32_16x16x32_bf16 v[84:87], v[52:55], v[20:23], 0
    ds_read_b128 v[36:39], v4 offset:2048
    v_mfma_f32_16x16x32_bf16 v[100:103], v[52:55], v[24:27], 0
    ds_read_b128 v[40:43], v4 offset:4096
    v_mfma_f32_16x16x32_bf16 v[116:119], v[52:55], v[28:31], 0
    ds_read_b128 v[44:47], v4 offset:6144
    ds_read_b64_tr_b16 v[52:53], v6 offset:8192
    ds_read_b64_tr_b16 v[54:55], v6 offset:9216
    v_mfma_f32_16x16x32_bf16 v[72:75], v[56:59], v[16:19], 0
    v_mfma_f32_16x16x32_bf16 v[88:91], v[56:59], v[20:23], 0
    v_mfma_f32_16x16x32_bf16 v[104:107], v[56:59], v[24:27], 0
    v_mfma_f32_16x16x32_bf16 v[120:123], v[56:59], v[28:31], 0
    ds_read_b64_tr_b16 v[56:57], v7 offset:8192
    ds_read_b64_tr_b16 v[58:59], v7 offset:9216
    v_mfma_f32_16x16x32_bf16 v[76:79], v[60:63], v[16:19], 0
    v_mfma_f32_16x16x32_bf16 v[92:95], v[60:63], v[20:23], 0
    v_mfma_f32_16x16x32_bf16 v[108:111], v[60:63], v[24:27], 0
    v_mfma_f32_16x16x32_bf16 v[124:127], v[60:63], v[28:31], 0
    ds_read_b64_tr_b16 v[60:61], v8 offset:8192
    ds_read_b64_tr_b16 v[62:63], v8 offset:9216
    s_waitcnt lgkmcnt(6)
    v_mfma_f32_16x16x32_bf16 v[64:67], v[48:51], v[32:35], v[64:67]
    v_mfma_f32_16x16x32_bf16 v[80:83], v[48:51], v[36:39], v[80:83]
    v_mfma_f32_16x16x32_bf16 v[96:99], v[48:51], v[40:43], v[96:99]
    v_mfma_f32_16x16x32_bf16 v[112:115], v[48:51], v[44:47], v[112:115]
    s_waitcnt lgkmcnt(0)
    s_barrier
    ds_read_b64_tr_b16 v[48:49], v5 offset:16384
    ds_read_b64_tr_b16 v[50:51], v5 offset:17408
    v_mfma_f32_16x16x32_bf16 v[68:71], v[52:55], v[32:35], v[68:71]
    ds_read_b128 v[16:19], v3 offset:16384
    v_mfma_f32_16x16x32_bf16 v[84:87], v[52:55], v[36:39], v[84:87]
    ds_read_b128 v[20:23], v3 offset:18432
    v_mfma_f32_16x16x32_bf16 v[100:103], v[52:55], v[40:43], v[100:103]
    ds_read_b128 v[24:27], v3 offset:20480
    v_mfma_f32_16x16x32_bf16 v[116:119], v[52:55], v[44:47], v[116:119]
    ds_read_b128 v[28:31], v3 offset:22528
    ds_read_b64_tr_b16 v[52:53], v6 offset:16384
    ds_read_b64_tr_b16 v[54:55], v6 offset:17408
    v_mfma_f32_16x16x32_bf16 v[72:75], v[56:59], v[32:35], v[72:75]
    v_mfma_f32_16x16x32_bf16 v[88:91], v[56:59], v[36:39], v[88:91]
    v_mfma_f32_16x16x32_bf16 v[104:107], v[56:59], v[40:43], v[104:107]
    v_mfma_f32_16x16x32_bf16 v[120:123], v[56:59], v[44:47], v[120:123]
    ds_read_b64_tr_b16 v[56:57], v7 offset:16384
    ds_read_b64_tr_b16 v[58:59], v7 offset:17408
    v_mfma_f32_16x16x32_bf16 v[76:79], v[60:63], v[32:35], v[76:79]
    v_mfma_f32_16x16x32_bf16 v[92:95], v[60:63], v[36:39], v[92:95]
    v_mfma_f32_16x16x32_bf16 v[108:111], v[60:63], v[40:43], v[108:111]
    v_mfma_f32_16x16x32_bf16 v[124:127], v[60:63], v[44:47], v[124:127]
    ds_read_b64_tr_b16 v[60:61], v8 offset:16384
    ds_read_b64_tr_b16 v[62:63], v8 offset:17408
    s_waitcnt lgkmcnt(6)
    v_mfma_f32_16x16x32_bf16 v[64:67], v[48:51], v[16:19], v[64:67]
    v_mfma_f32_16x16x32_bf16 v[80:83], v[48:51], v[20:23], v[80:83]
    v_mfma_f32_16x16x32_bf16 v[96:99], v[48:51], v[24:27], v[96:99]
    v_mfma_f32_16x16x32_bf16 v[112:115], v[48:51], v[28:31], v[112:115]
    s_waitcnt lgkmcnt(0)
    s_barrier
    ds_read_b64_tr_b16 v[48:49], v5 offset:24576
    ds_read_b64_tr_b16 v[50:51], v5 offset:25600
    v_mfma_f32_16x16x32_bf16 v[68:71], v[52:55], v[16:19], v[68:71]
    ds_read_b128 v[32:35], v4 offset:16384
    v_mfma_f32_16x16x32_bf16 v[84:87], v[52:55], v[20:23], v[84:87]
    ds_read_b128 v[36:39], v4 offset:18432
    v_mfma_f32_16x16x32_bf16 v[100:103], v[52:55], v[24:27], v[100:103]
    ds_read_b128 v[40:43], v4 offset:20480
    v_mfma_f32_16x16x32_bf16 v[116:119], v[52:55], v[28:31], v[116:119]
    ds_read_b128 v[44:47], v4 offset:22528
    ds_read_b64_tr_b16 v[52:53], v6 offset:24576
    ds_read_b64_tr_b16 v[54:55], v6 offset:25600
    v_mfma_f32_16x16x32_bf16 v[72:75], v[56:59], v[16:19], v[72:75]
    v_mfma_f32_16x16x32_bf16 v[88:91], v[56:59], v[20:23], v[88:91]
    v_mfma_f32_16x16x32_bf16 v[104:107], v[56:59], v[24:27], v[104:107]
    v_mfma_f32_16x16x32_bf16 v[120:123], v[56:59], v[28:31], v[120:123]
    ds_read_b64_tr_b16 v[56:57], v7 offset:24576
    ds_read_b64_tr_b16 v[58:59], v7 offset:25600
    v_mfma_f32_16x16x32_bf16 v[76:79], v[60:63], v[16:19], v[76:79]
    v_mfma_f32_16x16x32_bf16 v[92:95], v[60:63], v[20:23], v[92:95]
    v_mfma_f32_16x16x32_bf16 v[108:111], v[60:63], v[24:27], v[108:111]
    v_mfma_f32_16x16x32_bf16 v[124:127], v[60:63], v[28:31], v[124:127]
    ds_read_b64_tr_b16 v[60:61], v8 offset:24576
    ds_read_b64_tr_b16 v[62:63], v8 offset:25600
    s_waitcnt lgkmcnt(6)
    v_mfma_f32_16x16x32_bf16 v[64:67], v[48:51], v[32:35], v[64:67]
    v_mfma_f32_16x16x32_bf16 v[80:83], v[48:51], v[36:39], v[80:83]
    v_mfma_f32_16x16x32_bf16 v[96:99], v[48:51], v[40:43], v[96:99]
    v_mfma_f32_16x16x32_bf16 v[112:115], v[48:51], v[44:47], v[112:115]
    s_waitcnt lgkmcnt(0)
    s_barrier
    ds_read_b64_tr_b16 v[48:49], v5 offset:0
    ds_read_b64_tr_b16 v[50:51], v5 offset:1024
    v_mfma_f32_16x16x32_bf16 v[68:71], v[52:55], v[32:35], v[68:71]
    ds_read_b128 v[16:19], v3 offset:32768
    v_mfma_f32_16x16x32_bf16 v[84:87], v[52:55], v[36:39], v[84:87]
    ds_read_b128 v[20:23], v3 offset:34816
    v_mfma_f32_16x16x32_bf16 v[100:103], v[52:55], v[40:43], v[100:103]
    ds_read_b128 v[24:27], v3 offset:36864
    v_mfma_f32_16x16x32_bf16 v[116:119], v[52:55], v[44:47], v[116:119]
    ds_read_b128 v[28:31], v3 offset:38912
    ds_read_b64_tr_b16 v[52:53], v6 offset:0
    ds_read_b64_tr_b16 v[54:55], v6 offset:1024
    v_mfma_f32_16x16x32_bf16 v[72:75], v[56:59], v[32:35], v[72:75]
    v_mfma_f32_16x16x32_bf16 v[88:91], v[56:59], v[36:39], v[88:91]
    v_mfma_f32_16x16x32_bf16 v[104:107], v[56:59], v[40:43], v[104:107]
    v_mfma_f32_16x16x32_bf16 v[120:123], v[56:59], v[44:47], v[120:123]
    ds_read_b64_tr_b16 v[56:57], v7 offset:0
    ds_read_b64_tr_b16 v[58:59], v7 offset:1024
    v_mfma_f32_16x16x32_bf16 v[76:79], v[60:63], v[32:35], v[76:79]
    v_mfma_f32_16x16x32_bf16 v[92:95], v[60:63], v[36:39], v[92:95]
    v_mfma_f32_16x16x32_bf16 v[108:111], v[60:63], v[40:43], v[108:111]
    v_mfma_f32_16x16x32_bf16 v[124:127], v[60:63], v[44:47], v[124:127]
    ds_read_b64_tr_b16 v[60:61], v8 offset:0
    ds_read_b64_tr_b16 v[62:63], v8 offset:1024
    s_waitcnt lgkmcnt(6)
    v_mfma_f32_16x16x32_bf16 v[64:67], v[48:51], v[16:19], v[64:67]
    v_mfma_f32_16x16x32_bf16 v[80:83], v[48:51], v[20:23], v[80:83]
    v_mfma_f32_16x16x32_bf16 v[96:99], v[48:51], v[24:27], v[96:99]
    v_mfma_f32_16x16x32_bf16 v[112:115], v[48:51], v[28:31], v[112:115]
    s_waitcnt lgkmcnt(0)
    s_barrier
    ds_read_b64_tr_b16 v[48:49], v5 offset:8192
    ds_read_b64_tr_b16 v[50:51], v5 offset:9216
    v_mfma_f32_16x16x32_bf16 v[68:71], v[52:55], v[16:19], v[68:71]
    ds_read_b128 v[32:35], v4 offset:32768
    v_mfma_f32_16x16x32_bf16 v[84:87], v[52:55], v[20:23], v[84:87]
    ds_read_b128 v[36:39], v4 offset:34816
    v_mfma_f32_16x16x32_bf16 v[100:103], v[52:55], v[24:27], v[100:103]
    ds_read_b128 v[40:43], v4 offset:36864
    v_mfma_f32_16x16x32_bf16 v[116:119], v[52:55], v[28:31], v[116:119]
    ds_read_b128 v[44:47], v4 offset:38912
    ds_read_b64_tr_b16 v[52:53], v6 offset:8192
    ds_read_b64_tr_b16 v[54:55], v6 offset:9216
    v_mfma_f32_16x16x32_bf16 v[72:75], v[56:59], v[16:19], v[72:75]
    v_mfma_f32_16x16x32_bf16 v[88:91], v[56:59], v[20:23], v[88:91]
    v_mfma_f32_16x16x32_bf16 v[104:107], v[56:59], v[24:27], v[104:107]
    v_mfma_f32_16x16x32_bf16 v[120:123], v[56:59], v[28:31], v[120:123]
    ds_read_b64_tr_b16 v[56:57], v7 offset:8192
    ds_read_b64_tr_b16 v[58:59], v7 offset:9216
    v_mfma_f32_16x16x32_bf16 v[76:79], v[60:63], v[16:19], v[76:79]
    v_mfma_f32_16x16x32_bf16 v[92:95], v[60:63], v[20:23], v[92:95]
    v_mfma_f32_16x16x32_bf16 v[108:111], v[60:63], v[24:27], v[108:111]
    v_mfma_f32_16x16x32_bf16 v[124:127], v[60:63], v[28:31], v[124:127]
    ds_read_b64_tr_b16 v[60:61], v8 offset:8192
    ds_read_b64_tr_b16 v[62:63], v8 offset:9216
    s_waitcnt lgkmcnt(6)
    v_mfma_f32_16x16x32_bf16 v[64:67], v[48:51], v[32:35], v[64:67]
    v_mfma_f32_16x16x32_bf16 v[80:83], v[48:51], v[36:39], v[80:83]
    v_mfma_f32_16x16x32_bf16 v[96:99], v[48:51], v[40:43], v[96:99]
    v_mfma_f32_16x16x32_bf16 v[112:115], v[48:51], v[44:47], v[112:115]
    s_waitcnt lgkmcnt(0)
    s_barrier
    ds_read_b64_tr_b16 v[48:49], v5 offset:16384
    ds_read_b64_tr_b16 v[50:51], v5 offset:17408
    v_mfma_f32_16x16x32_bf16 v[68:71], v[52:55], v[32:35], v[68:71]
    ds_read_b128 v[16:19], v3 offset:0
    v_mfma_f32_16x16x32_bf16 v[84:87], v[52:55], v[36:39], v[84:87]
    ds_read_b128 v[20:23], v3 offset:2048
    v_mfma_f32_16x16x32_bf16 v[100:103], v[52:55], v[40:43], v[100:103]
    ds_read_b128 v[24:27], v3 offset:4096
    v_mfma_f32_16x16x32_bf16 v[116:119], v[52:55], v[44:47], v[116:119]
    ds_read_b128 v[28:31], v3 offset:6144
    ds_read_b64_tr_b16 v[52:53], v6 offset:16384
    ds_read_b64_tr_b16 v[54:55], v6 offset:17408
    v_mfma_f32_16x16x32_bf16 v[72:75], v[56:59], v[32:35], v[72:75]
    v_mfma_f32_16x16x32_bf16 v[88:91], v[56:59], v[36:39], v[88:91]
    v_mfma_f32_16x16x32_bf16 v[104:107], v[56:59], v[40:43], v[104:107]
    v_mfma_f32_16x16x32_bf16 v[120:123], v[56:59], v[44:47], v[120:123]
    ds_read_b64_tr_b16 v[56:57], v7 offset:16384
    ds_read_b64_tr_b16 v[58:59], v7 offset:17408
    v_mfma_f32_16x16x32_bf16 v[76:79], v[60:63], v[32:35], v[76:79]
    v_mfma_f32_16x16x32_bf16 v[92:95], v[60:63], v[36:39], v[92:95]
    v_mfma_f32_16x16x32_bf16 v[108:111], v[60:63], v[40:43], v[108:111]
    v_mfma_f32_16x16x32_bf16 v[124:127], v[60:63], v[44:47], v[124:127]
    ds_read_b64_tr_b16 v[60:61], v8 offset:16384
    ds_read_b64_tr_b16 v[62:63], v8 offset:17408
    s_waitcnt lgkmcnt(6)
    v_mfma_f32_16x16x32_bf16 v[64:67], v[48:51], v[16:19], v[64:67]
    v_mfma_f32_16x16x32_bf16 v[80:83], v[48:51], v[20:23], v[80:83]
    v_mfma_f32_16x16x32_bf16 v[96:99], v[48:51], v[24:27], v[96:99]
    v_mfma_f32_16x16x32_bf16 v[112:115], v[48:51], v[28:31], v[112:115]
    s_waitcnt lgkmcnt(0)
    s_barrier
    ds_read_b64_tr_b16 v[48:49], v5 offset:24576
    ds_read_b64_tr_b16 v[50:51], v5 offset:25600
    v_mfma_f32_16x16x32_bf16 v[68:71], v[52:55], v[16:19], v[68:71]
    ds_read_b128 v[32:35], v4 offset:0
    v_mfma_f32_16x16x32_bf16 v[84:87], v[52:55], v[20:23], v[84:87]
    ds_read_b128 v[36:39], v4 offset:2048
    v_mfma_f32_16x16x32_bf16 v[100:103], v[52:55], v[24:27], v[100:103]
    ds_read_b128 v[40:43], v4 offset:4096
    v_mfma_f32_16x16x32_bf16 v[116:119], v[52:55], v[28:31], v[116:119]
    ds_read_b128 v[44:47], v4 offset:6144
    ds_read_b64_tr_b16 v[52:53], v6 offset:24576
    ds_read_b64_tr_b16 v[54:55], v6 offset:25600
    v_mfma_f32_16x16x32_bf16 v[72:75], v[56:59], v[16:19], v[72:75]
    v_mfma_f32_16x16x32_bf16 v[88:91], v[56:59], v[20:23], v[88:91]
    v_mfma_f32_16x16x32_bf16 v[104:107], v[56:59], v[24:27], v[104:107]
    v_mfma_f32_16x16x32_bf16 v[120:123], v[56:59], v[28:31], v[120:123]
    ds_read_b64_tr_b16 v[56:57], v7 offset:24576
    ds_read_b64_tr_b16 v[58:59], v7 offset:25600
    v_mfma_f32_16x16x32_bf16 v[76:79], v[60:63], v[16:19], v[76:79]
    v_mfma_f32_16x16x32_bf16 v[92:95], v[60:63], v[20:23], v[92:95]
    v_mfma_f32_16x16x32_bf16 v[108:111], v[60:63], v[24:27], v[108:111]
    v_mfma_f32_16x16x32_bf16 v[124:127], v[60:63], v[28:31], v[124:127]
    ds_read_b64_tr_b16 v[60:61], v8 offset:24576
    ds_read_b64_tr_b16 v[62:63], v8 offset:25600
    s_waitcnt lgkmcnt(6)
    v_mfma_f32_16x16x32_bf16 v[64:67], v[48:51], v[32:35], v[64:67]
    v_mfma_f32_16x16x32_bf16 v[80:83], v[48:51], v[36:39], v[80:83]
    v_mfma_f32_16x16x32_bf16 v[96:99], v[48:51], v[40:43], v[96:99]
    v_mfma_f32_16x16x32_bf16 v[112:115], v[48:51], v[44:47], v[112:115]
    s_waitcnt lgkmcnt(0)
    s_barrier
    ds_read_b64_tr_b16 v[48:49], v5 offset:0
    ds_read_b64_tr_b16 v[50:51], v5 offset:1024
    v_mfma_f32_16x16x32_bf16 v[68:71], v[52:55], v[32:35], v[68:71]
    ds_read_b128 v[16:19], v3 offset:16384
    v_mfma_f32_16x16x32_bf16 v[84:87], v[52:55], v[36:39], v[84:87]
    ds_read_b128 v[20:23], v3 offset:18432
    v_mfma_f32_16x16x32_bf16 v[100:103], v[52:55], v[40:43], v[100:103]
    ds_read_b128 v[24:27], v3 offset:20480
    v_mfma_f32_16x16x32_bf16 v[116:119], v[52:55], v[44:47], v[116:119]
    ds_read_b128 v[28:31], v3 offset:22528
    ds_read_b64_tr_b16 v[52:53], v6 offset:0
    ds_read_b64_tr_b16 v[54:55], v6 offset:1024
    v_mfma_f32_16x16x32_bf16 v[72:75], v[56:59], v[32:35], v[72:75]
    v_mfma_f32_16x16x32_bf16 v[88:91], v[56:59], v[36:39], v[88:91]
    v_mfma_f32_16x16x32_bf16 v[104:107], v[56:59], v[40:43], v[104:107]
    v_mfma_f32_16x16x32_bf16 v[120:123], v[56:59], v[44:47], v[120:123]
    ds_read_b64_tr_b16 v[56:57], v7 offset:0
    ds_read_b64_tr_b16 v[58:59], v7 offset:1024
    v_mfma_f32_16x16x32_bf16 v[76:79], v[60:63], v[32:35], v[76:79]
    v_mfma_f32_16x16x32_bf16 v[92:95], v[60:63], v[36:39], v[92:95]
    v_mfma_f32_16x16x32_bf16 v[108:111], v[60:63], v[40:43], v[108:111]
    v_mfma_f32_16x16x32_bf16 v[124:127], v[60:63], v[44:47], v[124:127]
    ds_read_b64_tr_b16 v[60:61], v8 offset:0
    ds_read_b64_tr_b16 v[62:63], v8 offset:1024
    s_waitcnt lgkmcnt(6)
    v_mfma_f32_16x16x32_bf16 v[64:67], v[48:51], v[16:19], v[64:67]
    v_mfma_f32_16x16x32_bf16 v[80:83], v[48:51], v[20:23], v[80:83]
    v_mfma_f32_16x16x32_bf16 v[96:99], v[48:51], v[24:27], v[96:99]
    v_mfma_f32_16x16x32_bf16 v[112:115], v[48:51], v[28:31], v[112:115]
    s_waitcnt lgkmcnt(0)
    s_barrier
    ds_read_b64_tr_b16 v[48:49], v5 offset:8192
    ds_read_b64_tr_b16 v[50:51], v5 offset:9216
    v_mfma_f32_16x16x32_bf16 v[68:71], v[52:55], v[16:19], v[68:71]
    ds_read_b128 v[32:35], v4 offset:16384
    v_mfma_f32_16x16x32_bf16 v[84:87], v[52:55], v[20:23], v[84:87]
    ds_read_b128 v[36:39], v4 offset:18432
    v_mfma_f32_16x16x32_bf16 v[100:103], v[52:55], v[24:27], v[100:103]
    ds_read_b128 v[40:43], v4 offset:20480
    v_mfma_f32_16x16x32_bf16 v[116:119], v[52:55], v[28:31], v[116:119]
    ds_read_b128 v[44:47], v4 offset:22528
    ds_read_b64_tr_b16 v[52:53], v6 offset:8192
    ds_read_b64_tr_b16 v[54:55], v6 offset:9216
    v_mfma_f32_16x16x32_bf16 v[72:75], v[56:59], v[16:19], v[72:75]
    v_mfma_f32_16x16x32_bf16 v[88:91], v[56:59], v[20:23], v[88:91]
    v_mfma_f32_16x16x32_bf16 v[104:107], v[56:59], v[24:27], v[104:107]
    v_mfma_f32_16x16x32_bf16 v[120:123], v[56:59], v[28:31], v[120:123]
    ds_read_b64_tr_b16 v[56:57], v7 offset:8192
    ds_read_b64_tr_b16 v[58:59], v7 offset:9216
    v_mfma_f32_16x16x32_bf16 v[76:79], v[60:63], v[16:19], v[76:79]
    v_mfma_f32_16x16x32_bf16 v[92:95], v[60:63], v[20:23], v[92:95]
    v_mfma_f32_16x16x32_bf16 v[108:111], v[60:63], v[24:27], v[108:111]
    v_mfma_f32_16x16x32_bf16 v[124:127], v[60:63], v[28:31], v[124:127]
    ds_read_b64_tr_b16 v[60:61], v8 offset:8192
    ds_read_b64_tr_b16 v[62:63], v8 offset:9216
    s_waitcnt lgkmcnt(6)
    v_mfma_f32_16x16x32_bf16 v[64:67], v[48:51], v[32:35], v[64:67]
    v_mfma_f32_16x16x32_bf16 v[80:83], v[48:51], v[36:39], v[80:83]
    v_mfma_f32_16x16x32_bf16 v[96:99], v[48:51], v[40:43], v[96:99]
    v_mfma_f32_16x16x32_bf16 v[112:115], v[48:51], v[44:47], v[112:115]
    s_waitcnt lgkmcnt(0)
    s_barrier
    ds_read_b64_tr_b16 v[48:49], v5 offset:16384
    ds_read_b64_tr_b16 v[50:51], v5 offset:17408
    v_mfma_f32_16x16x32_bf16 v[68:71], v[52:55], v[32:35], v[68:71]
    ds_read_b128 v[16:19], v3 offset:32768
    v_mfma_f32_16x16x32_bf16 v[84:87], v[52:55], v[36:39], v[84:87]
    ds_read_b128 v[20:23], v3 offset:34816
    v_mfma_f32_16x16x32_bf16 v[100:103], v[52:55], v[40:43], v[100:103]
    ds_read_b128 v[24:27], v3 offset:36864
    v_mfma_f32_16x16x32_bf16 v[116:119], v[52:55], v[44:47], v[116:119]
    ds_read_b128 v[28:31], v3 offset:38912
    ds_read_b64_tr_b16 v[52:53], v6 offset:16384
    ds_read_b64_tr_b16 v[54:55], v6 offset:17408
    v_mfma_f32_16x16x32_bf16 v[72:75], v[56:59], v[32:35], v[72:75]
    v_mfma_f32_16x16x32_bf16 v[88:91], v[56:59], v[36:39], v[88:91]
    v_mfma_f32_16x16x32_bf16 v[104:107], v[56:59], v[40:43], v[104:107]
    v_mfma_f32_16x16x32_bf16 v[120:123], v[56:59], v[44:47], v[120:123]
    ds_read_b64_tr_b16 v[56:57], v7 offset:16384
    ds_read_b64_tr_b16 v[58:59], v7 offset:17408
    v_mfma_f32_16x16x32_bf16 v[76:79], v[60:63], v[32:35], v[76:79]
    v_mfma_f32_16x16x32_bf16 v[92:95], v[60:63], v[36:39], v[92:95]
    v_mfma_f32_16x16x32_bf16 v[108:111], v[60:63], v[40:43], v[108:111]
    v_mfma_f32_16x16x32_bf16 v[124:127], v[60:63], v[44:47], v[124:127]
    ds_read_b64_tr_b16 v[60:61], v8 offset:16384
    ds_read_b64_tr_b16 v[62:63], v8 offset:17408
    s_waitcnt lgkmcnt(6)
    v_mfma_f32_16x16x32_bf16 v[64:67], v[48:51], v[16:19], v[64:67]
    v_mfma_f32_16x16x32_bf16 v[80:83], v[48:51], v[20:23], v[80:83]
    v_mfma_f32_16x16x32_bf16 v[96:99], v[48:51], v[24:27], v[96:99]
    v_mfma_f32_16x16x32_bf16 v[112:115], v[48:51], v[28:31], v[112:115]
    s_waitcnt lgkmcnt(0)
    s_barrier
    ds_read_b64_tr_b16 v[48:49], v5 offset:24576
    ds_read_b64_tr_b16 v[50:51], v5 offset:25600
    v_mfma_f32_16x16x32_bf16 v[68:71], v[52:55], v[16:19], v[68:71]
    ds_read_b128 v[32:35], v4 offset:32768
    v_mfma_f32_16x16x32_bf16 v[84:87], v[52:55], v[20:23], v[84:87]
    ds_read_b128 v[36:39], v4 offset:34816
    v_mfma_f32_16x16x32_bf16 v[100:103], v[52:55], v[24:27], v[100:103]
    ds_read_b128 v[40:43], v4 offset:36864
    v_mfma_f32_16x16x32_bf16 v[116:119], v[52:55], v[28:31], v[116:119]
    ds_read_b128 v[44:47], v4 offset:38912
    ds_read_b64_tr_b16 v[52:53], v6 offset:24576
    ds_read_b64_tr_b16 v[54:55], v6 offset:25600
    v_mfma_f32_16x16x32_bf16 v[72:75], v[56:59], v[16:19], v[72:75]
    v_mfma_f32_16x16x32_bf16 v[88:91], v[56:59], v[20:23], v[88:91]
    v_mfma_f32_16x16x32_bf16 v[104:107], v[56:59], v[24:27], v[104:107]
    v_mfma_f32_16x16x32_bf16 v[120:123], v[56:59], v[28:31], v[120:123]
    ds_read_b64_tr_b16 v[56:57], v7 offset:24576
    ds_read_b64_tr_b16 v[58:59], v7 offset:25600
    v_mfma_f32_16x16x32_bf16 v[76:79], v[60:63], v[16:19], v[76:79]
    v_mfma_f32_16x16x32_bf16 v[92:95], v[60:63], v[20:23], v[92:95]
    v_mfma_f32_16x16x32_bf16 v[108:111], v[60:63], v[24:27], v[108:111]
    v_mfma_f32_16x16x32_bf16 v[124:127], v[60:63], v[28:31], v[124:127]
    ds_read_b64_tr_b16 v[60:61], v8 offset:24576
    ds_read_b64_tr_b16 v[62:63], v8 offset:25600
    s_waitcnt lgkmcnt(6)
    v_mfma_f32_16x16x32_bf16 v[64:67], v[48:51], v[32:35], v[64:67]
    v_mfma_f32_16x16x32_bf16 v[80:83], v[48:51], v[36:39], v[80:83]
    v_mfma_f32_16x16x32_bf16 v[96:99], v[48:51], v[40:43], v[96:99]
    v_mfma_f32_16x16x32_bf16 v[112:115], v[48:51], v[44:47], v[112:115]
    s_waitcnt lgkmcnt(0)
    s_barrier
    ds_read_b64_tr_b16 v[48:49], v5 offset:0
    ds_read_b64_tr_b16 v[50:51], v5 offset:1024
    v_mfma_f32_16x16x32_bf16 v[68:71], v[52:55], v[32:35], v[68:71]
    ds_read_b128 v[16:19], v3 offset:0
    v_mfma_f32_16x16x32_bf16 v[84:87], v[52:55], v[36:39], v[84:87]
    ds_read_b128 v[20:23], v3 offset:2048
    v_mfma_f32_16x16x32_bf16 v[100:103], v[52:55], v[40:43], v[100:103]
    ds_read_b128 v[24:27], v3 offset:4096
    v_mfma_f32_16x16x32_bf16 v[116:119], v[52:55], v[44:47], v[116:119]
    ds_read_b128 v[28:31], v3 offset:6144
    ds_read_b64_tr_b16 v[52:53], v6 offset:0
    ds_read_b64_tr_b16 v[54:55], v6 offset:1024
    v_mfma_f32_16x16x32_bf16 v[72:75], v[56:59], v[32:35], v[72:75]
    v_mfma_f32_16x16x32_bf16 v[88:91], v[56:59], v[36:39], v[88:91]
    v_mfma_f32_16x16x32_bf16 v[104:107], v[56:59], v[40:43], v[104:107]
    v_mfma_f32_16x16x32_bf16 v[120:123], v[56:59], v[44:47], v[120:123]
    ds_read_b64_tr_b16 v[56:57], v7 offset:0
    ds_read_b64_tr_b16 v[58:59], v7 offset:1024
    v_mfma_f32_16x16x32_bf16 v[76:79], v[60:63], v[32:35], v[76:79]
    v_mfma_f32_16x16x32_bf16 v[92:95], v[60:63], v[36:39], v[92:95]
    v_mfma_f32_16x16x32_bf16 v[108:111], v[60:63], v[40:43], v[108:111]
    v_mfma_f32_16x16x32_bf16 v[124:127], v[60:63], v[44:47], v[124:127]
    ds_read_b64_tr_b16 v[60:61], v8 offset:0
    ds_read_b64_tr_b16 v[62:63], v8 offset:1024
    s_waitcnt lgkmcnt(6)
    v_mfma_f32_16x16x32_bf16 v[64:67], v[48:51], v[16:19], v[64:67]
    v_mfma_f32_16x16x32_bf16 v[80:83], v[48:51], v[20:23], v[80:83]
    v_mfma_f32_16x16x32_bf16 v[96:99], v[48:51], v[24:27], v[96:99]
    v_mfma_f32_16x16x32_bf16 v[112:115], v[48:51], v[28:31], v[112:115]
    s_waitcnt lgkmcnt(0)
    s_barrier
    ds_read_b64_tr_b16 v[48:49], v5 offset:8192
    ds_read_b64_tr_b16 v[50:51], v5 offset:9216
    v_mfma_f32_16x16x32_bf16 v[68:71], v[52:55], v[16:19], v[68:71]
    ds_read_b128 v[32:35], v4 offset:0
    v_mfma_f32_16x16x32_bf16 v[84:87], v[52:55], v[20:23], v[84:87]
    ds_read_b128 v[36:39], v4 offset:2048
    v_mfma_f32_16x16x32_bf16 v[100:103], v[52:55], v[24:27], v[100:103]
    ds_read_b128 v[40:43], v4 offset:4096
    v_mfma_f32_16x16x32_bf16 v[116:119], v[52:55], v[28:31], v[116:119]
    ds_read_b128 v[44:47], v4 offset:6144
    ds_read_b64_tr_b16 v[52:53], v6 offset:8192
    ds_read_b64_tr_b16 v[54:55], v6 offset:9216
    v_mfma_f32_16x16x32_bf16 v[72:75], v[56:59], v[16:19], v[72:75]
    v_mfma_f32_16x16x32_bf16 v[88:91], v[56:59], v[20:23], v[88:91]
    v_mfma_f32_16x16x32_bf16 v[104:107], v[56:59], v[24:27], v[104:107]
    v_mfma_f32_16x16x32_bf16 v[120:123], v[56:59], v[28:31], v[120:123]
    ds_read_b64_tr_b16 v[56:57], v7 offset:8192
    ds_read_b64_tr_b16 v[58:59], v7 offset:9216
    v_mfma_f32_16x16x32_bf16 v[76:79], v[60:63], v[16:19], v[76:79]
    v_mfma_f32_16x16x32_bf16 v[92:95], v[60:63], v[20:23], v[92:95]
    v_mfma_f32_16x16x32_bf16 v[108:111], v[60:63], v[24:27], v[108:111]
    v_mfma_f32_16x16x32_bf16 v[124:127], v[60:63], v[28:31], v[124:127]
    ds_read_b64_tr_b16 v[60:61], v8 offset:8192
    ds_read_b64_tr_b16 v[62:63], v8 offset:9216
    s_waitcnt lgkmcnt(6)
    v_mfma_f32_16x16x32_bf16 v[64:67], v[48:51], v[32:35], v[64:67]
    v_mfma_f32_16x16x32_bf16 v[80:83], v[48:51], v[36:39], v[80:83]
    v_mfma_f32_16x16x32_bf16 v[96:99], v[48:51], v[40:43], v[96:99]
    v_mfma_f32_16x16x32_bf16 v[112:115], v[48:51], v[44:47], v[112:115]
    s_waitcnt lgkmcnt(0)
    s_barrier
    ds_read_b64_tr_b16 v[48:49], v5 offset:16384
    ds_read_b64_tr_b16 v[50:51], v5 offset:17408
    v_mfma_f32_16x16x32_bf16 v[68:71], v[52:55], v[32:35], v[68:71]
    ds_read_b128 v[16:19], v3 offset:16384
    v_mfma_f32_16x16x32_bf16 v[84:87], v[52:55], v[36:39], v[84:87]
    ds_read_b128 v[20:23], v3 offset:18432
    v_mfma_f32_16x16x32_bf16 v[100:103], v[52:55], v[40:43], v[100:103]
    ds_read_b128 v[24:27], v3 offset:20480
    v_mfma_f32_16x16x32_bf16 v[116:119], v[52:55], v[44:47], v[116:119]
    ds_read_b128 v[28:31], v3 offset:22528
    ds_read_b64_tr_b16 v[52:53], v6 offset:16384
    ds_read_b64_tr_b16 v[54:55], v6 offset:17408
    v_mfma_f32_16x16x32_bf16 v[72:75], v[56:59], v[32:35], v[72:75]
    v_mfma_f32_16x16x32_bf16 v[88:91], v[56:59], v[36:39], v[88:91]
    v_mfma_f32_16x16x32_bf16 v[104:107], v[56:59], v[40:43], v[104:107]
    v_mfma_f32_16x16x32_bf16 v[120:123], v[56:59], v[44:47], v[120:123]
    ds_read_b64_tr_b16 v[56:57], v7 offset:16384
    ds_read_b64_tr_b16 v[58:59], v7 offset:17408
    v_mfma_f32_16x16x32_bf16 v[76:79], v[60:63], v[32:35], v[76:79]
    v_mfma_f32_16x16x32_bf16 v[92:95], v[60:63], v[36:39], v[92:95]
    v_mfma_f32_16x16x32_bf16 v[108:111], v[60:63], v[40:43], v[108:111]
    v_mfma_f32_16x16x32_bf16 v[124:127], v[60:63], v[44:47], v[124:127]
    ds_read_b64_tr_b16 v[60:61], v8 offset:16384
    ds_read_b64_tr_b16 v[62:63], v8 offset:17408
    s_waitcnt lgkmcnt(6)
    v_mfma_f32_16x16x32_bf16 v[64:67], v[48:51], v[16:19], v[64:67]
    v_mfma_f32_16x16x32_bf16 v[80:83], v[48:51], v[20:23], v[80:83]
    v_mfma_f32_16x16x32_bf16 v[96:99], v[48:51], v[24:27], v[96:99]
    v_mfma_f32_16x16x32_bf16 v[112:115], v[48:51], v[28:31], v[112:115]
    s_waitcnt lgkmcnt(0)
    s_barrier
    ds_read_b64_tr_b16 v[48:49], v5 offset:24576
    ds_read_b64_tr_b16 v[50:51], v5 offset:25600
    v_mfma_f32_16x16x32_bf16 v[68:71], v[52:55], v[16:19], v[68:71]
    ds_read_b128 v[32:35], v4 offset:16384
    v_mfma_f32_16x16x32_bf16 v[84:87], v[52:55], v[20:23], v[84:87]
    ds_read_b128 v[36:39], v4 offset:18432
    v_mfma_f32_16x16x32_bf16 v[100:103], v[52:55], v[24:27], v[100:103]
    ds_read_b128 v[40:43], v4 offset:20480
    v_mfma_f32_16x16x32_bf16 v[116:119], v[52:55], v[28:31], v[116:119]
    ds_read_b128 v[44:47], v4 offset:22528
    ds_read_b64_tr_b16 v[52:53], v6 offset:24576
    ds_read_b64_tr_b16 v[54:55], v6 offset:25600
    v_mfma_f32_16x16x32_bf16 v[72:75], v[56:59], v[16:19], v[72:75]
    v_mfma_f32_16x16x32_bf16 v[88:91], v[56:59], v[20:23], v[88:91]
    v_mfma_f32_16x16x32_bf16 v[104:107], v[56:59], v[24:27], v[104:107]
    v_mfma_f32_16x16x32_bf16 v[120:123], v[56:59], v[28:31], v[120:123]
    ds_read_b64_tr_b16 v[56:57], v7 offset:24576
    ds_read_b64_tr_b16 v[58:59], v7 offset:25600
    v_mfma_f32_16x16x32_bf16 v[76:79], v[60:63], v[16:19], v[76:79]
    v_mfma_f32_16x16x32_bf16 v[92:95], v[60:63], v[20:23], v[92:95]
    v_mfma_f32_16x16x32_bf16 v[108:111], v[60:63], v[24:27], v[108:111]
    v_mfma_f32_16x16x32_bf16 v[124:127], v[60:63], v[28:31], v[124:127]
    ds_read_b64_tr_b16 v[60:61], v8 offset:24576
    ds_read_b64_tr_b16 v[62:63], v8 offset:25600
    s_waitcnt lgkmcnt(6)
    v_mfma_f32_16x16x32_bf16 v[64:67], v[48:51], v[32:35], v[64:67]
    v_mfma_f32_16x16x32_bf16 v[80:83], v[48:51], v[36:39], v[80:83]
    v_mfma_f32_16x16x32_bf16 v[96:99], v[48:51], v[40:43], v[96:99]
    v_mfma_f32_16x16x32_bf16 v[112:115], v[48:51], v[44:47], v[112:115]
    s_waitcnt lgkmcnt(0)
    s_barrier
    ds_read_b64_tr_b16 v[48:49], v5 offset:0
    ds_read_b64_tr_b16 v[50:51], v5 offset:1024
    v_mfma_f32_16x16x32_bf16 v[68:71], v[52:55], v[32:35], v[68:71]
    ds_read_b128 v[16:19], v3 offset:32768
    v_mfma_f32_16x16x32_bf16 v[84:87], v[52:55], v[36:39], v[84:87]
    ds_read_b128 v[20:23], v3 offset:34816
    v_mfma_f32_16x16x32_bf16 v[100:103], v[52:55], v[40:43], v[100:103]
    ds_read_b128 v[24:27], v3 offset:36864
    v_mfma_f32_16x16x32_bf16 v[116:119], v[52:55], v[44:47], v[116:119]
    ds_read_b128 v[28:31], v3 offset:38912
    ds_read_b64_tr_b16 v[52:53], v6 offset:0
    ds_read_b64_tr_b16 v[54:55], v6 offset:1024
    v_mfma_f32_16x16x32_bf16 v[72:75], v[56:59], v[32:35], v[72:75]
    v_mfma_f32_16x16x32_bf16 v[88:91], v[56:59], v[36:39], v[88:91]
    v_mfma_f32_16x16x32_bf16 v[104:107], v[56:59], v[40:43], v[104:107]
    v_mfma_f32_16x16x32_bf16 v[120:123], v[56:59], v[44:47], v[120:123]
    ds_read_b64_tr_b16 v[56:57], v7 offset:0
    ds_read_b64_tr_b16 v[58:59], v7 offset:1024
    v_mfma_f32_16x16x32_bf16 v[76:79], v[60:63], v[32:35], v[76:79]
    v_mfma_f32_16x16x32_bf16 v[92:95], v[60:63], v[36:39], v[92:95]
    v_mfma_f32_16x16x32_bf16 v[108:111], v[60:63], v[40:43], v[108:111]
    v_mfma_f32_16x16x32_bf16 v[124:127], v[60:63], v[44:47], v[124:127]
    ds_read_b64_tr_b16 v[60:61], v8 offset:0
    ds_read_b64_tr_b16 v[62:63], v8 offset:1024
    s_waitcnt lgkmcnt(6)
    v_mfma_f32_16x16x32_bf16 v[64:67], v[48:51], v[16:19], v[64:67]
    v_mfma_f32_16x16x32_bf16 v[80:83], v[48:51], v[20:23], v[80:83]
    v_mfma_f32_16x16x32_bf16 v[96:99], v[48:51], v[24:27], v[96:99]
    v_mfma_f32_16x16x32_bf16 v[112:115], v[48:51], v[28:31], v[112:115]
    s_waitcnt lgkmcnt(0)
    s_barrier
    ds_read_b64_tr_b16 v[48:49], v5 offset:8192
    ds_read_b64_tr_b16 v[50:51], v5 offset:9216
    v_mfma_f32_16x16x32_bf16 v[68:71], v[52:55], v[16:19], v[68:71]
    ds_read_b128 v[32:35], v4 offset:32768
    v_mfma_f32_16x16x32_bf16 v[84:87], v[52:55], v[20:23], v[84:87]
    ds_read_b128 v[36:39], v4 offset:34816
    v_mfma_f32_16x16x32_bf16 v[100:103], v[52:55], v[24:27], v[100:103]
    ds_read_b128 v[40:43], v4 offset:36864
    v_mfma_f32_16x16x32_bf16 v[116:119], v[52:55], v[28:31], v[116:119]
    ds_read_b128 v[44:47], v4 offset:38912
    ds_read_b64_tr_b16 v[52:53], v6 offset:8192
    ds_read_b64_tr_b16 v[54:55], v6 offset:9216
    v_mfma_f32_16x16x32_bf16 v[72:75], v[56:59], v[16:19], v[72:75]
    v_mfma_f32_16x16x32_bf16 v[88:91], v[56:59], v[20:23], v[88:91]
    v_mfma_f32_16x16x32_bf16 v[104:107], v[56:59], v[24:27], v[104:107]
    v_mfma_f32_16x16x32_bf16 v[120:123], v[56:59], v[28:31], v[120:123]
    ds_read_b64_tr_b16 v[56:57], v7 offset:8192
    ds_read_b64_tr_b16 v[58:59], v7 offset:9216
    v_mfma_f32_16x16x32_bf16 v[76:79], v[60:63], v[16:19], v[76:79]
    v_mfma_f32_16x16x32_bf16 v[92:95], v[60:63], v[20:23], v[92:95]
    v_mfma_f32_16x16x32_bf16 v[108:111], v[60:63], v[24:27], v[108:111]
    v_mfma_f32_16x16x32_bf16 v[124:127], v[60:63], v[28:31], v[124:127]
    ds_read_b64_tr_b16 v[60:61], v8 offset:8192
    ds_read_b64_tr_b16 v[62:63], v8 offset:9216
    s_waitcnt lgkmcnt(6)
    v_mfma_f32_16x16x32_bf16 v[64:67], v[48:51], v[32:35], v[64:67]
    v_mfma_f32_16x16x32_bf16 v[80:83], v[48:51], v[36:39], v[80:83]
    v_mfma_f32_16x16x32_bf16 v[96:99], v[48:51], v[40:43], v[96:99]
    v_mfma_f32_16x16x32_bf16 v[112:115], v[48:51], v[44:47], v[112:115]
    s_waitcnt lgkmcnt(0)
    s_barrier
    ds_read_b64_tr_b16 v[48:49], v5 offset:16384
    ds_read_b64_tr_b16 v[50:51], v5 offset:17408
    v_mfma_f32_16x16x32_bf16 v[68:71], v[52:55], v[32:35], v[68:71]
    ds_read_b128 v[16:19], v3 offset:0
    v_mfma_f32_16x16x32_bf16 v[84:87], v[52:55], v[36:39], v[84:87]
    ds_read_b128 v[20:23], v3 offset:2048
    v_mfma_f32_16x16x32_bf16 v[100:103], v[52:55], v[40:43], v[100:103]
    ds_read_b128 v[24:27], v3 offset:4096
    v_mfma_f32_16x16x32_bf16 v[116:119], v[52:55], v[44:47], v[116:119]
    ds_read_b128 v[28:31], v3 offset:6144
    ds_read_b64_tr_b16 v[52:53], v6 offset:16384
    ds_read_b64_tr_b16 v[54:55], v6 offset:17408
    v_mfma_f32_16x16x32_bf16 v[72:75], v[56:59], v[32:35], v[72:75]
    v_mfma_f32_16x16x32_bf16 v[88:91], v[56:59], v[36:39], v[88:91]
    v_mfma_f32_16x16x32_bf16 v[104:107], v[56:59], v[40:43], v[104:107]
    v_mfma_f32_16x16x32_bf16 v[120:123], v[56:59], v[44:47], v[120:123]
    ds_read_b64_tr_b16 v[56:57], v7 offset:16384
    ds_read_b64_tr_b16 v[58:59], v7 offset:17408
    v_mfma_f32_16x16x32_bf16 v[76:79], v[60:63], v[32:35], v[76:79]
    v_mfma_f32_16x16x32_bf16 v[92:95], v[60:63], v[36:39], v[92:95]
    v_mfma_f32_16x16x32_bf16 v[108:111], v[60:63], v[40:43], v[108:111]
    v_mfma_f32_16x16x32_bf16 v[124:127], v[60:63], v[44:47], v[124:127]
    ds_read_b64_tr_b16 v[60:61], v8 offset:16384
    ds_read_b64_tr_b16 v[62:63], v8 offset:17408
    s_waitcnt lgkmcnt(6)
    v_mfma_f32_16x16x32_bf16 v[64:67], v[48:51], v[16:19], v[64:67]
    v_mfma_f32_16x16x32_bf16 v[80:83], v[48:51], v[20:23], v[80:83]
    v_mfma_f32_16x16x32_bf16 v[96:99], v[48:51], v[24:27], v[96:99]
    v_mfma_f32_16x16x32_bf16 v[112:115], v[48:51], v[28:31], v[112:115]
    s_waitcnt lgkmcnt(0)
    s_barrier
    ds_read_b64_tr_b16 v[48:49], v5 offset:24576
    ds_read_b64_tr_b16 v[50:51], v5 offset:25600
    v_mfma_f32_16x16x32_bf16 v[68:71], v[52:55], v[16:19], v[68:71]
    ds_read_b128 v[32:35], v4 offset:0
    v_mfma_f32_16x16x32_bf16 v[84:87], v[52:55], v[20:23], v[84:87]
    ds_read_b128 v[36:39], v4 offset:2048
    v_mfma_f32_16x16x32_bf16 v[100:103], v[52:55], v[24:27], v[100:103]
    ds_read_b128 v[40:43], v4 offset:4096
    v_mfma_f32_16x16x32_bf16 v[116:119], v[52:55], v[28:31], v[116:119]
    ds_read_b128 v[44:47], v4 offset:6144
    ds_read_b64_tr_b16 v[52:53], v6 offset:24576
    ds_read_b64_tr_b16 v[54:55], v6 offset:25600
    v_mfma_f32_16x16x32_bf16 v[72:75], v[56:59], v[16:19], v[72:75]
    v_mfma_f32_16x16x32_bf16 v[88:91], v[56:59], v[20:23], v[88:91]
    v_mfma_f32_16x16x32_bf16 v[104:107], v[56:59], v[24:27], v[104:107]
    v_mfma_f32_16x16x32_bf16 v[120:123], v[56:59], v[28:31], v[120:123]
    ds_read_b64_tr_b16 v[56:57], v7 offset:24576
    ds_read_b64_tr_b16 v[58:59], v7 offset:25600
    v_mfma_f32_16x16x32_bf16 v[76:79], v[60:63], v[16:19], v[76:79]
    v_mfma_f32_16x16x32_bf16 v[92:95], v[60:63], v[20:23], v[92:95]
    v_mfma_f32_16x16x32_bf16 v[108:111], v[60:63], v[24:27], v[108:111]
    v_mfma_f32_16x16x32_bf16 v[124:127], v[60:63], v[28:31], v[124:127]
    ds_read_b64_tr_b16 v[60:61], v8 offset:24576
    ds_read_b64_tr_b16 v[62:63], v8 offset:25600
    s_waitcnt lgkmcnt(0)
    v_mfma_f32_16x16x32_bf16 v[64:67], v[48:51], v[32:35], v[64:67]
    v_mfma_f32_16x16x32_bf16 v[68:71], v[52:55], v[32:35], v[68:71]
    v_mfma_f32_16x16x32_bf16 v[72:75], v[56:59], v[32:35], v[72:75]
    v_mfma_f32_16x16x32_bf16 v[76:79], v[60:63], v[32:35], v[76:79]
    v_mfma_f32_16x16x32_bf16 v[80:83], v[48:51], v[36:39], v[80:83]
    v_mfma_f32_16x16x32_bf16 v[84:87], v[52:55], v[36:39], v[84:87]
    v_mfma_f32_16x16x32_bf16 v[88:91], v[56:59], v[36:39], v[88:91]
    v_mfma_f32_16x16x32_bf16 v[92:95], v[60:63], v[36:39], v[92:95]
    v_mfma_f32_16x16x32_bf16 v[96:99], v[48:51], v[40:43], v[96:99]
    v_pk_mul_f32 v[64:65], v[64:65], v[12:13]
    v_pk_mul_f32 v[66:67], v[66:67], v[12:13]
    v_pk_mul_f32 v[68:69], v[68:69], v[12:13]
    v_pk_mul_f32 v[70:71], v[70:71], v[12:13]
    v_pk_mul_f32 v[72:73], v[72:73], v[12:13]
    v_pk_mul_f32 v[74:75], v[74:75], v[12:13]
    v_mfma_f32_16x16x32_bf16 v[100:103], v[52:55], v[40:43], v[100:103]
    v_pk_mul_f32 v[76:77], v[76:77], v[12:13]
    v_pk_mul_f32 v[78:79], v[78:79], v[12:13]
    v_cvt_pk_bf16_f32 v16, v64, v65
    v_cvt_pk_bf16_f32 v17, v66, v67
    v_cvt_pk_bf16_f32 v18, v68, v69
    v_cvt_pk_bf16_f32 v19, v70, v71
    v_mfma_f32_16x16x32_bf16 v[104:107], v[56:59], v[40:43], v[104:107]
    v_cvt_pk_bf16_f32 v20, v72, v73
    v_cvt_pk_bf16_f32 v21, v74, v75
    v_cvt_pk_bf16_f32 v22, v76, v77
    v_cvt_pk_bf16_f32 v23, v78, v79
    v_permlane16_swap_b32 v16, v18
    v_permlane16_swap_b32 v17, v19
    v_mfma_f32_16x16x32_bf16 v[108:111], v[60:63], v[40:43], v[108:111]
    v_permlane16_swap_b32 v20, v22
    v_permlane16_swap_b32 v21, v23
    buffer_store_dwordx4 v[16:19], v9, s[36:39], s55 offen offset:0 sc1
    buffer_store_dwordx4 v[20:23], v10, s[36:39], s55 offen offset:0 sc1
    v_mfma_f32_16x16x32_bf16 v[112:115], v[48:51], v[44:47], v[112:115]
    v_pk_mul_f32 v[80:81], v[80:81], v[12:13]
    v_pk_mul_f32 v[82:83], v[82:83], v[12:13]
    v_pk_mul_f32 v[84:85], v[84:85], v[12:13]
    v_pk_mul_f32 v[86:87], v[86:87], v[12:13]
    v_pk_mul_f32 v[88:89], v[88:89], v[12:13]
    v_pk_mul_f32 v[90:91], v[90:91], v[12:13]
    v_mfma_f32_16x16x32_bf16 v[116:119], v[52:55], v[44:47], v[116:119]
    v_pk_mul_f32 v[92:93], v[92:93], v[12:13]
    v_pk_mul_f32 v[94:95], v[94:95], v[12:13]
    v_cvt_pk_bf16_f32 v24, v80, v81
    v_cvt_pk_bf16_f32 v25, v82, v83
    v_cvt_pk_bf16_f32 v26, v84, v85
    v_cvt_pk_bf16_f32 v27, v86, v87
    v_mfma_f32_16x16x32_bf16 v[120:123], v[56:59], v[44:47], v[120:123]
    v_cvt_pk_bf16_f32 v28, v88, v89
    v_cvt_pk_bf16_f32 v29, v90, v91
    v_cvt_pk_bf16_f32 v30, v92, v93
    v_cvt_pk_bf16_f32 v31, v94, v95
    v_permlane16_swap_b32 v24, v26
    v_permlane16_swap_b32 v25, v27
    v_mfma_f32_16x16x32_bf16 v[124:127], v[60:63], v[44:47], v[124:127]
    v_permlane16_swap_b32 v28, v30
    v_permlane16_swap_b32 v29, v31
    buffer_store_dwordx4 v[24:27], v9, s[36:39], s55 offen offset:256 sc1
    buffer_store_dwordx4 v[28:31], v10, s[36:39], s55 offen offset:256 sc1
    v_pk_mul_f32 v[96:97], v[96:97], v[12:13]
    v_pk_mul_f32 v[98:99], v[98:99], v[12:13]
    v_pk_mul_f32 v[100:101], v[100:101], v[12:13]
    v_pk_mul_f32 v[102:103], v[102:103], v[12:13]
    v_pk_mul_f32 v[104:105], v[104:105], v[12:13]
    v_pk_mul_f32 v[106:107], v[106:107], v[12:13]
    v_pk_mul_f32 v[108:109], v[108:109], v[12:13]
    v_pk_mul_f32 v[110:111], v[110:111], v[12:13]
    v_cvt_pk_bf16_f32 v64, v96, v97
    v_cvt_pk_bf16_f32 v65, v98, v99
    v_cvt_pk_bf16_f32 v66, v100, v101
    v_cvt_pk_bf16_f32 v67, v102, v103
    v_cvt_pk_bf16_f32 v68, v104, v105
    v_cvt_pk_bf16_f32 v69, v106, v107
    v_cvt_pk_bf16_f32 v70, v108, v109
    v_cvt_pk_bf16_f32 v71, v110, v111
    v_permlane16_swap_b32 v64, v66
    v_permlane16_swap_b32 v65, v67
    v_permlane16_swap_b32 v68, v70
    v_permlane16_swap_b32 v69, v71
    buffer_store_dwordx4 v[64:67], v9, s[36:39], s56 offen offset:0 sc1
    buffer_store_dwordx4 v[68:71], v10, s[36:39], s56 offen offset:0 sc1
    v_pk_mul_f32 v[112:113], v[112:113], v[12:13]
    v_pk_mul_f32 v[114:115], v[114:115], v[12:13]
    v_pk_mul_f32 v[116:117], v[116:117], v[12:13]
    v_pk_mul_f32 v[118:119], v[118:119], v[12:13]
    v_pk_mul_f32 v[120:121], v[120:121], v[12:13]
    v_pk_mul_f32 v[122:123], v[122:123], v[12:13]
    v_pk_mul_f32 v[124:125], v[124:125], v[12:13]
    v_pk_mul_f32 v[126:127], v[126:127], v[12:13]
    v_cvt_pk_bf16_f32 v72, v112, v113
    v_cvt_pk_bf16_f32 v73, v114, v115
    v_cvt_pk_bf16_f32 v74, v116, v117
    v_cvt_pk_bf16_f32 v75, v118, v119
    v_cvt_pk_bf16_f32 v76, v120, v121
    v_cvt_pk_bf16_f32 v77, v122, v123
    v_cvt_pk_bf16_f32 v78, v124, v125
    v_cvt_pk_bf16_f32 v79, v126, v127
    v_permlane16_swap_b32 v72, v74
    v_permlane16_swap_b32 v73, v75
    v_permlane16_swap_b32 v76, v78
    v_permlane16_swap_b32 v77, v79
    buffer_store_dwordx4 v[72:75], v9, s[36:39], s56 offen offset:256 sc1
    buffer_store_dwordx4 v[76:79], v10, s[36:39], s56 offen offset:256 sc1
    s_branch Lq_done
Lq_v:
    s_mov_b32 s36, s24
    s_mov_b32 s37, s25
    s_mov_b32 s38, 5242880
    s_mov_b32 s39, 0x00020000
    s_mul_i32 s55, s55, 5120
    s_add_u32 s56, s55, 5120
    s_sub_u32 s62, s45, 10
    s_lshl_b32 s62, s62, 1
    s_add_u32 s62, s62, s53
    s_lshl_b32 s62, s62, 6
    s_mov_b32 s63, 3277
    s_mov_b32 s58, 327680
    v_lshrrev_b32 v68, 1, v14
    v_lshl_add_u32 v68, v68, 4, v15
    v_and_b32 v69, 1, v14
    v_add3_u32 v64, s62, v68, 0
    v_mul_u32_u24 v65, s63, v64
    v_lshrrev_b32 v65, 16, v65
    v_mul_u32_u24 v66, 20, v65
    v_sub_u32 v64, v64, v66
    v_lshrrev_b32 v66, 2, v64
    v_xor_b32 v67, v66, v69
    v_and_b32 v67, 3, v67
    v_lshlrev_b32 v67, 6, v67
    v_lshl_add_u32 v67, v66, 8, v67
    v_and_b32 v64, 3, v64
    v_lshl_add_u32 v64, v64, 4, v67
    v_and_b32 v66, 1, v65
    v_mul_u32_u24 v66, 1792, v66
    v_lshrrev_b32 v65, 1, v65
    v_mul_lo_u32 v65, v65, s58
    v_add3_u32 v9, v64, v65, v66
    v_xor_b32 v10, 128, v9
    v_add3_u32 v64, s62, v68, 32
    v_mul_u32_u24 v65, s63, v64
    v_lshrrev_b32 v65, 16, v65
    v_mul_u32_u24 v66, 20, v65
    v_sub_u32 v64, v64, v66
    v_lshrrev_b32 v66, 2, v64
    v_xor_b32 v67, v66, v69
    v_and_b32 v67, 3, v67
    v_lshlrev_b32 v67, 6, v67
    v_lshl_add_u32 v67, v66, 8, v67
    v_and_b32 v64, 3, v64
    v_lshl_add_u32 v64, v64, 4, v67
    v_and_b32 v66, 1, v65
    v_mul_u32_u24 v66, 1792, v66
    v_lshrrev_b32 v65, 1, v65
    v_mul_lo_u32 v65, v65, s58
    v_add3_u32 v11, v64, v65, v66
    v_xor_b32 v12, 128, v11
    s_barrier
    ds_read_b128 v[16:19], v3 offset:0
    ds_read_b128 v[20:23], v3 offset:2048
    ds_read_b128 v[24:27], v3 offset:4096
    ds_read_b128 v[28:31], v3 offset:6144
    ds_read_b64_tr_b16 v[48:49], v5 offset:0
    ds_read_b64_tr_b16 v[50:51], v5 offset:1024
    ds_read_b64_tr_b16 v[52:53], v6 offset:0
    ds_read_b64_tr_b16 v[54:55], v6 offset:1024
    ds_read_b64_tr_b16 v[56:57], v7 offset:0
    ds_read_b64_tr_b16 v[58:59], v7 offset:1024
    ds_read_b64_tr_b16 v[60:61], v8 offset:0
    ds_read_b64_tr_b16 v[62:63], v8 offset:1024
    s_waitcnt lgkmcnt(6)
    v_mfma_f32_16x16x32_bf16 v[64:67], v[16:19], v[48:51], 0
    v_mfma_f32_16x16x32_bf16 v[80:83], v[20:23], v[48:51], 0
    v_mfma_f32_16x16x32_bf16 v[96:99], v[24:27], v[48:51], 0
    v_mfma_f32_16x16x32_bf16 v[112:115], v[28:31], v[48:51], 0
    s_waitcnt lgkmcnt(0)
    s_barrier
    ds_read_b64_tr_b16 v[48:49], v5 offset:8192
    ds_read_b64_tr_b16 v[50:51], v5 offset:9216
    v_mfma_f32_16x16x32_bf16 v[68:71], v[16:19], v[52:55], 0
    ds_read_b128 v[32:35], v4 offset:0
    v_mfma_f32_16x16x32_bf16 v[84:87], v[20:23], v[52:55], 0
    ds_read_b128 v[36:39], v4 offset:2048
    v_mfma_f32_16x16x32_bf16 v[100:103], v[24:27], v[52:55], 0
    ds_read_b128 v[40:43], v4 offset:4096
    v_mfma_f32_16x16x32_bf16 v[116:119], v[28:31], v[52:55], 0
    ds_read_b128 v[44:47], v4 offset:6144
    ds_read_b64_tr_b16 v[52:53], v6 offset:8192
    ds_read_b64_tr_b16 v[54:55], v6 offset:9216
    v_mfma_f32_16x16x32_bf16 v[72:75], v[16:19], v[56:59], 0
    v_mfma_f32_16x16x32_bf16 v[88:91], v[20:23], v[56:59], 0
    v_mfma_f32_16x16x32_bf16 v[104:107], v[24:27], v[56:59], 0
    v_mfma_f32_16x16x32_bf16 v[120:123], v[28:31], v[56:59], 0
    ds_read_b64_tr_b16 v[56:57], v7 offset:8192
    ds_read_b64_tr_b16 v[58:59], v7 offset:9216
    v_mfma_f32_16x16x32_bf16 v[76:79], v[16:19], v[60:63], 0
    v_mfma_f32_16x16x32_bf16 v[92:95], v[20:23], v[60:63], 0
    v_mfma_f32_16x16x32_bf16 v[108:111], v[24:27], v[60:63], 0
    v_mfma_f32_16x16x32_bf16 v[124:127], v[28:31], v[60:63], 0
    ds_read_b64_tr_b16 v[60:61], v8 offset:8192
    ds_read_b64_tr_b16 v[62:63], v8 offset:9216
    s_waitcnt lgkmcnt(6)
    v_mfma_f32_16x16x32_bf16 v[64:67], v[32:35], v[48:51], v[64:67]
    v_mfma_f32_16x16x32_bf16 v[80:83], v[36:39], v[48:51], v[80:83]
    v_mfma_f32_16x16x32_bf16 v[96:99], v[40:43], v[48:51], v[96:99]
    v_mfma_f32_16x16x32_bf16 v[112:115], v[44:47], v[48:51], v[112:115]
    s_waitcnt lgkmcnt(0)
    s_barrier
    ds_read_b64_tr_b16 v[48:49], v5 offset:16384
    ds_read_b64_tr_b16 v[50:51], v5 offset:17408
    v_mfma_f32_16x16x32_bf16 v[68:71], v[32:35], v[52:55], v[68:71]
    ds_read_b128 v[16:19], v3 offset:16384
    v_mfma_f32_16x16x32_bf16 v[84:87], v[36:39], v[52:55], v[84:87]
    ds_read_b128 v[20:23], v3 offset:18432
    v_mfma_f32_16x16x32_bf16 v[100:103], v[40:43], v[52:55], v[100:103]
    ds_read_b128 v[24:27], v3 offset:20480
    v_mfma_f32_16x16x32_bf16 v[116:119], v[44:47], v[52:55], v[116:119]
    ds_read_b128 v[28:31], v3 offset:22528
    ds_read_b64_tr_b16 v[52:53], v6 offset:16384
    ds_read_b64_tr_b16 v[54:55], v6 offset:17408
    v_mfma_f32_16x16x32_bf16 v[72:75], v[32:35], v[56:59], v[72:75]
    v_mfma_f32_16x16x32_bf16 v[88:91], v[36:39], v[56:59], v[88:91]
    v_mfma_f32_16x16x32_bf16 v[104:107], v[40:43], v[56:59], v[104:107]
    v_mfma_f32_16x16x32_bf16 v[120:123], v[44:47], v[56:59], v[120:123]
    ds_read_b64_tr_b16 v[56:57], v7 offset:16384
    ds_read_b64_tr_b16 v[58:59], v7 offset:17408
    v_mfma_f32_16x16x32_bf16 v[76:79], v[32:35], v[60:63], v[76:79]
    v_mfma_f32_16x16x32_bf16 v[92:95], v[36:39], v[60:63], v[92:95]
    v_mfma_f32_16x16x32_bf16 v[108:111], v[40:43], v[60:63], v[108:111]
    v_mfma_f32_16x16x32_bf16 v[124:127], v[44:47], v[60:63], v[124:127]
    ds_read_b64_tr_b16 v[60:61], v8 offset:16384
    ds_read_b64_tr_b16 v[62:63], v8 offset:17408
    s_waitcnt lgkmcnt(6)
    v_mfma_f32_16x16x32_bf16 v[64:67], v[16:19], v[48:51], v[64:67]
    v_mfma_f32_16x16x32_bf16 v[80:83], v[20:23], v[48:51], v[80:83]
    v_mfma_f32_16x16x32_bf16 v[96:99], v[24:27], v[48:51], v[96:99]
    v_mfma_f32_16x16x32_bf16 v[112:115], v[28:31], v[48:51], v[112:115]
    s_waitcnt lgkmcnt(0)
    s_barrier
    ds_read_b64_tr_b16 v[48:49], v5 offset:24576
    ds_read_b64_tr_b16 v[50:51], v5 offset:25600
    v_mfma_f32_16x16x32_bf16 v[68:71], v[16:19], v[52:55], v[68:71]
    ds_read_b128 v[32:35], v4 offset:16384
    v_mfma_f32_16x16x32_bf16 v[84:87], v[20:23], v[52:55], v[84:87]
    ds_read_b128 v[36:39], v4 offset:18432
    v_mfma_f32_16x16x32_bf16 v[100:103], v[24:27], v[52:55], v[100:103]
    ds_read_b128 v[40:43], v4 offset:20480
    v_mfma_f32_16x16x32_bf16 v[116:119], v[28:31], v[52:55], v[116:119]
    ds_read_b128 v[44:47], v4 offset:22528
    ds_read_b64_tr_b16 v[52:53], v6 offset:24576
    ds_read_b64_tr_b16 v[54:55], v6 offset:25600
    v_mfma_f32_16x16x32_bf16 v[72:75], v[16:19], v[56:59], v[72:75]
    v_mfma_f32_16x16x32_bf16 v[88:91], v[20:23], v[56:59], v[88:91]
    v_mfma_f32_16x16x32_bf16 v[104:107], v[24:27], v[56:59], v[104:107]
    v_mfma_f32_16x16x32_bf16 v[120:123], v[28:31], v[56:59], v[120:123]
    ds_read_b64_tr_b16 v[56:57], v7 offset:24576
    ds_read_b64_tr_b16 v[58:59], v7 offset:25600
    v_mfma_f32_16x16x32_bf16 v[76:79], v[16:19], v[60:63], v[76:79]
    v_mfma_f32_16x16x32_bf16 v[92:95], v[20:23], v[60:63], v[92:95]
    v_mfma_f32_16x16x32_bf16 v[108:111], v[24:27], v[60:63], v[108:111]
    v_mfma_f32_16x16x32_bf16 v[124:127], v[28:31], v[60:63], v[124:127]
    ds_read_b64_tr_b16 v[60:61], v8 offset:24576
    ds_read_b64_tr_b16 v[62:63], v8 offset:25600
    s_waitcnt lgkmcnt(6)
    v_mfma_f32_16x16x32_bf16 v[64:67], v[32:35], v[48:51], v[64:67]
    v_mfma_f32_16x16x32_bf16 v[80:83], v[36:39], v[48:51], v[80:83]
    v_mfma_f32_16x16x32_bf16 v[96:99], v[40:43], v[48:51], v[96:99]
    v_mfma_f32_16x16x32_bf16 v[112:115], v[44:47], v[48:51], v[112:115]
    s_waitcnt lgkmcnt(0)
    s_barrier
    ds_read_b64_tr_b16 v[48:49], v5 offset:0
    ds_read_b64_tr_b16 v[50:51], v5 offset:1024
    v_mfma_f32_16x16x32_bf16 v[68:71], v[32:35], v[52:55], v[68:71]
    ds_read_b128 v[16:19], v3 offset:32768
    v_mfma_f32_16x16x32_bf16 v[84:87], v[36:39], v[52:55], v[84:87]
    ds_read_b128 v[20:23], v3 offset:34816
    v_mfma_f32_16x16x32_bf16 v[100:103], v[40:43], v[52:55], v[100:103]
    ds_read_b128 v[24:27], v3 offset:36864
    v_mfma_f32_16x16x32_bf16 v[116:119], v[44:47], v[52:55], v[116:119]
    ds_read_b128 v[28:31], v3 offset:38912
    ds_read_b64_tr_b16 v[52:53], v6 offset:0
    ds_read_b64_tr_b16 v[54:55], v6 offset:1024
    v_mfma_f32_16x16x32_bf16 v[72:75], v[32:35], v[56:59], v[72:75]
    v_mfma_f32_16x16x32_bf16 v[88:91], v[36:39], v[56:59], v[88:91]
    v_mfma_f32_16x16x32_bf16 v[104:107], v[40:43], v[56:59], v[104:107]
    v_mfma_f32_16x16x32_bf16 v[120:123], v[44:47], v[56:59], v[120:123]
    ds_read_b64_tr_b16 v[56:57], v7 offset:0
    ds_read_b64_tr_b16 v[58:59], v7 offset:1024
    v_mfma_f32_16x16x32_bf16 v[76:79], v[32:35], v[60:63], v[76:79]
    v_mfma_f32_16x16x32_bf16 v[92:95], v[36:39], v[60:63], v[92:95]
    v_mfma_f32_16x16x32_bf16 v[108:111], v[40:43], v[60:63], v[108:111]
    v_mfma_f32_16x16x32_bf16 v[124:127], v[44:47], v[60:63], v[124:127]
    ds_read_b64_tr_b16 v[60:61], v8 offset:0
    ds_read_b64_tr_b16 v[62:63], v8 offset:1024
    s_waitcnt lgkmcnt(6)
    v_mfma_f32_16x16x32_bf16 v[64:67], v[16:19], v[48:51], v[64:67]
    v_mfma_f32_16x16x32_bf16 v[80:83], v[20:23], v[48:51], v[80:83]
    v_mfma_f32_16x16x32_bf16 v[96:99], v[24:27], v[48:51], v[96:99]
    v_mfma_f32_16x16x32_bf16 v[112:115], v[28:31], v[48:51], v[112:115]
    s_waitcnt lgkmcnt(0)
    s_barrier
    ds_read_b64_tr_b16 v[48:49], v5 offset:8192
    ds_read_b64_tr_b16 v[50:51], v5 offset:9216
    v_mfma_f32_16x16x32_bf16 v[68:71], v[16:19], v[52:55], v[68:71]
    ds_read_b128 v[32:35], v4 offset:32768
    v_mfma_f32_16x16x32_bf16 v[84:87], v[20:23], v[52:55], v[84:87]
    ds_read_b128 v[36:39], v4 offset:34816
    v_mfma_f32_16x16x32_bf16 v[100:103], v[24:27], v[52:55], v[100:103]
    ds_read_b128 v[40:43], v4 offset:36864
    v_mfma_f32_16x16x32_bf16 v[116:119], v[28:31], v[52:55], v[116:119]
    ds_read_b128 v[44:47], v4 offset:38912
    ds_read_b64_tr_b16 v[52:53], v6 offset:8192
    ds_read_b64_tr_b16 v[54:55], v6 offset:9216
    v_mfma_f32_16x16x32_bf16 v[72:75], v[16:19], v[56:59], v[72:75]
    v_mfma_f32_16x16x32_bf16 v[88:91], v[20:23], v[56:59], v[88:91]
    v_mfma_f32_16x16x32_bf16 v[104:107], v[24:27], v[56:59], v[104:107]
    v_mfma_f32_16x16x32_bf16 v[120:123], v[28:31], v[56:59], v[120:123]
    ds_read_b64_tr_b16 v[56:57], v7 offset:8192
    ds_read_b64_tr_b16 v[58:59], v7 offset:9216
    v_mfma_f32_16x16x32_bf16 v[76:79], v[16:19], v[60:63], v[76:79]
    v_mfma_f32_16x16x32_bf16 v[92:95], v[20:23], v[60:63], v[92:95]
    v_mfma_f32_16x16x32_bf16 v[108:111], v[24:27], v[60:63], v[108:111]
    v_mfma_f32_16x16x32_bf16 v[124:127], v[28:31], v[60:63], v[124:127]
    ds_read_b64_tr_b16 v[60:61], v8 offset:8192
    ds_read_b64_tr_b16 v[62:63], v8 offset:9216
    s_waitcnt lgkmcnt(6)
    v_mfma_f32_16x16x32_bf16 v[64:67], v[32:35], v[48:51], v[64:67]
    v_mfma_f32_16x16x32_bf16 v[80:83], v[36:39], v[48:51], v[80:83]
    v_mfma_f32_16x16x32_bf16 v[96:99], v[40:43], v[48:51], v[96:99]
    v_mfma_f32_16x16x32_bf16 v[112:115], v[44:47], v[48:51], v[112:115]
    s_waitcnt lgkmcnt(0)
    s_barrier
    ds_read_b64_tr_b16 v[48:49], v5 offset:16384
    ds_read_b64_tr_b16 v[50:51], v5 offset:17408
    v_mfma_f32_16x16x32_bf16 v[68:71], v[32:35], v[52:55], v[68:71]
    ds_read_b128 v[16:19], v3 offset:0
    v_mfma_f32_16x16x32_bf16 v[84:87], v[36:39], v[52:55], v[84:87]
    ds_read_b128 v[20:23], v3 offset:2048
    v_mfma_f32_16x16x32_bf16 v[100:103], v[40:43], v[52:55], v[100:103]
    ds_read_b128 v[24:27], v3 offset:4096
    v_mfma_f32_16x16x32_bf16 v[116:119], v[44:47], v[52:55], v[116:119]
    ds_read_b128 v[28:31], v3 offset:6144
    ds_read_b64_tr_b16 v[52:53], v6 offset:16384
    ds_read_b64_tr_b16 v[54:55], v6 offset:17408
    v_mfma_f32_16x16x32_bf16 v[72:75], v[32:35], v[56:59], v[72:75]
    v_mfma_f32_16x16x32_bf16 v[88:91], v[36:39], v[56:59], v[88:91]
    v_mfma_f32_16x16x32_bf16 v[104:107], v[40:43], v[56:59], v[104:107]
    v_mfma_f32_16x16x32_bf16 v[120:123], v[44:47], v[56:59], v[120:123]
    ds_read_b64_tr_b16 v[56:57], v7 offset:16384
    ds_read_b64_tr_b16 v[58:59], v7 offset:17408
    v_mfma_f32_16x16x32_bf16 v[76:79], v[32:35], v[60:63], v[76:79]
    v_mfma_f32_16x16x32_bf16 v[92:95], v[36:39], v[60:63], v[92:95]
    v_mfma_f32_16x16x32_bf16 v[108:111], v[40:43], v[60:63], v[108:111]
    v_mfma_f32_16x16x32_bf16 v[124:127], v[44:47], v[60:63], v[124:127]
    ds_read_b64_tr_b16 v[60:61], v8 offset:16384
    ds_read_b64_tr_b16 v[62:63], v8 offset:17408
    s_waitcnt lgkmcnt(6)
    v_mfma_f32_16x16x32_bf16 v[64:67], v[16:19], v[48:51], v[64:67]
    v_mfma_f32_16x16x32_bf16 v[80:83], v[20:23], v[48:51], v[80:83]
    v_mfma_f32_16x16x32_bf16 v[96:99], v[24:27], v[48:51], v[96:99]
    v_mfma_f32_16x16x32_bf16 v[112:115], v[28:31], v[48:51], v[112:115]
    s_waitcnt lgkmcnt(0)
    s_barrier
    ds_read_b64_tr_b16 v[48:49], v5 offset:24576
    ds_read_b64_tr_b16 v[50:51], v5 offset:25600
    v_mfma_f32_16x16x32_bf16 v[68:71], v[16:19], v[52:55], v[68:71]
    ds_read_b128 v[32:35], v4 offset:0
    v_mfma_f32_16x16x32_bf16 v[84:87], v[20:23], v[52:55], v[84:87]
    ds_read_b128 v[36:39], v4 offset:2048
    v_mfma_f32_16x16x32_bf16 v[100:103], v[24:27], v[52:55], v[100:103]
    ds_read_b128 v[40:43], v4 offset:4096
    v_mfma_f32_16x16x32_bf16 v[116:119], v[28:31], v[52:55], v[116:119]
    ds_read_b128 v[44:47], v4 offset:6144
    ds_read_b64_tr_b16 v[52:53], v6 offset:24576
    ds_read_b64_tr_b16 v[54:55], v6 offset:25600
    v_mfma_f32_16x16x32_bf16 v[72:75], v[16:19], v[56:59], v[72:75]
    v_mfma_f32_16x16x32_bf16 v[88:91], v[20:23], v[56:59], v[88:91]
    v_mfma_f32_16x16x32_bf16 v[104:107], v[24:27], v[56:59], v[104:107]
    v_mfma_f32_16x16x32_bf16 v[120:123], v[28:31], v[56:59], v[120:123]
    ds_read_b64_tr_b16 v[56:57], v7 offset:24576
    ds_read_b64_tr_b16 v[58:59], v7 offset:25600
    v_mfma_f32_16x16x32_bf16 v[76:79], v[16:19], v[60:63], v[76:79]
    v_mfma_f32_16x16x32_bf16 v[92:95], v[20:23], v[60:63], v[92:95]
    v_mfma_f32_16x16x32_bf16 v[108:111], v[24:27], v[60:63], v[108:111]
    v_mfma_f32_16x16x32_bf16 v[124:127], v[28:31], v[60:63], v[124:127]
    ds_read_b64_tr_b16 v[60:61], v8 offset:24576
    ds_read_b64_tr_b16 v[62:63], v8 offset:25600
    s_waitcnt lgkmcnt(6)
    v_mfma_f32_16x16x32_bf16 v[64:67], v[32:35], v[48:51], v[64:67]
    v_mfma_f32_16x16x32_bf16 v[80:83], v[36:39], v[48:51], v[80:83]
    v_mfma_f32_16x16x32_bf16 v[96:99], v[40:43], v[48:51], v[96:99]
    v_mfma_f32_16x16x32_bf16 v[112:115], v[44:47], v[48:51], v[112:115]
    s_waitcnt lgkmcnt(0)
    s_barrier
    ds_read_b64_tr_b16 v[48:49], v5 offset:0
    ds_read_b64_tr_b16 v[50:51], v5 offset:1024
    v_mfma_f32_16x16x32_bf16 v[68:71], v[32:35], v[52:55], v[68:71]
    ds_read_b128 v[16:19], v3 offset:16384
    v_mfma_f32_16x16x32_bf16 v[84:87], v[36:39], v[52:55], v[84:87]
    ds_read_b128 v[20:23], v3 offset:18432
    v_mfma_f32_16x16x32_bf16 v[100:103], v[40:43], v[52:55], v[100:103]
    ds_read_b128 v[24:27], v3 offset:20480
    v_mfma_f32_16x16x32_bf16 v[116:119], v[44:47], v[52:55], v[116:119]
    ds_read_b128 v[28:31], v3 offset:22528
    ds_read_b64_tr_b16 v[52:53], v6 offset:0
    ds_read_b64_tr_b16 v[54:55], v6 offset:1024
    v_mfma_f32_16x16x32_bf16 v[72:75], v[32:35], v[56:59], v[72:75]
    v_mfma_f32_16x16x32_bf16 v[88:91], v[36:39], v[56:59], v[88:91]
    v_mfma_f32_16x16x32_bf16 v[104:107], v[40:43], v[56:59], v[104:107]
    v_mfma_f32_16x16x32_bf16 v[120:123], v[44:47], v[56:59], v[120:123]
    ds_read_b64_tr_b16 v[56:57], v7 offset:0
    ds_read_b64_tr_b16 v[58:59], v7 offset:1024
    v_mfma_f32_16x16x32_bf16 v[76:79], v[32:35], v[60:63], v[76:79]
    v_mfma_f32_16x16x32_bf16 v[92:95], v[36:39], v[60:63], v[92:95]
    v_mfma_f32_16x16x32_bf16 v[108:111], v[40:43], v[60:63], v[108:111]
    v_mfma_f32_16x16x32_bf16 v[124:127], v[44:47], v[60:63], v[124:127]
    ds_read_b64_tr_b16 v[60:61], v8 offset:0
    ds_read_b64_tr_b16 v[62:63], v8 offset:1024
    s_waitcnt lgkmcnt(6)
    v_mfma_f32_16x16x32_bf16 v[64:67], v[16:19], v[48:51], v[64:67]
    v_mfma_f32_16x16x32_bf16 v[80:83], v[20:23], v[48:51], v[80:83]
    v_mfma_f32_16x16x32_bf16 v[96:99], v[24:27], v[48:51], v[96:99]
    v_mfma_f32_16x16x32_bf16 v[112:115], v[28:31], v[48:51], v[112:115]
    s_waitcnt lgkmcnt(0)
    s_barrier
    ds_read_b64_tr_b16 v[48:49], v5 offset:8192
    ds_read_b64_tr_b16 v[50:51], v5 offset:9216
    v_mfma_f32_16x16x32_bf16 v[68:71], v[16:19], v[52:55], v[68:71]
    ds_read_b128 v[32:35], v4 offset:16384
    v_mfma_f32_16x16x32_bf16 v[84:87], v[20:23], v[52:55], v[84:87]
    ds_read_b128 v[36:39], v4 offset:18432
    v_mfma_f32_16x16x32_bf16 v[100:103], v[24:27], v[52:55], v[100:103]
    ds_read_b128 v[40:43], v4 offset:20480
    v_mfma_f32_16x16x32_bf16 v[116:119], v[28:31], v[52:55], v[116:119]
    ds_read_b128 v[44:47], v4 offset:22528
    ds_read_b64_tr_b16 v[52:53], v6 offset:8192
    ds_read_b64_tr_b16 v[54:55], v6 offset:9216
    v_mfma_f32_16x16x32_bf16 v[72:75], v[16:19], v[56:59], v[72:75]
    v_mfma_f32_16x16x32_bf16 v[88:91], v[20:23], v[56:59], v[88:91]
    v_mfma_f32_16x16x32_bf16 v[104:107], v[24:27], v[56:59], v[104:107]
    v_mfma_f32_16x16x32_bf16 v[120:123], v[28:31], v[56:59], v[120:123]
    ds_read_b64_tr_b16 v[56:57], v7 offset:8192
    ds_read_b64_tr_b16 v[58:59], v7 offset:9216
    v_mfma_f32_16x16x32_bf16 v[76:79], v[16:19], v[60:63], v[76:79]
    v_mfma_f32_16x16x32_bf16 v[92:95], v[20:23], v[60:63], v[92:95]
    v_mfma_f32_16x16x32_bf16 v[108:111], v[24:27], v[60:63], v[108:111]
    v_mfma_f32_16x16x32_bf16 v[124:127], v[28:31], v[60:63], v[124:127]
    ds_read_b64_tr_b16 v[60:61], v8 offset:8192
    ds_read_b64_tr_b16 v[62:63], v8 offset:9216
    s_waitcnt lgkmcnt(6)
    v_mfma_f32_16x16x32_bf16 v[64:67], v[32:35], v[48:51], v[64:67]
    v_mfma_f32_16x16x32_bf16 v[80:83], v[36:39], v[48:51], v[80:83]
    v_mfma_f32_16x16x32_bf16 v[96:99], v[40:43], v[48:51], v[96:99]
    v_mfma_f32_16x16x32_bf16 v[112:115], v[44:47], v[48:51], v[112:115]
    s_waitcnt lgkmcnt(0)
    s_barrier
    ds_read_b64_tr_b16 v[48:49], v5 offset:16384
    ds_read_b64_tr_b16 v[50:51], v5 offset:17408
    v_mfma_f32_16x16x32_bf16 v[68:71], v[32:35], v[52:55], v[68:71]
    ds_read_b128 v[16:19], v3 offset:32768
    v_mfma_f32_16x16x32_bf16 v[84:87], v[36:39], v[52:55], v[84:87]
    ds_read_b128 v[20:23], v3 offset:34816
    v_mfma_f32_16x16x32_bf16 v[100:103], v[40:43], v[52:55], v[100:103]
    ds_read_b128 v[24:27], v3 offset:36864
    v_mfma_f32_16x16x32_bf16 v[116:119], v[44:47], v[52:55], v[116:119]
    ds_read_b128 v[28:31], v3 offset:38912
    ds_read_b64_tr_b16 v[52:53], v6 offset:16384
    ds_read_b64_tr_b16 v[54:55], v6 offset:17408
    v_mfma_f32_16x16x32_bf16 v[72:75], v[32:35], v[56:59], v[72:75]
    v_mfma_f32_16x16x32_bf16 v[88:91], v[36:39], v[56:59], v[88:91]
    v_mfma_f32_16x16x32_bf16 v[104:107], v[40:43], v[56:59], v[104:107]
    v_mfma_f32_16x16x32_bf16 v[120:123], v[44:47], v[56:59], v[120:123]
    ds_read_b64_tr_b16 v[56:57], v7 offset:16384
    ds_read_b64_tr_b16 v[58:59], v7 offset:17408
    v_mfma_f32_16x16x32_bf16 v[76:79], v[32:35], v[60:63], v[76:79]
    v_mfma_f32_16x16x32_bf16 v[92:95], v[36:39], v[60:63], v[92:95]
    v_mfma_f32_16x16x32_bf16 v[108:111], v[40:43], v[60:63], v[108:111]
    v_mfma_f32_16x16x32_bf16 v[124:127], v[44:47], v[60:63], v[124:127]
    ds_read_b64_tr_b16 v[60:61], v8 offset:16384
    ds_read_b64_tr_b16 v[62:63], v8 offset:17408
    s_waitcnt lgkmcnt(6)
    v_mfma_f32_16x16x32_bf16 v[64:67], v[16:19], v[48:51], v[64:67]
    v_mfma_f32_16x16x32_bf16 v[80:83], v[20:23], v[48:51], v[80:83]
    v_mfma_f32_16x16x32_bf16 v[96:99], v[24:27], v[48:51], v[96:99]
    v_mfma_f32_16x16x32_bf16 v[112:115], v[28:31], v[48:51], v[112:115]
    s_waitcnt lgkmcnt(0)
    s_barrier
    ds_read_b64_tr_b16 v[48:49], v5 offset:24576
    ds_read_b64_tr_b16 v[50:51], v5 offset:25600
    v_mfma_f32_16x16x32_bf16 v[68:71], v[16:19], v[52:55], v[68:71]
    ds_read_b128 v[32:35], v4 offset:32768
    v_mfma_f32_16x16x32_bf16 v[84:87], v[20:23], v[52:55], v[84:87]
    ds_read_b128 v[36:39], v4 offset:34816
    v_mfma_f32_16x16x32_bf16 v[100:103], v[24:27], v[52:55], v[100:103]
    ds_read_b128 v[40:43], v4 offset:36864
    v_mfma_f32_16x16x32_bf16 v[116:119], v[28:31], v[52:55], v[116:119]
    ds_read_b128 v[44:47], v4 offset:38912
    ds_read_b64_tr_b16 v[52:53], v6 offset:24576
    ds_read_b64_tr_b16 v[54:55], v6 offset:25600
    v_mfma_f32_16x16x32_bf16 v[72:75], v[16:19], v[56:59], v[72:75]
    v_mfma_f32_16x16x32_bf16 v[88:91], v[20:23], v[56:59], v[88:91]
    v_mfma_f32_16x16x32_bf16 v[104:107], v[24:27], v[56:59], v[104:107]
    v_mfma_f32_16x16x32_bf16 v[120:123], v[28:31], v[56:59], v[120:123]
    ds_read_b64_tr_b16 v[56:57], v7 offset:24576
    ds_read_b64_tr_b16 v[58:59], v7 offset:25600
    v_mfma_f32_16x16x32_bf16 v[76:79], v[16:19], v[60:63], v[76:79]
    v_mfma_f32_16x16x32_bf16 v[92:95], v[20:23], v[60:63], v[92:95]
    v_mfma_f32_16x16x32_bf16 v[108:111], v[24:27], v[60:63], v[108:111]
    v_mfma_f32_16x16x32_bf16 v[124:127], v[28:31], v[60:63], v[124:127]
    ds_read_b64_tr_b16 v[60:61], v8 offset:24576
    ds_read_b64_tr_b16 v[62:63], v8 offset:25600
    s_waitcnt lgkmcnt(6)
    v_mfma_f32_16x16x32_bf16 v[64:67], v[32:35], v[48:51], v[64:67]
    v_mfma_f32_16x16x32_bf16 v[80:83], v[36:39], v[48:51], v[80:83]
    v_mfma_f32_16x16x32_bf16 v[96:99], v[40:43], v[48:51], v[96:99]
    v_mfma_f32_16x16x32_bf16 v[112:115], v[44:47], v[48:51], v[112:115]
    s_waitcnt lgkmcnt(0)
    s_barrier
    ds_read_b64_tr_b16 v[48:49], v5 offset:0
    ds_read_b64_tr_b16 v[50:51], v5 offset:1024
    v_mfma_f32_16x16x32_bf16 v[68:71], v[32:35], v[52:55], v[68:71]
    ds_read_b128 v[16:19], v3 offset:0
    v_mfma_f32_16x16x32_bf16 v[84:87], v[36:39], v[52:55], v[84:87]
    ds_read_b128 v[20:23], v3 offset:2048
    v_mfma_f32_16x16x32_bf16 v[100:103], v[40:43], v[52:55], v[100:103]
    ds_read_b128 v[24:27], v3 offset:4096
    v_mfma_f32_16x16x32_bf16 v[116:119], v[44:47], v[52:55], v[116:119]
    ds_read_b128 v[28:31], v3 offset:6144
    ds_read_b64_tr_b16 v[52:53], v6 offset:0
    ds_read_b64_tr_b16 v[54:55], v6 offset:1024
    v_mfma_f32_16x16x32_bf16 v[72:75], v[32:35], v[56:59], v[72:75]
    v_mfma_f32_16x16x32_bf16 v[88:91], v[36:39], v[56:59], v[88:91]
    v_mfma_f32_16x16x32_bf16 v[104:107], v[40:43], v[56:59], v[104:107]
    v_mfma_f32_16x16x32_bf16 v[120:123], v[44:47], v[56:59], v[120:123]
    ds_read_b64_tr_b16 v[56:57], v7 offset:0
    ds_read_b64_tr_b16 v[58:59], v7 offset:1024
    v_mfma_f32_16x16x32_bf16 v[76:79], v[32:35], v[60:63], v[76:79]
    v_mfma_f32_16x16x32_bf16 v[92:95], v[36:39], v[60:63], v[92:95]
    v_mfma_f32_16x16x32_bf16 v[108:111], v[40:43], v[60:63], v[108:111]
    v_mfma_f32_16x16x32_bf16 v[124:127], v[44:47], v[60:63], v[124:127]
    ds_read_b64_tr_b16 v[60:61], v8 offset:0
    ds_read_b64_tr_b16 v[62:63], v8 offset:1024
    s_waitcnt lgkmcnt(6)
    v_mfma_f32_16x16x32_bf16 v[64:67], v[16:19], v[48:51], v[64:67]
    v_mfma_f32_16x16x32_bf16 v[80:83], v[20:23], v[48:51], v[80:83]
    v_mfma_f32_16x16x32_bf16 v[96:99], v[24:27], v[48:51], v[96:99]
    v_mfma_f32_16x16x32_bf16 v[112:115], v[28:31], v[48:51], v[112:115]
    s_waitcnt lgkmcnt(0)
    s_barrier
    ds_read_b64_tr_b16 v[48:49], v5 offset:8192
    ds_read_b64_tr_b16 v[50:51], v5 offset:9216
    v_mfma_f32_16x16x32_bf16 v[68:71], v[16:19], v[52:55], v[68:71]
    ds_read_b128 v[32:35], v4 offset:0
    v_mfma_f32_16x16x32_bf16 v[84:87], v[20:23], v[52:55], v[84:87]
    ds_read_b128 v[36:39], v4 offset:2048
    v_mfma_f32_16x16x32_bf16 v[100:103], v[24:27], v[52:55], v[100:103]
    ds_read_b128 v[40:43], v4 offset:4096
    v_mfma_f32_16x16x32_bf16 v[116:119], v[28:31], v[52:55], v[116:119]
    ds_read_b128 v[44:47], v4 offset:6144
    ds_read_b64_tr_b16 v[52:53], v6 offset:8192
    ds_read_b64_tr_b16 v[54:55], v6 offset:9216
    v_mfma_f32_16x16x32_bf16 v[72:75], v[16:19], v[56:59], v[72:75]
    v_mfma_f32_16x16x32_bf16 v[88:91], v[20:23], v[56:59], v[88:91]
    v_mfma_f32_16x16x32_bf16 v[104:107], v[24:27], v[56:59], v[104:107]
    v_mfma_f32_16x16x32_bf16 v[120:123], v[28:31], v[56:59], v[120:123]
    ds_read_b64_tr_b16 v[56:57], v7 offset:8192
    ds_read_b64_tr_b16 v[58:59], v7 offset:9216
    v_mfma_f32_16x16x32_bf16 v[76:79], v[16:19], v[60:63], v[76:79]
    v_mfma_f32_16x16x32_bf16 v[92:95], v[20:23], v[60:63], v[92:95]
    v_mfma_f32_16x16x32_bf16 v[108:111], v[24:27], v[60:63], v[108:111]
    v_mfma_f32_16x16x32_bf16 v[124:127], v[28:31], v[60:63], v[124:127]
    ds_read_b64_tr_b16 v[60:61], v8 offset:8192
    ds_read_b64_tr_b16 v[62:63], v8 offset:9216
    s_waitcnt lgkmcnt(6)
    v_mfma_f32_16x16x32_bf16 v[64:67], v[32:35], v[48:51], v[64:67]
    v_mfma_f32_16x16x32_bf16 v[80:83], v[36:39], v[48:51], v[80:83]
    v_mfma_f32_16x16x32_bf16 v[96:99], v[40:43], v[48:51], v[96:99]
    v_mfma_f32_16x16x32_bf16 v[112:115], v[44:47], v[48:51], v[112:115]
    s_waitcnt lgkmcnt(0)
    s_barrier
    ds_read_b64_tr_b16 v[48:49], v5 offset:16384
    ds_read_b64_tr_b16 v[50:51], v5 offset:17408
    v_mfma_f32_16x16x32_bf16 v[68:71], v[32:35], v[52:55], v[68:71]
    ds_read_b128 v[16:19], v3 offset:16384
    v_mfma_f32_16x16x32_bf16 v[84:87], v[36:39], v[52:55], v[84:87]
    ds_read_b128 v[20:23], v3 offset:18432
    v_mfma_f32_16x16x32_bf16 v[100:103], v[40:43], v[52:55], v[100:103]
    ds_read_b128 v[24:27], v3 offset:20480
    v_mfma_f32_16x16x32_bf16 v[116:119], v[44:47], v[52:55], v[116:119]
    ds_read_b128 v[28:31], v3 offset:22528
    ds_read_b64_tr_b16 v[52:53], v6 offset:16384
    ds_read_b64_tr_b16 v[54:55], v6 offset:17408
    v_mfma_f32_16x16x32_bf16 v[72:75], v[32:35], v[56:59], v[72:75]
    v_mfma_f32_16x16x32_bf16 v[88:91], v[36:39], v[56:59], v[88:91]
    v_mfma_f32_16x16x32_bf16 v[104:107], v[40:43], v[56:59], v[104:107]
    v_mfma_f32_16x16x32_bf16 v[120:123], v[44:47], v[56:59], v[120:123]
    ds_read_b64_tr_b16 v[56:57], v7 offset:16384
    ds_read_b64_tr_b16 v[58:59], v7 offset:17408
    v_mfma_f32_16x16x32_bf16 v[76:79], v[32:35], v[60:63], v[76:79]
    v_mfma_f32_16x16x32_bf16 v[92:95], v[36:39], v[60:63], v[92:95]
    v_mfma_f32_16x16x32_bf16 v[108:111], v[40:43], v[60:63], v[108:111]
    v_mfma_f32_16x16x32_bf16 v[124:127], v[44:47], v[60:63], v[124:127]
    ds_read_b64_tr_b16 v[60:61], v8 offset:16384
    ds_read_b64_tr_b16 v[62:63], v8 offset:17408
    s_waitcnt lgkmcnt(6)
    v_mfma_f32_16x16x32_bf16 v[64:67], v[16:19], v[48:51], v[64:67]
    v_mfma_f32_16x16x32_bf16 v[80:83], v[20:23], v[48:51], v[80:83]
    v_mfma_f32_16x16x32_bf16 v[96:99], v[24:27], v[48:51], v[96:99]
    v_mfma_f32_16x16x32_bf16 v[112:115], v[28:31], v[48:51], v[112:115]
    s_waitcnt lgkmcnt(0)
    s_barrier
    ds_read_b64_tr_b16 v[48:49], v5 offset:24576
    ds_read_b64_tr_b16 v[50:51], v5 offset:25600
    v_mfma_f32_16x16x32_bf16 v[68:71], v[16:19], v[52:55], v[68:71]
    ds_read_b128 v[32:35], v4 offset:16384
    v_mfma_f32_16x16x32_bf16 v[84:87], v[20:23], v[52:55], v[84:87]
    ds_read_b128 v[36:39], v4 offset:18432
    v_mfma_f32_16x16x32_bf16 v[100:103], v[24:27], v[52:55], v[100:103]
    ds_read_b128 v[40:43], v4 offset:20480
    v_mfma_f32_16x16x32_bf16 v[116:119], v[28:31], v[52:55], v[116:119]
    ds_read_b128 v[44:47], v4 offset:22528
    ds_read_b64_tr_b16 v[52:53], v6 offset:24576
    ds_read_b64_tr_b16 v[54:55], v6 offset:25600
    v_mfma_f32_16x16x32_bf16 v[72:75], v[16:19], v[56:59], v[72:75]
    v_mfma_f32_16x16x32_bf16 v[88:91], v[20:23], v[56:59], v[88:91]
    v_mfma_f32_16x16x32_bf16 v[104:107], v[24:27], v[56:59], v[104:107]
    v_mfma_f32_16x16x32_bf16 v[120:123], v[28:31], v[56:59], v[120:123]
    ds_read_b64_tr_b16 v[56:57], v7 offset:24576
    ds_read_b64_tr_b16 v[58:59], v7 offset:25600
    v_mfma_f32_16x16x32_bf16 v[76:79], v[16:19], v[60:63], v[76:79]
    v_mfma_f32_16x16x32_bf16 v[92:95], v[20:23], v[60:63], v[92:95]
    v_mfma_f32_16x16x32_bf16 v[108:111], v[24:27], v[60:63], v[108:111]
    v_mfma_f32_16x16x32_bf16 v[124:127], v[28:31], v[60:63], v[124:127]
    ds_read_b64_tr_b16 v[60:61], v8 offset:24576
    ds_read_b64_tr_b16 v[62:63], v8 offset:25600
    s_waitcnt lgkmcnt(6)
    v_mfma_f32_16x16x32_bf16 v[64:67], v[32:35], v[48:51], v[64:67]
    v_mfma_f32_16x16x32_bf16 v[80:83], v[36:39], v[48:51], v[80:83]
    v_mfma_f32_16x16x32_bf16 v[96:99], v[40:43], v[48:51], v[96:99]
    v_mfma_f32_16x16x32_bf16 v[112:115], v[44:47], v[48:51], v[112:115]
    s_waitcnt lgkmcnt(0)
    s_barrier
    ds_read_b64_tr_b16 v[48:49], v5 offset:0
    ds_read_b64_tr_b16 v[50:51], v5 offset:1024
    v_mfma_f32_16x16x32_bf16 v[68:71], v[32:35], v[52:55], v[68:71]
    ds_read_b128 v[16:19], v3 offset:32768
    v_mfma_f32_16x16x32_bf16 v[84:87], v[36:39], v[52:55], v[84:87]
    ds_read_b128 v[20:23], v3 offset:34816
    v_mfma_f32_16x16x32_bf16 v[100:103], v[40:43], v[52:55], v[100:103]
    ds_read_b128 v[24:27], v3 offset:36864
    v_mfma_f32_16x16x32_bf16 v[116:119], v[44:47], v[52:55], v[116:119]
    ds_read_b128 v[28:31], v3 offset:38912
    ds_read_b64_tr_b16 v[52:53], v6 offset:0
    ds_read_b64_tr_b16 v[54:55], v6 offset:1024
    v_mfma_f32_16x16x32_bf16 v[72:75], v[32:35], v[56:59], v[72:75]
    v_mfma_f32_16x16x32_bf16 v[88:91], v[36:39], v[56:59], v[88:91]
    v_mfma_f32_16x16x32_bf16 v[104:107], v[40:43], v[56:59], v[104:107]
    v_mfma_f32_16x16x32_bf16 v[120:123], v[44:47], v[56:59], v[120:123]
    ds_read_b64_tr_b16 v[56:57], v7 offset:0
    ds_read_b64_tr_b16 v[58:59], v7 offset:1024
    v_mfma_f32_16x16x32_bf16 v[76:79], v[32:35], v[60:63], v[76:79]
    v_mfma_f32_16x16x32_bf16 v[92:95], v[36:39], v[60:63], v[92:95]
    v_mfma_f32_16x16x32_bf16 v[108:111], v[40:43], v[60:63], v[108:111]
    v_mfma_f32_16x16x32_bf16 v[124:127], v[44:47], v[60:63], v[124:127]
    ds_read_b64_tr_b16 v[60:61], v8 offset:0
    ds_read_b64_tr_b16 v[62:63], v8 offset:1024
    s_waitcnt lgkmcnt(6)
    v_mfma_f32_16x16x32_bf16 v[64:67], v[16:19], v[48:51], v[64:67]
    v_mfma_f32_16x16x32_bf16 v[80:83], v[20:23], v[48:51], v[80:83]
    v_mfma_f32_16x16x32_bf16 v[96:99], v[24:27], v[48:51], v[96:99]
    v_mfma_f32_16x16x32_bf16 v[112:115], v[28:31], v[48:51], v[112:115]
    s_waitcnt lgkmcnt(0)
    s_barrier
    ds_read_b64_tr_b16 v[48:49], v5 offset:8192
    ds_read_b64_tr_b16 v[50:51], v5 offset:9216
    v_mfma_f32_16x16x32_bf16 v[68:71], v[16:19], v[52:55], v[68:71]
    ds_read_b128 v[32:35], v4 offset:32768
    v_mfma_f32_16x16x32_bf16 v[84:87], v[20:23], v[52:55], v[84:87]
    ds_read_b128 v[36:39], v4 offset:34816
    v_mfma_f32_16x16x32_bf16 v[100:103], v[24:27], v[52:55], v[100:103]
    ds_read_b128 v[40:43], v4 offset:36864
    v_mfma_f32_16x16x32_bf16 v[116:119], v[28:31], v[52:55], v[116:119]
    ds_read_b128 v[44:47], v4 offset:38912
    ds_read_b64_tr_b16 v[52:53], v6 offset:8192
    ds_read_b64_tr_b16 v[54:55], v6 offset:9216
    v_mfma_f32_16x16x32_bf16 v[72:75], v[16:19], v[56:59], v[72:75]
    v_mfma_f32_16x16x32_bf16 v[88:91], v[20:23], v[56:59], v[88:91]
    v_mfma_f32_16x16x32_bf16 v[104:107], v[24:27], v[56:59], v[104:107]
    v_mfma_f32_16x16x32_bf16 v[120:123], v[28:31], v[56:59], v[120:123]
    ds_read_b64_tr_b16 v[56:57], v7 offset:8192
    ds_read_b64_tr_b16 v[58:59], v7 offset:9216
    v_mfma_f32_16x16x32_bf16 v[76:79], v[16:19], v[60:63], v[76:79]
    v_mfma_f32_16x16x32_bf16 v[92:95], v[20:23], v[60:63], v[92:95]
    v_mfma_f32_16x16x32_bf16 v[108:111], v[24:27], v[60:63], v[108:111]
    v_mfma_f32_16x16x32_bf16 v[124:127], v[28:31], v[60:63], v[124:127]
    ds_read_b64_tr_b16 v[60:61], v8 offset:8192
    ds_read_b64_tr_b16 v[62:63], v8 offset:9216
    s_waitcnt lgkmcnt(6)
    v_mfma_f32_16x16x32_bf16 v[64:67], v[32:35], v[48:51], v[64:67]
    v_mfma_f32_16x16x32_bf16 v[80:83], v[36:39], v[48:51], v[80:83]
    v_mfma_f32_16x16x32_bf16 v[96:99], v[40:43], v[48:51], v[96:99]
    v_mfma_f32_16x16x32_bf16 v[112:115], v[44:47], v[48:51], v[112:115]
    s_waitcnt lgkmcnt(0)
    s_barrier
    ds_read_b64_tr_b16 v[48:49], v5 offset:16384
    ds_read_b64_tr_b16 v[50:51], v5 offset:17408
    v_mfma_f32_16x16x32_bf16 v[68:71], v[32:35], v[52:55], v[68:71]
    ds_read_b128 v[16:19], v3 offset:0
    v_mfma_f32_16x16x32_bf16 v[84:87], v[36:39], v[52:55], v[84:87]
    ds_read_b128 v[20:23], v3 offset:2048
    v_mfma_f32_16x16x32_bf16 v[100:103], v[40:43], v[52:55], v[100:103]
    ds_read_b128 v[24:27], v3 offset:4096
    v_mfma_f32_16x16x32_bf16 v[116:119], v[44:47], v[52:55], v[116:119]
    ds_read_b128 v[28:31], v3 offset:6144
    ds_read_b64_tr_b16 v[52:53], v6 offset:16384
    ds_read_b64_tr_b16 v[54:55], v6 offset:17408
    v_mfma_f32_16x16x32_bf16 v[72:75], v[32:35], v[56:59], v[72:75]
    v_mfma_f32_16x16x32_bf16 v[88:91], v[36:39], v[56:59], v[88:91]
    v_mfma_f32_16x16x32_bf16 v[104:107], v[40:43], v[56:59], v[104:107]
    v_mfma_f32_16x16x32_bf16 v[120:123], v[44:47], v[56:59], v[120:123]
    ds_read_b64_tr_b16 v[56:57], v7 offset:16384
    ds_read_b64_tr_b16 v[58:59], v7 offset:17408
    v_mfma_f32_16x16x32_bf16 v[76:79], v[32:35], v[60:63], v[76:79]
    v_mfma_f32_16x16x32_bf16 v[92:95], v[36:39], v[60:63], v[92:95]
    v_mfma_f32_16x16x32_bf16 v[108:111], v[40:43], v[60:63], v[108:111]
    v_mfma_f32_16x16x32_bf16 v[124:127], v[44:47], v[60:63], v[124:127]
    ds_read_b64_tr_b16 v[60:61], v8 offset:16384
    ds_read_b64_tr_b16 v[62:63], v8 offset:17408
    s_waitcnt lgkmcnt(6)
    v_mfma_f32_16x16x32_bf16 v[64:67], v[16:19], v[48:51], v[64:67]
    v_mfma_f32_16x16x32_bf16 v[80:83], v[20:23], v[48:51], v[80:83]
    v_mfma_f32_16x16x32_bf16 v[96:99], v[24:27], v[48:51], v[96:99]
    v_mfma_f32_16x16x32_bf16 v[112:115], v[28:31], v[48:51], v[112:115]
    s_waitcnt lgkmcnt(0)
    s_barrier
    ds_read_b64_tr_b16 v[48:49], v5 offset:24576
    ds_read_b64_tr_b16 v[50:51], v5 offset:25600
    v_mfma_f32_16x16x32_bf16 v[68:71], v[16:19], v[52:55], v[68:71]
    ds_read_b128 v[32:35], v4 offset:0
    v_mfma_f32_16x16x32_bf16 v[84:87], v[20:23], v[52:55], v[84:87]
    ds_read_b128 v[36:39], v4 offset:2048
    v_mfma_f32_16x16x32_bf16 v[100:103], v[24:27], v[52:55], v[100:103]
    ds_read_b128 v[40:43], v4 offset:4096
    v_mfma_f32_16x16x32_bf16 v[116:119], v[28:31], v[52:55], v[116:119]
    ds_read_b128 v[44:47], v4 offset:6144
    ds_read_b64_tr_b16 v[52:53], v6 offset:24576
    ds_read_b64_tr_b16 v[54:55], v6 offset:25600
    v_mfma_f32_16x16x32_bf16 v[72:75], v[16:19], v[56:59], v[72:75]
    v_mfma_f32_16x16x32_bf16 v[88:91], v[20:23], v[56:59], v[88:91]
    v_mfma_f32_16x16x32_bf16 v[104:107], v[24:27], v[56:59], v[104:107]
    v_mfma_f32_16x16x32_bf16 v[120:123], v[28:31], v[56:59], v[120:123]
    ds_read_b64_tr_b16 v[56:57], v7 offset:24576
    ds_read_b64_tr_b16 v[58:59], v7 offset:25600
    v_mfma_f32_16x16x32_bf16 v[76:79], v[16:19], v[60:63], v[76:79]
    v_mfma_f32_16x16x32_bf16 v[92:95], v[20:23], v[60:63], v[92:95]
    v_mfma_f32_16x16x32_bf16 v[108:111], v[24:27], v[60:63], v[108:111]
    v_mfma_f32_16x16x32_bf16 v[124:127], v[28:31], v[60:63], v[124:127]
    ds_read_b64_tr_b16 v[60:61], v8 offset:24576
    ds_read_b64_tr_b16 v[62:63], v8 offset:25600
    s_waitcnt lgkmcnt(0)
    v_mfma_f32_16x16x32_bf16 v[64:67], v[32:35], v[48:51], v[64:67]
    v_mfma_f32_16x16x32_bf16 v[68:71], v[32:35], v[52:55], v[68:71]
    v_mfma_f32_16x16x32_bf16 v[72:75], v[32:35], v[56:59], v[72:75]
    v_mfma_f32_16x16x32_bf16 v[76:79], v[32:35], v[60:63], v[76:79]
    v_mfma_f32_16x16x32_bf16 v[80:83], v[36:39], v[48:51], v[80:83]
    v_mfma_f32_16x16x32_bf16 v[84:87], v[36:39], v[52:55], v[84:87]
    v_mfma_f32_16x16x32_bf16 v[88:91], v[36:39], v[56:59], v[88:91]
    v_mfma_f32_16x16x32_bf16 v[92:95], v[36:39], v[60:63], v[92:95]
    v_mfma_f32_16x16x32_bf16 v[96:99], v[40:43], v[48:51], v[96:99]
    v_cvt_pk_bf16_f32 v16, v64, v65
    v_cvt_pk_bf16_f32 v17, v66, v67
    v_cvt_pk_bf16_f32 v18, v68, v69
    v_cvt_pk_bf16_f32 v19, v70, v71
    v_mfma_f32_16x16x32_bf16 v[100:103], v[40:43], v[52:55], v[100:103]
    v_cvt_pk_bf16_f32 v20, v72, v73
    v_cvt_pk_bf16_f32 v21, v74, v75
    v_cvt_pk_bf16_f32 v22, v76, v77
    v_cvt_pk_bf16_f32 v23, v78, v79
    v_mfma_f32_16x16x32_bf16 v[104:107], v[40:43], v[56:59], v[104:107]
    v_permlane32_swap_b32 v16, v18
    v_permlane32_swap_b32 v17, v19
    v_permlane32_swap_b32 v20, v22
    v_permlane32_swap_b32 v21, v23
    v_mfma_f32_16x16x32_bf16 v[108:111], v[40:43], v[60:63], v[108:111]
    buffer_store_dwordx4 v[16:19], v9, s[36:39], s55 offen offset:1024 sc1
    buffer_store_dwordx4 v[20:23], v11, s[36:39], s55 offen offset:1024 sc1
    v_mfma_f32_16x16x32_bf16 v[112:115], v[44:47], v[48:51], v[112:115]
    v_cvt_pk_bf16_f32 v24, v80, v81
    v_cvt_pk_bf16_f32 v25, v82, v83
    v_cvt_pk_bf16_f32 v26, v84, v85
    v_cvt_pk_bf16_f32 v27, v86, v87
    v_mfma_f32_16x16x32_bf16 v[116:119], v[44:47], v[52:55], v[116:119]
    v_cvt_pk_bf16_f32 v28, v88, v89
    v_cvt_pk_bf16_f32 v29, v90, v91
    v_cvt_pk_bf16_f32 v30, v92, v93
    v_cvt_pk_bf16_f32 v31, v94, v95
    v_mfma_f32_16x16x32_bf16 v[120:123], v[44:47], v[56:59], v[120:123]
    v_permlane32_swap_b32 v24, v26
    v_permlane32_swap_b32 v25, v27
    v_permlane32_swap_b32 v28, v30
    v_permlane32_swap_b32 v29, v31
    v_mfma_f32_16x16x32_bf16 v[124:127], v[44:47], v[60:63], v[124:127]
    buffer_store_dwordx4 v[24:27], v10, s[36:39], s55 offen offset:1024 sc1
    buffer_store_dwordx4 v[28:31], v12, s[36:39], s55 offen offset:1024 sc1
    v_cvt_pk_bf16_f32 v64, v96, v97
    v_cvt_pk_bf16_f32 v65, v98, v99
    v_cvt_pk_bf16_f32 v66, v100, v101
    v_cvt_pk_bf16_f32 v67, v102, v103
    v_cvt_pk_bf16_f32 v68, v104, v105
    v_cvt_pk_bf16_f32 v69, v106, v107
    v_cvt_pk_bf16_f32 v70, v108, v109
    v_cvt_pk_bf16_f32 v71, v110, v111
    v_permlane32_swap_b32 v64, v66
    v_permlane32_swap_b32 v65, v67
    v_permlane32_swap_b32 v68, v70
    v_permlane32_swap_b32 v69, v71
    buffer_store_dwordx4 v[64:67], v9, s[36:39], s56 offen offset:1024 sc1
    buffer_store_dwordx4 v[68:71], v11, s[36:39], s56 offen offset:1024 sc1
    v_cvt_pk_bf16_f32 v72, v112, v113
    v_cvt_pk_bf16_f32 v73, v114, v115
    v_cvt_pk_bf16_f32 v74, v116, v117
    v_cvt_pk_bf16_f32 v75, v118, v119
    v_cvt_pk_bf16_f32 v76, v120, v121
    v_cvt_pk_bf16_f32 v77, v122, v123
    v_cvt_pk_bf16_f32 v78, v124, v125
    v_cvt_pk_bf16_f32 v79, v126, v127
    v_permlane32_swap_b32 v72, v74
    v_permlane32_swap_b32 v73, v75
    v_permlane32_swap_b32 v76, v78
    v_permlane32_swap_b32 v77, v79
    buffer_store_dwordx4 v[72:75], v10, s[36:39], s56 offen offset:1024 sc1
    buffer_store_dwordx4 v[76:79], v12, s[36:39], s56 offen offset:1024 sc1
    s_branch Lq_done
Lq_misc:
    s_waitcnt lgkmcnt(0)
    s_add_u32 s76, s24, 9502720
    s_addc_u32 s77, s25, 0
    s_mov_b32 s78, 65536
    s_mov_b32 s79, 0x00020000
    s_mov_b32 s84, s22
    s_mov_b32 s85, s23
    s_mov_b32 s86, 256
    s_mov_b32 s87, 0x00020000
    s_cmp_lg_u32 s2, 240
    s_cbranch_scc1 Lq_m1
    s_cmp_lg_u32 s26, 7
    s_cbranch_scc1 Lq_m1
    v_mov_b32 v3, 0
    v_lshlrev_b32 v4, 8, v2
    buffer_store_dword v3, v4, s[76:79], 0 offen sc1
    v_mov_b32 v5, 1
    s_movk_i32 s63, 16384
    buffer_store_dword v3, v4, s[76:79], s63 offen sc1
    s_waitcnt vmcnt(0)
    s_mov_b64 exec, 1
    buffer_atomic_add v5, v3, s[84:87], 0 offen sc1
    s_mov_b64 exec, -1
Lq_m1:
    s_sub_u32 s46, s2, 240
    s_cmp_ge_u32 s46, 8
    s_cselect_b32 s36, s14, s12
    s_cselect_b32 s37, s15, s13
    s_mov_b32 s38, 2211840
    s_mov_b32 s39, 0x00020000
    s_and_b32 s49, s46, 7
    s_mul_i32 s49, s49, 41472
    v_lshlrev_b32 v120, 7, v0
    v_cmp_gt_u32 vcc, 324, v0
    v_mov_b32 v121, 0x7ff00000
    s_nop 0
    v_cndmask_b32 v120, v121, v120, vcc
    buffer_load_dword v122, v120, s[36:39], s49 offen
    s_mov_b32 s28, s4
    s_mov_b32 s29, s5
    s_mov_b32 s30, 2621440
    s_mov_b32 s31, 0x00020000
    s_mov_b32 s32, s18
    s_mov_b32 s33, s19
    s_mov_b32 s34, 1280
    s_mov_b32 s35, 0x00020000
    s_add_u32 s40, s24, 9437184
    s_addc_u32 s41, s25, 0
    s_mov_b32 s42, 8192
    s_mov_b32 s43, 0x00020000
    v_and_b32 v3, 15, v2
    v_lshrrev_b32 v4, 4, v2
    v_lshlrev_b32 v5, 4, v3
    buffer_load_dwordx4 v[8:11], v5, s[32:35], 0 offen offset:0
    buffer_load_dwordx4 v[12:15], v5, s[32:35], 0 offen offset:256
    buffer_load_dwordx4 v[16:19], v5, s[32:35], 0 offen offset:512
    buffer_load_dwordx4 v[20:23], v5, s[32:35], 0 offen offset:768
    buffer_load_dwordx4 v[24:27], v5, s[32:35], 0 offen offset:1024
    s_sub_u32 s46, s2, 240
    s_lshl_b32 s49, s46, 7
    s_lshl_b32 s50, s26, 4
    s_add_u32 s49, s49, s50
    v_add_u32 v6, s49, v4
    v_lshlrev_b32 v7, 2, v6
    v_mul_u32_u24 v6, 1280, v6
    v_add_u32 v6, v6, v5
    s_mov_b32 s50, 0
    buffer_load_dwordx4 v[32:35], v6, s[28:31], s50 offen offset:0
    buffer_load_dwordx4 v[36:39], v6, s[28:31], s50 offen offset:256
    buffer_load_dwordx4 v[40:43], v6, s[28:31], s50 offen offset:512
    buffer_load_dwordx4 v[44:47], v6, s[28:31], s50 offen offset:768
    buffer_load_dwordx4 v[48:51], v6, s[28:31], s50 offen offset:1024
    s_mov_b32 s50, 5120
    buffer_load_dwordx4 v[52:55], v6, s[28:31], s50 offen offset:0
    buffer_load_dwordx4 v[56:59], v6, s[28:31], s50 offen offset:256
    buffer_load_dwordx4 v[60:63], v6, s[28:31], s50 offen offset:512
    buffer_load_dwordx4 v[64:67], v6, s[28:31], s50 offen offset:768
    buffer_load_dwordx4 v[68:71], v6, s[28:31], s50 offen offset:1024
    s_mov_b32 s50, 10240
    buffer_load_dwordx4 v[72:75], v6, s[28:31], s50 offen offset:0
    buffer_load_dwordx4 v[76:79], v6, s[28:31], s50 offen offset:256
    buffer_load_dwordx4 v[80:83], v6, s[28:31], s50 offen offset:512
    buffer_load_dwordx4 v[84:87], v6, s[28:31], s50 offen offset:768
    buffer_load_dwordx4 v[88:91], v6, s[28:31], s50 offen offset:1024
    s_mov_b32 s50, 15360
    buffer_load_dwordx4 v[92:95], v6, s[28:31], s50 offen offset:0
    buffer_load_dwordx4 v[96:99], v6, s[28:31], s50 offen offset:256
    buffer_load_dwordx4 v[100:103], v6, s[28:31], s50 offen offset:512
    buffer_load_dwordx4 v[104:107], v6, s[28:31], s50 offen offset:768
    buffer_load_dwordx4 v[108:111], v6, s[28:31], s50 offen offset:1024
    s_waitcnt vmcnt(15)
    v_mov_b32 v112, 0
    v_dot2c_f32_bf16 v112, v32, v8
    v_dot2c_f32_bf16 v112, v33, v9
    v_dot2c_f32_bf16 v112, v34, v10
    v_dot2c_f32_bf16 v112, v35, v11
    v_dot2c_f32_bf16 v112, v36, v12
    v_dot2c_f32_bf16 v112, v37, v13
    v_dot2c_f32_bf16 v112, v38, v14
    v_dot2c_f32_bf16 v112, v39, v15
    v_dot2c_f32_bf16 v112, v40, v16
    v_dot2c_f32_bf16 v112, v41, v17
    v_dot2c_f32_bf16 v112, v42, v18
    v_dot2c_f32_bf16 v112, v43, v19
    v_dot2c_f32_bf16 v112, v44, v20
    v_dot2c_f32_bf16 v112, v45, v21
    v_dot2c_f32_bf16 v112, v46, v22
    v_dot2c_f32_bf16 v112, v47, v23
    v_dot2c_f32_bf16 v112, v48, v24
    v_dot2c_f32_bf16 v112, v49, v25
    v_dot2c_f32_bf16 v112, v50, v26
    v_dot2c_f32_bf16 v112, v51, v27
    s_waitcnt vmcnt(10)
    v_mov_b32 v113, 0
    v_dot2c_f32_bf16 v113, v52, v8
    v_dot2c_f32_bf16 v113, v53, v9
    v_dot2c_f32_bf16 v113, v54, v10
    v_dot2c_f32_bf16 v113, v55, v11
    v_dot2c_f32_bf16 v113, v56, v12
    v_dot2c_f32_bf16 v113, v57, v13
    v_dot2c_f32_bf16 v113, v58, v14
    v_dot2c_f32_bf16 v113, v59, v15
    v_dot2c_f32_bf16 v113, v60, v16
    v_dot2c_f32_bf16 v113, v61, v17
    v_dot2c_f32_bf16 v113, v62, v18
    v_dot2c_f32_bf16 v113, v63, v19
    v_dot2c_f32_bf16 v113, v64, v20
    v_dot2c_f32_bf16 v113, v65, v21
    v_dot2c_f32_bf16 v113, v66, v22
    v_dot2c_f32_bf16 v113, v67, v23
    v_dot2c_f32_bf16 v113, v68, v24
    v_dot2c_f32_bf16 v113, v69, v25
    v_dot2c_f32_bf16 v113, v70, v26
    v_dot2c_f32_bf16 v113, v71, v27
    s_waitcnt vmcnt(5)
    v_mov_b32 v114, 0
    v_dot2c_f32_bf16 v114, v72, v8
    v_dot2c_f32_bf16 v114, v73, v9
    v_dot2c_f32_bf16 v114, v74, v10
    v_dot2c_f32_bf16 v114, v75, v11
    v_dot2c_f32_bf16 v114, v76, v12
    v_dot2c_f32_bf16 v114, v77, v13
    v_dot2c_f32_bf16 v114, v78, v14
    v_dot2c_f32_bf16 v114, v79, v15
    v_dot2c_f32_bf16 v114, v80, v16
    v_dot2c_f32_bf16 v114, v81, v17
    v_dot2c_f32_bf16 v114, v82, v18
    v_dot2c_f32_bf16 v114, v83, v19
    v_dot2c_f32_bf16 v114, v84, v20
    v_dot2c_f32_bf16 v114, v85, v21
    v_dot2c_f32_bf16 v114, v86, v22
    v_dot2c_f32_bf16 v114, v87, v23
    v_dot2c_f32_bf16 v114, v88, v24
    v_dot2c_f32_bf16 v114, v89, v25
    v_dot2c_f32_bf16 v114, v90, v26
    v_dot2c_f32_bf16 v114, v91, v27
    s_waitcnt vmcnt(0)
    v_mov_b32 v115, 0
    v_dot2c_f32_bf16 v115, v92, v8
    v_dot2c_f32_bf16 v115, v93, v9
    v_dot2c_f32_bf16 v115, v94, v10
    v_dot2c_f32_bf16 v115, v95, v11
    v_dot2c_f32_bf16 v115, v96, v12
    v_dot2c_f32_bf16 v115, v97, v13
    v_dot2c_f32_bf16 v115, v98, v14
    v_dot2c_f32_bf16 v115, v99, v15
    v_dot2c_f32_bf16 v115, v100, v16
    v_dot2c_f32_bf16 v115, v101, v17
    v_dot2c_f32_bf16 v115, v102, v18
    v_dot2c_f32_bf16 v115, v103, v19
    v_dot2c_f32_bf16 v115, v104, v20
    v_dot2c_f32_bf16 v115, v105, v21
    v_dot2c_f32_bf16 v115, v106, v22
    v_dot2c_f32_bf16 v115, v107, v23
    v_dot2c_f32_bf16 v115, v108, v24
    v_dot2c_f32_bf16 v115, v109, v25
    v_dot2c_f32_bf16 v115, v110, v26
    v_dot2c_f32_bf16 v115, v111, v27
    s_nop 2
    v_add_f32 v112, v112, v112 row_ror:8 row_mask:0xf bank_mask:0xf
    v_add_f32 v113, v113, v113 row_ror:8 row_mask:0xf bank_mask:0xf
    v_add_f32 v114, v114, v114 row_ror:8 row_mask:0xf bank_mask:0xf
    v_add_f32 v115, v115, v115 row_ror:8 row_mask:0xf bank_mask:0xf
    v_add_f32 v112, v112, v112 row_ror:4 row_mask:0xf bank_mask:0xf
    v_add_f32 v113, v113, v113 row_ror:4 row_mask:0xf bank_mask:0xf
    v_add_f32 v114, v114, v114 row_ror:4 row_mask:0xf bank_mask:0xf
    v_add_f32 v115, v115, v115 row_ror:4 row_mask:0xf bank_mask:0xf
    v_add_f32 v112, v112, v112 row_ror:2 row_mask:0xf bank_mask:0xf
    v_add_f32 v113, v113, v113 row_ror:2 row_mask:0xf bank_mask:0xf
    v_add_f32 v114, v114, v114 row_ror:2 row_mask:0xf bank_mask:0xf
    v_add_f32 v115, v115, v115 row_ror:2 row_mask:0xf bank_mask:0xf
    v_add_f32 v112, v112, v112 row_ror:1 row_mask:0xf bank_mask:0xf
    v_add_f32 v113, v113, v113 row_ror:1 row_mask:0xf bank_mask:0xf
    v_add_f32 v114, v114, v114 row_ror:1 row_mask:0xf bank_mask:0xf
    v_add_f32 v115, v115, v115 row_ror:1 row_mask:0xf bank_mask:0xf
    v_mul_f32 v112, 0xbfb8aa3b, v112
    v_mul_f32 v113, 0xbfb8aa3b, v113
    v_mul_f32 v114, 0xbfb8aa3b, v114
    v_mul_f32 v115, 0xbfb8aa3b, v115
    v_exp_f32 v112, v112
    v_exp_f32 v113, v113
    v_exp_f32 v114, v114
    v_exp_f32 v115, v115
    v_add_f32 v112, 1.0, v112
    v_add_f32 v113, 1.0, v113
    v_add_f32 v114, 1.0, v114
    v_add_f32 v115, 1.0, v115
    v_rcp_f32 v112, v112
    v_rcp_f32 v113, v113
    v_rcp_f32 v114, v114
    v_rcp_f32 v115, v115
    buffer_store_dword v112, v7, s[40:43], 0 offen offset:0 sc1
    buffer_store_dword v113, v7, s[40:43], 0 offen offset:16 sc1
    buffer_store_dword v114, v7, s[40:43], 0 offen offset:32 sc1
    buffer_store_dword v115, v7, s[40:43], 0 offen offset:48 sc1
    s_movk_i32 s64, 8192
    s_mov_b64 s[98:99], 0xffff
    s_branch Lq_d2
Lq_done:
    s_mul_i32 s64, s45, 52429
    s_lshr_b32 s64, s64, 18
    s_mul_i32 s65, s45, 3
    s_add_u32 s64, s64, s65
    s_add_u32 s64, s64, 48
    s_lshl_b32 s64, s64, 8
    s_mov_b64 s[98:99], 15
Lq_d2:
    s_and_b32 s46, s2, 7
    s_lshl_b32 s46, s46, 2
    s_bfe_u32 s47, s2, 0x20003
    s_add_u32 s44, s46, s47
    s_lshr_b32 s45, s2, 5
    s_and_b32 s65, s44, 1
    s_and_b32 s53, s26, 3
    s_lshl_b32 s53, s53, 1
    s_lshl_b32 s46, s45, 3
    s_add_u32 s53, s53, s46
    v_and_b32 v3, 31, v2
    v_lshrrev_b32 v4, 5, v2
    v_lshlrev_b32 v5, 4, v2
    s_mul_i32 s48, s26, 3072
    s_mul_i32 s49, s26, 5120
    s_mul_i32 s46, s65, 2304
    s_add_u32 s49, s49, s46
    s_lshr_b32 s47, s44, 1
    s_mul_i32 s46, s47, 327680
    s_mul_i32 s47, s47, 163840
    s_add_u32 s28, s24, s46
    s_addc_u32 s29, s25, 0
    s_mov_b32 s30, 327680
    s_mov_b32 s31, 0x00020000
    s_add_u32 s32, s24, s47
    s_addc_u32 s33, s25, 0
    s_add_u32 s32, s32, 6291456
    s_addc_u32 s33, s33, 0
    s_mov_b32 s34, 163840
    s_mov_b32 s35, 0x00020000
    s_mov_b32 s54, -1
    s_mov_b32 s55, 0
    s_mov_b32 s60, 0xfffff
    s_mov_b32 s61, 0xfffff
    s_cmp_lg_u32 s26, 4
    s_cbranch_scc1 La_s1_r
    s_mov_b32 s62, 0
    v_mov_b32 v7, 0
La_s1_p:
    buffer_load_dword v1, v7, s[84:87], 0 offen sc1
    s_waitcnt vmcnt(0)
    v_readfirstlane_b32 s63, v1
    s_add_u32 s62, s62, 1
    s_cmp_lg_u32 s63, 0
    s_cbranch_scc1 La_s1_r
    s_sleep 1
    s_cmp_lt_u32 s62, 0x200000
    s_cbranch_scc1 La_s1_p
La_s1_r:
    s_waitcnt vmcnt(0)
    s_barrier
    s_cmp_lg_u32 s26, 0
    s_cbranch_scc1 La_s1
    v_mov_b32 v1, 1
    v_lshlrev_b32 v7, 8, v2
    s_mov_b64 exec, s[98:99]
    buffer_atomic_add v1, v7, s[76:79], s64 offen sc1
    s_mov_b64 exec, -1
La_s1:
    v_and_b32 v7, 3, v2
    v_cmp_eq_u32 vcc, 0, v7
    v_mov_b32 v1, 0x3f803f80
    s_nop 0
    v_cndmask_b32 v88, 0, v1, vcc
    v_cndmask_b32 v89, 0, v1, vcc
    v_cndmask_b32 v90, 0, v1, vcc
    v_cndmask_b32 v91, 0, v1, vcc
    v_cmp_eq_u32 vcc, 2, v7
    v_mov_b32 v1, 0x3f80
    s_nop 0
    v_cndmask_b32 v88, v88, v1, vcc
    v_add_u32 v1, s48, v5
    s_mov_b64 exec, 0xffff
    ds_write_b128 v1, v[88:91] offset:2816
    ds_write_b128 v1, v[88:91] offset:27392
    ds_write_b128 v1, v[88:91] offset:51968
    s_mov_b64 exec, -1
    s_add_u32 s36, s24, 9437184
    s_addc_u32 s37, s25, 0
    s_mov_b32 s38, 8192
    s_mov_b32 s39, 0x00020000
    s_add_u32 s40, s24, 10485760
    s_addc_u32 s41, s25, 0
    s_mov_b32 s42, 9699328
    s_mov_b32 s43, 0x00020000
    s_lshr_b32 s64, s26, 2
    s_lshr_b32 s56, s44, 1
    s_lshl_b32 s59, 1, s56
    s_and_b32 s59, s59, 0x1248
    s_cselect_b32 s59, 32, 16
    s_add_u32 s56, s56, 48
    s_lshl_b32 s56, s56, 8
    s_add_u32 s57, s56, 4096
    s_add_u32 s58, s56, 8192
    s_and_b32 s50, s2, 15
    s_add_u32 s50, s50, 32
    s_lshl_b32 s50, s50, 8
    s_mov_b32 s80, s50
    s_add_u32 s46, s53, 1
    s_sub_u32 s46, s46, s64
    s_add_u32 s53, s53, s64
    s_mul_i32 s82, s53, 2560
    s_mul_i32 s83, s46, 2560
    s_lshl_b32 s47, s65, 3
    s_add_u32 s100, s82, s47
    s_add_u32 s101, s83, s47
    s_mul_i32 s47, s65, 1536
    s_add_u32 s82, s82, s47
    s_add_u32 s83, s83, s47
    s_lshl_b32 s81, s53, 7
    v_lshlrev_b32 v6, 2, v3
    s_mov_b32 s27, s56
    s_mov_b32 s3, s57
    s_mov_b32 s51, s58
    s_mov_b32 s52, s59
    v_lshlrev_b32 v7, 4, v3
    s_cmp_eq_u32 s65, 0
    s_mov_b32 s56, 1792
    s_cmov_b32 s56, 0
    s_mov_b32 s57, 8
    s_cmov_b32 s57, 2304
    s_mov_b32 s58, 512
    s_cmov_b32 s58, 1024
    s_mul_i32 s59, s64, 12288
    v_add_u32 v11, s56, v5
    v_add_u32 v12, s57, v7
    v_mov_b32 v1, 2848
    v_cndmask_b32 v12, v1, v12, s[54:55]
    v_add_u32 v8, s59, v11
    v_add_u32 v9, s59, v12
    v_lshrrev_b32 v1, 2, v3
    v_xor_b32 v10, v1, v4
    v_and_b32 v10, 3, v10
    v_lshlrev_b32 v10, 6, v10
    v_lshl_add_u32 v10, v1, 8, v10
    v_and_b32 v1, 3, v3
    v_lshl_add_u32 v10, v1, 4, v10
    v_xor_b32 v14, 128, v10
    v_add_u32 v10, s58, v10
    v_add_u32 v14, s58, v14
    v_cmp_eq_u32 vcc, 20, v3
    v_mov_b32 v1, 2832
    v_mov_b32 v15, 2816
    v_cndmask_b32 v1, v1, v15, vcc
    v_cmp_gt_u32 vcc, 28, v3
    v_mov_b32 v15, 3
    s_nop 0
    v_cndmask_b32 v15, v15, 1, vcc
    v_xor_b32 v15, v15, v4
    v_lshl_add_u32 v1, v15, 6, v1
    v_xor_b32 v15, 128, v1
    v_cmp_gt_u32 vcc, 20, v3
    s_nop 1
    v_cndmask_b32 v13, v1, v10, vcc
    v_cndmask_b32 v15, v15, v14, vcc
    v_add_u32 v10, s59, v13
    v_add_u32 v14, s59, v15
    s_lshr_b32 s46, s44, 3
    s_mul_i32 s46, s46, 5
    s_add_u32 s46, s46, 54
    s_bfe_u32 s47, s44, 0x20001
    s_add_u32 s56, s46, s47
    s_lshl_b32 s56, s56, 10
    s_lshl_b32 s58, s65, 9
    s_add_u32 s56, s56, s58
    s_add_u32 s59, s46, 4
    s_lshl_b32 s59, s59, 10
    s_lshl_b32 s58, s47, 8
    s_add_u32 s59, s59, s58
    s_lshl_b32 s58, s65, 7
    s_add_u32 s59, s59, s58
    s_mul_i32 s58, s53, 151552
    s_add_u32 s56, s56, s58
    s_add_u32 s59, s59, s58
    s_lshl_b32 s57, s45, 8
    s_add_u32 s57, s57, 4096
    v_lshrrev_b32 v124, 4, v3
    v_mul_u32_u24 v124, 75776, v124
    v_and_b32 v125, 15, v3
    v_lshl_add_u32 v126, v125, 4, v124
    v_lshl_add_u32 v124, v125, 3, v124
    v_lshl_add_u32 v125, v4, 8, v126
    s_cmp_lg_u32 s26, 0
    s_cbranch_scc1 La_w1_d
    s_mov_b32 s62, 0
    v_mov_b32 v120, 0
    v_writelane_b32 v120, s27, 0
    v_writelane_b32 v121, s52, 0
    v_writelane_b32 v120, s3, 1
    v_writelane_b32 v121, s52, 1
    v_writelane_b32 v120, s51, 2
    v_writelane_b32 v121, s52, 2
    s_mov_b64 exec, 7
La_w1:
    buffer_load_dword v1, v120, s[76:79], 0 offen sc1
    s_add_u32 s62, s62, 1
    s_waitcnt vmcnt(0)
    v_cmp_lt_u32 vcc, v1, v121
    s_nop 0
    s_cmp_eq_u64 vcc, 0
    s_cbranch_scc1 La_w1_o
    s_sleep 2
    s_cmp_lt_u32 s62, 0x200000
    s_cbranch_scc1 La_w1
La_w1_o:
    s_mov_b64 exec, -1
La_w1_d:
    s_waitcnt vmcnt(0)
    s_barrier
    s_mov_b32 m0, s48
    v_lshlrev_b32 v7, 4, v3
    buffer_load_dwordx4 v5, s[28:31], s49 offen offset:0 sc1 lds
    buffer_load_dwordx4 v5, s[28:31], s49 offen offset:1024 sc1 lds
    s_mov_b32 exec_hi, 0xffff
    buffer_load_dwordx4 v5, s[28:31], s49 offen offset:2048 sc1 lds
    s_mov_b32 exec_hi, -1
    buffer_load_dwordx4 v[16:19], v5, s[32:35], s82 offen sc1
    buffer_load_dwordx2 v[20:21], v7, s[32:35], s100 offen offset:1024 sc1
    buffer_load_dwordx4 v[24:27], v5, s[32:35], s83 offen sc1
    buffer_load_dwordx2 v[28:29], v7, s[32:35], s101 offen offset:1024 sc1
    s_add_u32 m0, s48, 24576
    s_add_u32 s49, s49, 40960
    buffer_load_dwordx4 v5, s[28:31], s49 offen offset:0 sc1 lds
    buffer_load_dwordx4 v5, s[28:31], s49 offen offset:1024 sc1 lds
    s_mov_b32 exec_hi, 0xffff
    buffer_load_dwordx4 v5, s[28:31], s49 offen offset:2048 sc1 lds
    s_mov_b32 exec_hi, -1
    s_cmp_lg_u32 s26, 0
    s_cbranch_scc1 Lq_goe
    v_mov_b32 v1, 2
    v_mov_b32 v127, 0
    s_mov_b64 exec, 1
    s_lshl_b32 s63, s2, 7
    s_add_u32 s63, s63, 32768
    buffer_store_dword v1, v127, s[76:79], s63 offen sc1
    s_mov_b64 exec, -1
Lq_goe:
    s_waitcnt vmcnt(3)
    v_cndmask_b32 v20, 0, v20, s[54:55]
    v_cndmask_b32 v21, 0, v21, s[54:55]
    v_cndmask_b32 v28, 0, v28, s[54:55]
    v_cndmask_b32 v29, 0, v29, s[54:55]
    s_waitcnt lgkmcnt(0)
    s_barrier
    ds_read_b128 v[32:35], v11
    ds_read_b64 v[36:37], v12 offset:0
    ds_read_b128 v[40:43], v10 offset:0
    s_waitcnt lgkmcnt(1)
    v_mfma_f32_32x32x16_bf16 v[88:103], v[32:35], v[16:19], 0
    v_mfma_f32_32x32x16_bf16 v[104:119], v[32:35], v[24:27], 0
    v_mfma_f32_32x32x8bf16_1k v[88:103], v[36:37], v[20:21], v[88:103]
    v_mfma_f32_32x32x8bf16_1k v[104:119], v[36:37], v[28:29], v[104:119]
    ds_read_b128 v[32:35], v8
    ds_read_b64 v[36:37], v9 offset:0
    s_nop 8
    v_max3_f32 v120, v88, v89, v90
    v_max3_f32 v120, v120, v91, v92
    v_max3_f32 v120, v120, v93, v94
    v_max3_f32 v120, v120, v95, v96
    v_max3_f32 v120, v120, v97, v98
    v_max3_f32 v120, v120, v99, v100
    v_max3_f32 v120, v120, v101, v102
    v_max_f32 v120, v120, v103
    v_mov_b32 v122, v120
    v_max3_f32 v121, v104, v105, v106
    v_max3_f32 v121, v121, v107, v108
    v_max3_f32 v121, v121, v109, v110
    v_max3_f32 v121, v121, v111, v112
    v_max3_f32 v121, v121, v113, v114
    v_max3_f32 v121, v121, v115, v116
    v_max3_f32 v121, v121, v117, v118
    v_max_f32 v121, v121, v119
    v_mov_b32 v123, v121
    v_permlane32_swap_b32 v120, v122
    s_nop 0
    v_permlane32_swap_b32 v121, v123
    v_max_f32 v120, v120, v122
    v_max_f32 v121, v121, v123
    v_cvt_pk_bf16_f32 v120, -v120, 0
    v_cvt_pk_bf16_f32 v121, -v121, 0
    v_cndmask_b32 v20, v120, v20, s[54:55]
    v_cndmask_b32 v28, v121, v28, s[54:55]
    s_waitcnt lgkmcnt(0)
    v_mfma_f32_32x32x16_bf16 v[88:103], v[32:35], v[16:19], 0
    v_mfma_f32_32x32x8bf16_1k v[88:103], v[36:37], v[20:21], v[88:103]
    s_cmp_lg_u32 s26, 0
    s_cbranch_scc1 Lq_god
    v_mov_b32 v1, 3
    v_mov_b32 v127, 0
    s_mov_b64 exec, 1
    s_lshl_b32 s63, s2, 7
    s_add_u32 s63, s63, 32768
    buffer_store_dword v1, v127, s[76:79], s63 offen sc1
    s_mov_b64 exec, -1
Lq_god:
    s_mov_b32 s50, 8
    s_setprio 1
    v_mfma_f32_32x32x16_bf16 v[104:119], v[32:35], v[24:27], 0
    ds_read_b128 v[32:35], v8 offset:3072
    s_nop 5
    v_exp_f32 v88, v88
    v_exp_f32 v89, v89
    v_exp_f32 v90, v90
    v_exp_f32 v91, v91
    v_cvt_pk_bf16_f32 v48, v88, v89
    v_cvt_pk_bf16_f32 v49, v90, v91
    ds_read_b128 v[44:47], v14 offset:0
    v_exp_f32 v92, v92
    v_exp_f32 v93, v93
    v_exp_f32 v94, v94
    v_exp_f32 v95, v95
    v_cvt_pk_bf16_f32 v50, v92, v93
    v_cvt_pk_bf16_f32 v51, v94, v95
    v_mfma_f32_32x32x8bf16_1k v[104:119], v[36:37], v[28:29], v[104:119]
    ds_read_b64 v[36:37], v9 offset:3072
    v_exp_f32 v96, v96
    v_exp_f32 v97, v97
    v_exp_f32 v98, v98
    v_exp_f32 v99, v99
    v_cvt_pk_bf16_f32 v52, v96, v97
    v_cvt_pk_bf16_f32 v53, v98, v99
    s_waitcnt lgkmcnt(3)
    v_mfma_f32_32x32x16_bf16 v[56:71], v[40:43], v[48:51], 0
    v_exp_f32 v100, v100
    v_exp_f32 v101, v101
    v_exp_f32 v102, v102
    v_exp_f32 v103, v103
    v_cvt_pk_bf16_f32 v54, v100, v101
    v_cvt_pk_bf16_f32 v55, v102, v103
    s_waitcnt lgkmcnt(1)
    v_mfma_f32_32x32x16_bf16 v[88:103], v[32:35], v[16:19], 0
    v_exp_f32 v104, v104
    v_exp_f32 v105, v105
    v_exp_f32 v106, v106
    v_exp_f32 v107, v107
    v_cvt_pk_bf16_f32 v48, v104, v105
    v_cvt_pk_bf16_f32 v49, v106, v107
    v_mfma_f32_32x32x16_bf16 v[56:71], v[44:47], v[52:55], v[56:71]
    v_exp_f32 v108, v108
    v_exp_f32 v109, v109
    v_exp_f32 v110, v110
    v_exp_f32 v111, v111
    v_cvt_pk_bf16_f32 v50, v108, v109
    v_cvt_pk_bf16_f32 v51, v110, v111
    s_waitcnt lgkmcnt(0)
    v_mfma_f32_32x32x8bf16_1k v[88:103], v[36:37], v[20:21], v[88:103]
    v_exp_f32 v112, v112
    v_exp_f32 v113, v113
    v_exp_f32 v114, v114
    v_exp_f32 v115, v115
    v_cvt_pk_bf16_f32 v52, v112, v113
    v_cvt_pk_bf16_f32 v53, v114, v115
    v_mfma_f32_32x32x16_bf16 v[72:87], v[40:43], v[48:51], 0
    ds_read_b128 v[40:43], v10 offset:3072
    v_exp_f32 v116, v116
    v_exp_f32 v117, v117
    v_exp_f32 v118, v118
    v_exp_f32 v119, v119
    v_cvt_pk_bf16_f32 v54, v116, v117
    v_cvt_pk_bf16_f32 v55, v118, v119
    v_mfma_f32_32x32x16_bf16 v[104:119], v[32:35], v[24:27], 0
    ds_read_b128 v[32:35], v8 offset:6144
    v_exp_f32 v88, v88
    v_exp_f32 v89, v89
    v_exp_f32 v90, v90
    v_exp_f32 v91, v91
    v_cvt_pk_bf16_f32 v48, v88, v89
    v_cvt_pk_bf16_f32 v49, v90, v91
    v_mfma_f32_32x32x16_bf16 v[72:87], v[44:47], v[52:55], v[72:87]
    ds_read_b128 v[44:47], v14 offset:3072
    v_exp_f32 v92, v92
    v_exp_f32 v93, v93
    v_exp_f32 v94, v94
    v_exp_f32 v95, v95
    v_cvt_pk_bf16_f32 v50, v92, v93
    v_cvt_pk_bf16_f32 v51, v94, v95
    v_mfma_f32_32x32x8bf16_1k v[104:119], v[36:37], v[28:29], v[104:119]
    ds_read_b64 v[36:37], v9 offset:6144
    v_exp_f32 v96, v96
    v_exp_f32 v97, v97
    v_exp_f32 v98, v98
    v_exp_f32 v99, v99
    v_cvt_pk_bf16_f32 v52, v96, v97
    v_cvt_pk_bf16_f32 v53, v98, v99
    s_waitcnt lgkmcnt(3)
    v_mfma_f32_32x32x16_bf16 v[56:71], v[40:43], v[48:51], v[56:71]
    v_exp_f32 v100, v100
    v_exp_f32 v101, v101
    v_exp_f32 v102, v102
    v_exp_f32 v103, v103
    v_cvt_pk_bf16_f32 v54, v100, v101
    v_cvt_pk_bf16_f32 v55, v102, v103
    s_waitcnt lgkmcnt(1)
    v_mfma_f32_32x32x16_bf16 v[88:103], v[32:35], v[16:19], 0
    v_exp_f32 v104, v104
    v_exp_f32 v105, v105
    v_exp_f32 v106, v106
    v_exp_f32 v107, v107
    v_cvt_pk_bf16_f32 v48, v104, v105
    v_cvt_pk_bf16_f32 v49, v106, v107
    v_mfma_f32_32x32x16_bf16 v[56:71], v[44:47], v[52:55], v[56:71]
    v_exp_f32 v108, v108
    v_exp_f32 v109, v109
    v_exp_f32 v110, v110
    v_exp_f32 v111, v111
    v_cvt_pk_bf16_f32 v50, v108, v109
    v_cvt_pk_bf16_f32 v51, v110, v111
    s_waitcnt lgkmcnt(0)
    v_mfma_f32_32x32x8bf16_1k v[88:103], v[36:37], v[20:21], v[88:103]
    v_exp_f32 v112, v112
    v_exp_f32 v113, v113
    v_exp_f32 v114, v114
    v_exp_f32 v115, v115
    v_cvt_pk_bf16_f32 v52, v112, v113
    v_cvt_pk_bf16_f32 v53, v114, v115
    v_mfma_f32_32x32x16_bf16 v[72:87], v[40:43], v[48:51], v[72:87]
    ds_read_b128 v[40:43], v10 offset:6144
    v_exp_f32 v116, v116
    v_exp_f32 v117, v117
    v_exp_f32 v118, v118
    v_exp_f32 v119, v119
    v_cvt_pk_bf16_f32 v54, v116, v117
    v_cvt_pk_bf16_f32 v55, v118, v119
    v_mfma_f32_32x32x16_bf16 v[104:119], v[32:35], v[24:27], 0
    ds_read_b128 v[32:35], v8 offset:9216
    v_exp_f32 v88, v88
    v_exp_f32 v89, v89
    v_exp_f32 v90, v90
    v_exp_f32 v91, v91
    v_cvt_pk_bf16_f32 v48, v88, v89
    v_cvt_pk_bf16_f32 v49, v90, v91
    v_mfma_f32_32x32x16_bf16 v[72:87], v[44:47], v[52:55], v[72:87]
    ds_read_b128 v[44:47], v14 offset:6144
    v_exp_f32 v92, v92
    v_exp_f32 v93, v93
    v_exp_f32 v94, v94
    v_exp_f32 v95, v95
    v_cvt_pk_bf16_f32 v50, v92, v93
    v_cvt_pk_bf16_f32 v51, v94, v95
    v_mfma_f32_32x32x8bf16_1k v[104:119], v[36:37], v[28:29], v[104:119]
    ds_read_b64 v[36:37], v9 offset:9216
    v_exp_f32 v96, v96
    v_exp_f32 v97, v97
    v_exp_f32 v98, v98
    v_exp_f32 v99, v99
    v_cvt_pk_bf16_f32 v52, v96, v97
    v_cvt_pk_bf16_f32 v53, v98, v99
    s_waitcnt lgkmcnt(3)
    v_mfma_f32_32x32x16_bf16 v[56:71], v[40:43], v[48:51], v[56:71]
    v_exp_f32 v100, v100
    v_exp_f32 v101, v101
    v_exp_f32 v102, v102
    v_exp_f32 v103, v103
    v_cvt_pk_bf16_f32 v54, v100, v101
    v_cvt_pk_bf16_f32 v55, v102, v103
    s_waitcnt lgkmcnt(1)
    v_mfma_f32_32x32x16_bf16 v[88:103], v[32:35], v[16:19], 0
    v_exp_f32 v104, v104
    v_exp_f32 v105, v105
    v_exp_f32 v106, v106
    v_exp_f32 v107, v107
    v_cvt_pk_bf16_f32 v48, v104, v105
    v_cvt_pk_bf16_f32 v49, v106, v107
    v_mfma_f32_32x32x16_bf16 v[56:71], v[44:47], v[52:55], v[56:71]
    v_exp_f32 v108, v108
    v_exp_f32 v109, v109
    v_exp_f32 v110, v110
    v_exp_f32 v111, v111
    v_cvt_pk_bf16_f32 v50, v108, v109
    v_cvt_pk_bf16_f32 v51, v110, v111
    s_waitcnt lgkmcnt(0)
    v_mfma_f32_32x32x8bf16_1k v[88:103], v[36:37], v[20:21], v[88:103]
    v_exp_f32 v112, v112
    v_exp_f32 v113, v113
    v_exp_f32 v114, v114
    v_exp_f32 v115, v115
    v_cvt_pk_bf16_f32 v52, v112, v113
    v_cvt_pk_bf16_f32 v53, v114, v115
    v_mfma_f32_32x32x16_bf16 v[72:87], v[40:43], v[48:51], v[72:87]
    ds_read_b128 v[40:43], v10 offset:9216
    v_exp_f32 v116, v116
    v_exp_f32 v117, v117
    v_exp_f32 v118, v118
    v_exp_f32 v119, v119
    s_waitcnt vmcnt(0)
    s_barrier
    s_add_u32 m0, s48, 49152
    s_add_u32 s49, s49, 40960
    v_cvt_pk_bf16_f32 v54, v116, v117
    v_cvt_pk_bf16_f32 v55, v118, v119
    v_mfma_f32_32x32x16_bf16 v[104:119], v[32:35], v[24:27], 0
    ds_read_b128 v[32:35], v8 offset:24576
    v_exp_f32 v88, v88
    v_exp_f32 v89, v89
    v_exp_f32 v90, v90
    v_exp_f32 v91, v91
    buffer_load_dwordx4 v5, s[28:31], s49 offen offset:0 sc1 lds
    v_cvt_pk_bf16_f32 v48, v88, v89
    v_cvt_pk_bf16_f32 v49, v90, v91
    v_mfma_f32_32x32x16_bf16 v[72:87], v[44:47], v[52:55], v[72:87]
    ds_read_b128 v[44:47], v14 offset:9216
    v_exp_f32 v92, v92
    v_exp_f32 v93, v93
    v_exp_f32 v94, v94
    v_exp_f32 v95, v95
    buffer_load_dwordx4 v5, s[28:31], s49 offen offset:1024 sc1 lds
    v_cvt_pk_bf16_f32 v50, v92, v93
    v_cvt_pk_bf16_f32 v51, v94, v95
    v_mfma_f32_32x32x8bf16_1k v[104:119], v[36:37], v[28:29], v[104:119]
    ds_read_b64 v[36:37], v9 offset:24576
    v_exp_f32 v96, v96
    v_exp_f32 v97, v97
    v_exp_f32 v98, v98
    v_exp_f32 v99, v99
    s_mov_b32 exec_hi, 0xffff
    buffer_load_dwordx4 v5, s[28:31], s49 offen offset:2048 sc1 lds
    s_mov_b32 exec_hi, -1
    v_cvt_pk_bf16_f32 v52, v96, v97
    v_cvt_pk_bf16_f32 v53, v98, v99
    s_waitcnt lgkmcnt(3)
    v_mfma_f32_32x32x16_bf16 v[56:71], v[40:43], v[48:51], v[56:71]
    v_exp_f32 v100, v100
    v_exp_f32 v101, v101
    v_exp_f32 v102, v102
    v_exp_f32 v103, v103
    v_cvt_pk_bf16_f32 v54, v100, v101
    v_cvt_pk_bf16_f32 v55, v102, v103
    s_waitcnt lgkmcnt(1)
    v_mfma_f32_32x32x16_bf16 v[88:103], v[32:35], v[16:19], 0
    v_exp_f32 v104, v104
    v_exp_f32 v105, v105
    v_exp_f32 v106, v106
    v_exp_f32 v107, v107
    v_cvt_pk_bf16_f32 v48, v104, v105
    v_cvt_pk_bf16_f32 v49, v106, v107
    v_mfma_f32_32x32x16_bf16 v[56:71], v[44:47], v[52:55], v[56:71]
    v_exp_f32 v108, v108
    v_exp_f32 v109, v109
    v_exp_f32 v110, v110
    v_exp_f32 v111, v111
    v_cvt_pk_bf16_f32 v50, v108, v109
    v_cvt_pk_bf16_f32 v51, v110, v111
    s_waitcnt lgkmcnt(0)
    v_mfma_f32_32x32x8bf16_1k v[88:103], v[36:37], v[20:21], v[88:103]
    v_exp_f32 v112, v112
    v_exp_f32 v113, v113
    v_exp_f32 v114, v114
    v_exp_f32 v115, v115
    v_cvt_pk_bf16_f32 v52, v112, v113
    v_cvt_pk_bf16_f32 v53, v114, v115
    v_mfma_f32_32x32x16_bf16 v[72:87], v[40:43], v[48:51], v[72:87]
    ds_read_b128 v[40:43], v10 offset:24576
    v_exp_f32 v116, v116
    v_exp_f32 v117, v117
    v_exp_f32 v118, v118
    v_exp_f32 v119, v119
    v_cvt_pk_bf16_f32 v54, v116, v117
    v_cvt_pk_bf16_f32 v55, v118, v119
    v_mfma_f32_32x32x16_bf16 v[104:119], v[32:35], v[24:27], 0
    ds_read_b128 v[32:35], v8 offset:27648
    v_exp_f32 v88, v88
    v_exp_f32 v89, v89
    v_exp_f32 v90, v90
    v_exp_f32 v91, v91
    v_cvt_pk_bf16_f32 v48, v88, v89
    v_cvt_pk_bf16_f32 v49, v90, v91
    v_mfma_f32_32x32x16_bf16 v[72:87], v[44:47], v[52:55], v[72:87]
    ds_read_b128 v[44:47], v14 offset:24576
    v_exp_f32 v92, v92
    v_exp_f32 v93, v93
    v_exp_f32 v94, v94
    v_exp_f32 v95, v95
    v_cvt_pk_bf16_f32 v50, v92, v93
    v_cvt_pk_bf16_f32 v51, v94, v95
    v_mfma_f32_32x32x8bf16_1k v[104:119], v[36:37], v[28:29], v[104:119]
    ds_read_b64 v[36:37], v9 offset:27648
    v_exp_f32 v96, v96
    v_exp_f32 v97, v97
    v_exp_f32 v98, v98
    v_exp_f32 v99, v99
    v_cvt_pk_bf16_f32 v52, v96, v97
    v_cvt_pk_bf16_f32 v53, v98, v99
    s_waitcnt lgkmcnt(3)
    v_mfma_f32_32x32x16_bf16 v[56:71], v[40:43], v[48:51], v[56:71]
    v_exp_f32 v100, v100
    v_exp_f32 v101, v101
    v_exp_f32 v102, v102
    v_exp_f32 v103, v103
    v_cvt_pk_bf16_f32 v54, v100, v101
    v_cvt_pk_bf16_f32 v55, v102, v103
    s_waitcnt lgkmcnt(1)
    v_mfma_f32_32x32x16_bf16 v[88:103], v[32:35], v[16:19], 0
    v_exp_f32 v104, v104
    v_exp_f32 v105, v105
    v_exp_f32 v106, v106
    v_exp_f32 v107, v107
    v_cvt_pk_bf16_f32 v48, v104, v105
    v_cvt_pk_bf16_f32 v49, v106, v107
    v_mfma_f32_32x32x16_bf16 v[56:71], v[44:47], v[52:55], v[56:71]
    v_exp_f32 v108, v108
    v_exp_f32 v109, v109
    v_exp_f32 v110, v110
    v_exp_f32 v111, v111
    v_cvt_pk_bf16_f32 v50, v108, v109
    v_cvt_pk_bf16_f32 v51, v110, v111
    s_waitcnt lgkmcnt(0)
    v_mfma_f32_32x32x8bf16_1k v[88:103], v[36:37], v[20:21], v[88:103]
    v_exp_f32 v112, v112
    v_exp_f32 v113, v113
    v_exp_f32 v114, v114
    v_exp_f32 v115, v115
    v_cvt_pk_bf16_f32 v52, v112, v113
    v_cvt_pk_bf16_f32 v53, v114, v115
    v_mfma_f32_32x32x16_bf16 v[72:87], v[40:43], v[48:51], v[72:87]
    ds_read_b128 v[40:43], v10 offset:27648
    v_exp_f32 v116, v116
    v_exp_f32 v117, v117
    v_exp_f32 v118, v118
    v_exp_f32 v119, v119
    v_cvt_pk_bf16_f32 v54, v116, v117
    v_cvt_pk_bf16_f32 v55, v118, v119
    v_mfma_f32_32x32x16_bf16 v[104:119], v[32:35], v[24:27], 0
    ds_read_b128 v[32:35], v8 offset:30720
    v_exp_f32 v88, v88
    v_exp_f32 v89, v89
    v_exp_f32 v90, v90
    v_exp_f32 v91, v91
    v_cvt_pk_bf16_f32 v48, v88, v89
    v_cvt_pk_bf16_f32 v49, v90, v91
    v_mfma_f32_32x32x16_bf16 v[72:87], v[44:47], v[52:55], v[72:87]
    ds_read_b128 v[44:47], v14 offset:27648
    v_exp_f32 v92, v92
    v_exp_f32 v93, v93
    v_exp_f32 v94, v94
    v_exp_f32 v95, v95
    v_cvt_pk_bf16_f32 v50, v92, v93
    v_cvt_pk_bf16_f32 v51, v94, v95
    v_mfma_f32_32x32x8bf16_1k v[104:119], v[36:37], v[28:29], v[104:119]
    ds_read_b64 v[36:37], v9 offset:30720
    v_exp_f32 v96, v96
    v_exp_f32 v97, v97
    v_exp_f32 v98, v98
    v_exp_f32 v99, v99
    v_cvt_pk_bf16_f32 v52, v96, v97
    v_cvt_pk_bf16_f32 v53, v98, v99
    s_waitcnt lgkmcnt(3)
    v_mfma_f32_32x32x16_bf16 v[56:71], v[40:43], v[48:51], v[56:71]
    v_exp_f32 v100, v100
    v_exp_f32 v101, v101
    v_exp_f32 v102, v102
    v_exp_f32 v103, v103
    v_cvt_pk_bf16_f32 v54, v100, v101
    v_cvt_pk_bf16_f32 v55, v102, v103
    s_waitcnt lgkmcnt(1)
    v_mfma_f32_32x32x16_bf16 v[88:103], v[32:35], v[16:19], 0
    v_exp_f32 v104, v104
    v_exp_f32 v105, v105
    v_exp_f32 v106, v106
    v_exp_f32 v107, v107
    v_cvt_pk_bf16_f32 v48, v104, v105
    v_cvt_pk_bf16_f32 v49, v106, v107
    v_mfma_f32_32x32x16_bf16 v[56:71], v[44:47], v[52:55], v[56:71]
    v_exp_f32 v108, v108
    v_exp_f32 v109, v109
    v_exp_f32 v110, v110
    v_exp_f32 v111, v111
    v_cvt_pk_bf16_f32 v50, v108, v109
    v_cvt_pk_bf16_f32 v51, v110, v111
    s_waitcnt lgkmcnt(0)
    v_mfma_f32_32x32x8bf16_1k v[88:103], v[36:37], v[20:21], v[88:103]
    v_exp_f32 v112, v112
    v_exp_f32 v113, v113
    v_exp_f32 v114, v114
    v_exp_f32 v115, v115
    v_cvt_pk_bf16_f32 v52, v112, v113
    v_cvt_pk_bf16_f32 v53, v114, v115
    v_mfma_f32_32x32x16_bf16 v[72:87], v[40:43], v[48:51], v[72:87]
    ds_read_b128 v[40:43], v10 offset:30720
    v_exp_f32 v116, v116
    v_exp_f32 v117, v117
    v_exp_f32 v118, v118
    v_exp_f32 v119, v119
    v_cvt_pk_bf16_f32 v54, v116, v117
    v_cvt_pk_bf16_f32 v55, v118, v119
    v_mfma_f32_32x32x16_bf16 v[104:119], v[32:35], v[24:27], 0
    ds_read_b128 v[32:35], v8 offset:33792
    v_exp_f32 v88, v88
    v_exp_f32 v89, v89
    v_exp_f32 v90, v90
    v_exp_f32 v91, v91
    v_cvt_pk_bf16_f32 v48, v88, v89
    v_cvt_pk_bf16_f32 v49, v90, v91
    v_mfma_f32_32x32x16_bf16 v[72:87], v[44:47], v[52:55], v[72:87]
    ds_read_b128 v[44:47], v14 offset:30720
    v_exp_f32 v92, v92
    v_exp_f32 v93, v93
    v_exp_f32 v94, v94
    v_exp_f32 v95, v95
    v_cvt_pk_bf16_f32 v50, v92, v93
    v_cvt_pk_bf16_f32 v51, v94, v95
    v_mfma_f32_32x32x8bf16_1k v[104:119], v[36:37], v[28:29], v[104:119]
    ds_read_b64 v[36:37], v9 offset:33792
    v_exp_f32 v96, v96
    v_exp_f32 v97, v97
    v_exp_f32 v98, v98
    v_exp_f32 v99, v99
    v_cvt_pk_bf16_f32 v52, v96, v97
    v_cvt_pk_bf16_f32 v53, v98, v99
    s_waitcnt lgkmcnt(3)
    v_mfma_f32_32x32x16_bf16 v[56:71], v[40:43], v[48:51], v[56:71]
    v_exp_f32 v100, v100
    v_exp_f32 v101, v101
    v_exp_f32 v102, v102
    v_exp_f32 v103, v103
    v_cvt_pk_bf16_f32 v54, v100, v101
    v_cvt_pk_bf16_f32 v55, v102, v103
    s_waitcnt lgkmcnt(1)
    v_mfma_f32_32x32x16_bf16 v[88:103], v[32:35], v[16:19], 0
    v_exp_f32 v104, v104
    v_exp_f32 v105, v105
    v_exp_f32 v106, v106
    v_exp_f32 v107, v107
    v_cvt_pk_bf16_f32 v48, v104, v105
    v_cvt_pk_bf16_f32 v49, v106, v107
    v_mfma_f32_32x32x16_bf16 v[56:71], v[44:47], v[52:55], v[56:71]
    v_exp_f32 v108, v108
    v_exp_f32 v109, v109
    v_exp_f32 v110, v110
    v_exp_f32 v111, v111
    v_cvt_pk_bf16_f32 v50, v108, v109
    v_cvt_pk_bf16_f32 v51, v110, v111
    s_waitcnt lgkmcnt(0)
    v_mfma_f32_32x32x8bf16_1k v[88:103], v[36:37], v[20:21], v[88:103]
    v_exp_f32 v112, v112
    v_exp_f32 v113, v113
    v_exp_f32 v114, v114
    v_exp_f32 v115, v115
    v_cvt_pk_bf16_f32 v52, v112, v113
    v_cvt_pk_bf16_f32 v53, v114, v115
    v_mfma_f32_32x32x16_bf16 v[72:87], v[40:43], v[48:51], v[72:87]
    ds_read_b128 v[40:43], v10 offset:33792
    v_exp_f32 v116, v116
    v_exp_f32 v117, v117
    v_exp_f32 v118, v118
    v_exp_f32 v119, v119
    s_waitcnt vmcnt(0)
    s_barrier
    s_add_u32 m0, s48, 0
    s_add_u32 s49, s49, 40960
    v_cvt_pk_bf16_f32 v54, v116, v117
    v_cvt_pk_bf16_f32 v55, v118, v119
    v_mfma_f32_32x32x16_bf16 v[104:119], v[32:35], v[24:27], 0
    ds_read_b128 v[32:35], v8 offset:49152
    v_exp_f32 v88, v88
    v_exp_f32 v89, v89
    v_exp_f32 v90, v90
    v_exp_f32 v91, v91
    buffer_load_dwordx4 v5, s[28:31], s49 offen offset:0 sc1 lds
    v_cvt_pk_bf16_f32 v48, v88, v89
    v_cvt_pk_bf16_f32 v49, v90, v91
    v_mfma_f32_32x32x16_bf16 v[72:87], v[44:47], v[52:55], v[72:87]
    ds_read_b128 v[44:47], v14 offset:33792
    v_exp_f32 v92, v92
    v_exp_f32 v93, v93
    v_exp_f32 v94, v94
    v_exp_f32 v95, v95
    buffer_load_dwordx4 v5, s[28:31], s49 offen offset:1024 sc1 lds
    v_cvt_pk_bf16_f32 v50, v92, v93
    v_cvt_pk_bf16_f32 v51, v94, v95
    v_mfma_f32_32x32x8bf16_1k v[104:119], v[36:37], v[28:29], v[104:119]
    ds_read_b64 v[36:37], v9 offset:49152
    v_exp_f32 v96, v96
    v_exp_f32 v97, v97
    v_exp_f32 v98, v98
    v_exp_f32 v99, v99
    s_mov_b32 exec_hi, 0xffff
    buffer_load_dwordx4 v5, s[28:31], s49 offen offset:2048 sc1 lds
    s_mov_b32 exec_hi, -1
    v_cvt_pk_bf16_f32 v52, v96, v97
    v_cvt_pk_bf16_f32 v53, v98, v99
    s_waitcnt lgkmcnt(3)
    v_mfma_f32_32x32x16_bf16 v[56:71], v[40:43], v[48:51], v[56:71]
    v_exp_f32 v100, v100
    v_exp_f32 v101, v101
    v_exp_f32 v102, v102
    v_exp_f32 v103, v103
    v_cvt_pk_bf16_f32 v54, v100, v101
    v_cvt_pk_bf16_f32 v55, v102, v103
    s_waitcnt lgkmcnt(1)
    v_mfma_f32_32x32x16_bf16 v[88:103], v[32:35], v[16:19], 0
    v_exp_f32 v104, v104
    v_exp_f32 v105, v105
    v_exp_f32 v106, v106
    v_exp_f32 v107, v107
    v_cvt_pk_bf16_f32 v48, v104, v105
    v_cvt_pk_bf16_f32 v49, v106, v107
    v_mfma_f32_32x32x16_bf16 v[56:71], v[44:47], v[52:55], v[56:71]
    v_exp_f32 v108, v108
    v_exp_f32 v109, v109
    v_exp_f32 v110, v110
    v_exp_f32 v111, v111
    v_cvt_pk_bf16_f32 v50, v108, v109
    v_cvt_pk_bf16_f32 v51, v110, v111
    s_waitcnt lgkmcnt(0)
    v_mfma_f32_32x32x8bf16_1k v[88:103], v[36:37], v[20:21], v[88:103]
    v_exp_f32 v112, v112
    v_exp_f32 v113, v113
    v_exp_f32 v114, v114
    v_exp_f32 v115, v115
    v_cvt_pk_bf16_f32 v52, v112, v113
    v_cvt_pk_bf16_f32 v53, v114, v115
    v_mfma_f32_32x32x16_bf16 v[72:87], v[40:43], v[48:51], v[72:87]
    ds_read_b128 v[40:43], v10 offset:49152
    v_exp_f32 v116, v116
    v_exp_f32 v117, v117
    v_exp_f32 v118, v118
    v_exp_f32 v119, v119
    v_cvt_pk_bf16_f32 v54, v116, v117
    v_cvt_pk_bf16_f32 v55, v118, v119
    v_mfma_f32_32x32x16_bf16 v[104:119], v[32:35], v[24:27], 0
    ds_read_b128 v[32:35], v8 offset:52224
    v_exp_f32 v88, v88
    v_exp_f32 v89, v89
    v_exp_f32 v90, v90
    v_exp_f32 v91, v91
    v_cvt_pk_bf16_f32 v48, v88, v89
    v_cvt_pk_bf16_f32 v49, v90, v91
    v_mfma_f32_32x32x16_bf16 v[72:87], v[44:47], v[52:55], v[72:87]
    ds_read_b128 v[44:47], v14 offset:49152
    v_exp_f32 v92, v92
    v_exp_f32 v93, v93
    v_exp_f32 v94, v94
    v_exp_f32 v95, v95
    v_cvt_pk_bf16_f32 v50, v92, v93
    v_cvt_pk_bf16_f32 v51, v94, v95
    v_mfma_f32_32x32x8bf16_1k v[104:119], v[36:37], v[28:29], v[104:119]
    ds_read_b64 v[36:37], v9 offset:52224
    v_exp_f32 v96, v96
    v_exp_f32 v97, v97
    v_exp_f32 v98, v98
    v_exp_f32 v99, v99
    v_cvt_pk_bf16_f32 v52, v96, v97
    v_cvt_pk_bf16_f32 v53, v98, v99
    s_waitcnt lgkmcnt(3)
    v_mfma_f32_32x32x16_bf16 v[56:71], v[40:43], v[48:51], v[56:71]
    v_exp_f32 v100, v100
    v_exp_f32 v101, v101
    v_exp_f32 v102, v102
    v_exp_f32 v103, v103
    v_cvt_pk_bf16_f32 v54, v100, v101
    v_cvt_pk_bf16_f32 v55, v102, v103
    s_waitcnt lgkmcnt(1)
    v_mfma_f32_32x32x16_bf16 v[88:103], v[32:35], v[16:19], 0
    v_exp_f32 v104, v104
    v_exp_f32 v105, v105
    v_exp_f32 v106, v106
    v_exp_f32 v107, v107
    v_cvt_pk_bf16_f32 v48, v104, v105
    v_cvt_pk_bf16_f32 v49, v106, v107
    v_mfma_f32_32x32x16_bf16 v[56:71], v[44:47], v[52:55], v[56:71]
    v_exp_f32 v108, v108
    v_exp_f32 v109, v109
    v_exp_f32 v110, v110
    v_exp_f32 v111, v111
    v_cvt_pk_bf16_f32 v50, v108, v109
    v_cvt_pk_bf16_f32 v51, v110, v111
    s_waitcnt lgkmcnt(0)
    v_mfma_f32_32x32x8bf16_1k v[88:103], v[36:37], v[20:21], v[88:103]
    v_exp_f32 v112, v112
    v_exp_f32 v113, v113
    v_exp_f32 v114, v114
    v_exp_f32 v115, v115
    v_cvt_pk_bf16_f32 v52, v112, v113
    v_cvt_pk_bf16_f32 v53, v114, v115
    v_mfma_f32_32x32x16_bf16 v[72:87], v[40:43], v[48:51], v[72:87]
    ds_read_b128 v[40:43], v10 offset:52224
    v_exp_f32 v116, v116
    v_exp_f32 v117, v117
    v_exp_f32 v118, v118
    v_exp_f32 v119, v119
    v_cvt_pk_bf16_f32 v54, v116, v117
    v_cvt_pk_bf16_f32 v55, v118, v119
    v_mfma_f32_32x32x16_bf16 v[104:119], v[32:35], v[24:27], 0
    ds_read_b128 v[32:35], v8 offset:55296
    v_exp_f32 v88, v88
    v_exp_f32 v89, v89
    v_exp_f32 v90, v90
    v_exp_f32 v91, v91
    v_cvt_pk_bf16_f32 v48, v88, v89
    v_cvt_pk_bf16_f32 v49, v90, v91
    v_mfma_f32_32x32x16_bf16 v[72:87], v[44:47], v[52:55], v[72:87]
    ds_read_b128 v[44:47], v14 offset:52224
    v_exp_f32 v92, v92
    v_exp_f32 v93, v93
    v_exp_f32 v94, v94
    v_exp_f32 v95, v95
    v_cvt_pk_bf16_f32 v50, v92, v93
    v_cvt_pk_bf16_f32 v51, v94, v95
    v_mfma_f32_32x32x8bf16_1k v[104:119], v[36:37], v[28:29], v[104:119]
    ds_read_b64 v[36:37], v9 offset:55296
    v_exp_f32 v96, v96
    v_exp_f32 v97, v97
    v_exp_f32 v98, v98
    v_exp_f32 v99, v99
    v_cvt_pk_bf16_f32 v52, v96, v97
    v_cvt_pk_bf16_f32 v53, v98, v99
    s_waitcnt lgkmcnt(3)
    v_mfma_f32_32x32x16_bf16 v[56:71], v[40:43], v[48:51], v[56:71]
    v_exp_f32 v100, v100
    v_exp_f32 v101, v101
    v_exp_f32 v102, v102
    v_exp_f32 v103, v103
    v_cvt_pk_bf16_f32 v54, v100, v101
    v_cvt_pk_bf16_f32 v55, v102, v103
    s_waitcnt lgkmcnt(1)
    v_mfma_f32_32x32x16_bf16 v[88:103], v[32:35], v[16:19], 0
    v_exp_f32 v104, v104
    v_exp_f32 v105, v105
    v_exp_f32 v106, v106
    v_exp_f32 v107, v107
    v_cvt_pk_bf16_f32 v48, v104, v105
    v_cvt_pk_bf16_f32 v49, v106, v107
    v_mfma_f32_32x32x16_bf16 v[56:71], v[44:47], v[52:55], v[56:71]
    v_exp_f32 v108, v108
    v_exp_f32 v109, v109
    v_exp_f32 v110, v110
    v_exp_f32 v111, v111
    v_cvt_pk_bf16_f32 v50, v108, v109
    v_cvt_pk_bf16_f32 v51, v110, v111
    s_waitcnt lgkmcnt(0)
    v_mfma_f32_32x32x8bf16_1k v[88:103], v[36:37], v[20:21], v[88:103]
    v_exp_f32 v112, v112
    v_exp_f32 v113, v113
    v_exp_f32 v114, v114
    v_exp_f32 v115, v115
    v_cvt_pk_bf16_f32 v52, v112, v113
    v_cvt_pk_bf16_f32 v53, v114, v115
    v_mfma_f32_32x32x16_bf16 v[72:87], v[40:43], v[48:51], v[72:87]
    ds_read_b128 v[40:43], v10 offset:55296
    v_exp_f32 v116, v116
    v_exp_f32 v117, v117
    v_exp_f32 v118, v118
    v_exp_f32 v119, v119
    v_cvt_pk_bf16_f32 v54, v116, v117
    v_cvt_pk_bf16_f32 v55, v118, v119
    v_mfma_f32_32x32x16_bf16 v[104:119], v[32:35], v[24:27], 0
    ds_read_b128 v[32:35], v8 offset:58368
    v_exp_f32 v88, v88
    v_exp_f32 v89, v89
    v_exp_f32 v90, v90
    v_exp_f32 v91, v91
    v_cvt_pk_bf16_f32 v48, v88, v89
    v_cvt_pk_bf16_f32 v49, v90, v91
    v_mfma_f32_32x32x16_bf16 v[72:87], v[44:47], v[52:55], v[72:87]
    ds_read_b128 v[44:47], v14 offset:55296
    v_exp_f32 v92, v92
    v_exp_f32 v93, v93
    v_exp_f32 v94, v94
    v_exp_f32 v95, v95
    v_cvt_pk_bf16_f32 v50, v92, v93
    v_cvt_pk_bf16_f32 v51, v94, v95
    v_mfma_f32_32x32x8bf16_1k v[104:119], v[36:37], v[28:29], v[104:119]
    ds_read_b64 v[36:37], v9 offset:58368
    v_exp_f32 v96, v96
    v_exp_f32 v97, v97
    v_exp_f32 v98, v98
    v_exp_f32 v99, v99
    v_cvt_pk_bf16_f32 v52, v96, v97
    v_cvt_pk_bf16_f32 v53, v98, v99
    s_waitcnt lgkmcnt(3)
    v_mfma_f32_32x32x16_bf16 v[56:71], v[40:43], v[48:51], v[56:71]
    v_exp_f32 v100, v100
    v_exp_f32 v101, v101
    v_exp_f32 v102, v102
    v_exp_f32 v103, v103
    v_cvt_pk_bf16_f32 v54, v100, v101
    v_cvt_pk_bf16_f32 v55, v102, v103
    s_waitcnt lgkmcnt(1)
    v_mfma_f32_32x32x16_bf16 v[88:103], v[32:35], v[16:19], 0
    v_exp_f32 v104, v104
    v_exp_f32 v105, v105
    v_exp_f32 v106, v106
    v_exp_f32 v107, v107
    v_cvt_pk_bf16_f32 v48, v104, v105
    v_cvt_pk_bf16_f32 v49, v106, v107
    v_mfma_f32_32x32x16_bf16 v[56:71], v[44:47], v[52:55], v[56:71]
    v_exp_f32 v108, v108
    v_exp_f32 v109, v109
    v_exp_f32 v110, v110
    v_exp_f32 v111, v111
    v_cvt_pk_bf16_f32 v50, v108, v109
    v_cvt_pk_bf16_f32 v51, v110, v111
    s_waitcnt lgkmcnt(0)
    v_mfma_f32_32x32x8bf16_1k v[88:103], v[36:37], v[20:21], v[88:103]
    v_exp_f32 v112, v112
    v_exp_f32 v113, v113
    v_exp_f32 v114, v114
    v_exp_f32 v115, v115
    v_cvt_pk_bf16_f32 v52, v112, v113
    v_cvt_pk_bf16_f32 v53, v114, v115
    v_mfma_f32_32x32x16_bf16 v[72:87], v[40:43], v[48:51], v[72:87]
    ds_read_b128 v[40:43], v10 offset:58368
    v_exp_f32 v116, v116
    v_exp_f32 v117, v117
    v_exp_f32 v118, v118
    v_exp_f32 v119, v119
    s_waitcnt vmcnt(0)
    s_barrier
    s_add_u32 m0, s48, 24576
    s_add_u32 s49, s49, 40960
    v_cvt_pk_bf16_f32 v54, v116, v117
    v_cvt_pk_bf16_f32 v55, v118, v119
    v_mfma_f32_32x32x16_bf16 v[104:119], v[32:35], v[24:27], 0
    ds_read_b128 v[32:35], v8 offset:0
    v_exp_f32 v88, v88
    v_exp_f32 v89, v89
    v_exp_f32 v90, v90
    v_exp_f32 v91, v91
    buffer_load_dwordx4 v5, s[28:31], s49 offen offset:0 sc1 lds
    v_cvt_pk_bf16_f32 v48, v88, v89
    v_cvt_pk_bf16_f32 v49, v90, v91
    v_mfma_f32_32x32x16_bf16 v[72:87], v[44:47], v[52:55], v[72:87]
    ds_read_b128 v[44:47], v14 offset:58368
    v_exp_f32 v92, v92
    v_exp_f32 v93, v93
    v_exp_f32 v94, v94
    v_exp_f32 v95, v95
    buffer_load_dwordx4 v5, s[28:31], s49 offen offset:1024 sc1 lds
    v_cvt_pk_bf16_f32 v50, v92, v93
    v_cvt_pk_bf16_f32 v51, v94, v95
    v_mfma_f32_32x32x8bf16_1k v[104:119], v[36:37], v[28:29], v[104:119]
    ds_read_b64 v[36:37], v9 offset:0
    v_exp_f32 v96, v96
    v_exp_f32 v97, v97
    v_exp_f32 v98, v98
    v_exp_f32 v99, v99
    s_mov_b32 exec_hi, 0xffff
    buffer_load_dwordx4 v5, s[28:31], s49 offen offset:2048 sc1 lds
    s_mov_b32 exec_hi, -1
    v_cvt_pk_bf16_f32 v52, v96, v97
    v_cvt_pk_bf16_f32 v53, v98, v99
    s_waitcnt lgkmcnt(3)
    v_mfma_f32_32x32x16_bf16 v[56:71], v[40:43], v[48:51], v[56:71]
    v_exp_f32 v100, v100
    v_exp_f32 v101, v101
    v_exp_f32 v102, v102
    v_exp_f32 v103, v103
    v_cvt_pk_bf16_f32 v54, v100, v101
    v_cvt_pk_bf16_f32 v55, v102, v103
    s_waitcnt lgkmcnt(1)
    v_mfma_f32_32x32x16_bf16 v[88:103], v[32:35], v[16:19], 0
    v_exp_f32 v104, v104
    v_exp_f32 v105, v105
    v_exp_f32 v106, v106
    v_exp_f32 v107, v107
    v_cvt_pk_bf16_f32 v48, v104, v105
    v_cvt_pk_bf16_f32 v49, v106, v107
    v_mfma_f32_32x32x16_bf16 v[56:71], v[44:47], v[52:55], v[56:71]
    v_exp_f32 v108, v108
    v_exp_f32 v109, v109
    v_exp_f32 v110, v110
    v_exp_f32 v111, v111
    v_cvt_pk_bf16_f32 v50, v108, v109
    v_cvt_pk_bf16_f32 v51, v110, v111
    s_waitcnt lgkmcnt(0)
    v_mfma_f32_32x32x8bf16_1k v[88:103], v[36:37], v[20:21], v[88:103]
    v_exp_f32 v112, v112
    v_exp_f32 v113, v113
    v_exp_f32 v114, v114
    v_exp_f32 v115, v115
    v_cvt_pk_bf16_f32 v52, v112, v113
    v_cvt_pk_bf16_f32 v53, v114, v115
    v_mfma_f32_32x32x16_bf16 v[72:87], v[40:43], v[48:51], v[72:87]
    ds_read_b128 v[40:43], v10 offset:0
    v_exp_f32 v116, v116
    v_exp_f32 v117, v117
    v_exp_f32 v118, v118
    v_exp_f32 v119, v119
    v_cvt_pk_bf16_f32 v54, v116, v117
    v_cvt_pk_bf16_f32 v55, v118, v119
    v_mfma_f32_32x32x16_bf16 v[104:119], v[32:35], v[24:27], 0
    ds_read_b128 v[32:35], v8 offset:3072
    v_exp_f32 v88, v88
    v_exp_f32 v89, v89
    v_exp_f32 v90, v90
    v_exp_f32 v91, v91
    v_cvt_pk_bf16_f32 v48, v88, v89
    v_cvt_pk_bf16_f32 v49, v90, v91
    v_mfma_f32_32x32x16_bf16 v[72:87], v[44:47], v[52:55], v[72:87]
    ds_read_b128 v[44:47], v14 offset:0
    v_exp_f32 v92, v92
    v_exp_f32 v93, v93
    v_exp_f32 v94, v94
    v_exp_f32 v95, v95
    v_cvt_pk_bf16_f32 v50, v92, v93
    v_cvt_pk_bf16_f32 v51, v94, v95
    v_mfma_f32_32x32x8bf16_1k v[104:119], v[36:37], v[28:29], v[104:119]
    ds_read_b64 v[36:37], v9 offset:3072
    v_exp_f32 v96, v96
    v_exp_f32 v97, v97
    v_exp_f32 v98, v98
    v_exp_f32 v99, v99
    v_cvt_pk_bf16_f32 v52, v96, v97
    v_cvt_pk_bf16_f32 v53, v98, v99
    s_waitcnt lgkmcnt(3)
    v_mfma_f32_32x32x16_bf16 v[56:71], v[40:43], v[48:51], v[56:71]
    v_exp_f32 v100, v100
    v_exp_f32 v101, v101
    v_exp_f32 v102, v102
    v_exp_f32 v103, v103
    v_cvt_pk_bf16_f32 v54, v100, v101
    v_cvt_pk_bf16_f32 v55, v102, v103
    s_waitcnt lgkmcnt(1)
    v_mfma_f32_32x32x16_bf16 v[88:103], v[32:35], v[16:19], 0
    v_exp_f32 v104, v104
    v_exp_f32 v105, v105
    v_exp_f32 v106, v106
    v_exp_f32 v107, v107
    v_cvt_pk_bf16_f32 v48, v104, v105
    v_cvt_pk_bf16_f32 v49, v106, v107
    v_mfma_f32_32x32x16_bf16 v[56:71], v[44:47], v[52:55], v[56:71]
    v_exp_f32 v108, v108
    v_exp_f32 v109, v109
    v_exp_f32 v110, v110
    v_exp_f32 v111, v111
    v_cvt_pk_bf16_f32 v50, v108, v109
    v_cvt_pk_bf16_f32 v51, v110, v111
    s_waitcnt lgkmcnt(0)
    v_mfma_f32_32x32x8bf16_1k v[88:103], v[36:37], v[20:21], v[88:103]
    v_exp_f32 v112, v112
    v_exp_f32 v113, v113
    v_exp_f32 v114, v114
    v_exp_f32 v115, v115
    v_cvt_pk_bf16_f32 v52, v112, v113
    v_cvt_pk_bf16_f32 v53, v114, v115
    v_mfma_f32_32x32x16_bf16 v[72:87], v[40:43], v[48:51], v[72:87]
    ds_read_b128 v[40:43], v10 offset:3072
    v_exp_f32 v116, v116
    v_exp_f32 v117, v117
    v_exp_f32 v118, v118
    v_exp_f32 v119, v119
    v_cvt_pk_bf16_f32 v54, v116, v117
    v_cvt_pk_bf16_f32 v55, v118, v119
    v_mfma_f32_32x32x16_bf16 v[104:119], v[32:35], v[24:27], 0
    ds_read_b128 v[32:35], v8 offset:6144
    v_exp_f32 v88, v88
    v_exp_f32 v89, v89
    v_exp_f32 v90, v90
    v_exp_f32 v91, v91
    v_cvt_pk_bf16_f32 v48, v88, v89
    v_cvt_pk_bf16_f32 v49, v90, v91
    v_mfma_f32_32x32x16_bf16 v[72:87], v[44:47], v[52:55], v[72:87]
    ds_read_b128 v[44:47], v14 offset:3072
    v_exp_f32 v92, v92
    v_exp_f32 v93, v93
    v_exp_f32 v94, v94
    v_exp_f32 v95, v95
    v_cvt_pk_bf16_f32 v50, v92, v93
    v_cvt_pk_bf16_f32 v51, v94, v95
    v_mfma_f32_32x32x8bf16_1k v[104:119], v[36:37], v[28:29], v[104:119]
    ds_read_b64 v[36:37], v9 offset:6144
    v_exp_f32 v96, v96
    v_exp_f32 v97, v97
    v_exp_f32 v98, v98
    v_exp_f32 v99, v99
    v_cvt_pk_bf16_f32 v52, v96, v97
    v_cvt_pk_bf16_f32 v53, v98, v99
    s_waitcnt lgkmcnt(3)
    v_mfma_f32_32x32x16_bf16 v[56:71], v[40:43], v[48:51], v[56:71]
    v_exp_f32 v100, v100
    v_exp_f32 v101, v101
    v_exp_f32 v102, v102
    v_exp_f32 v103, v103
    v_cvt_pk_bf16_f32 v54, v100, v101
    v_cvt_pk_bf16_f32 v55, v102, v103
    s_waitcnt lgkmcnt(1)
    v_mfma_f32_32x32x16_bf16 v[88:103], v[32:35], v[16:19], 0
    v_exp_f32 v104, v104
    v_exp_f32 v105, v105
    v_exp_f32 v106, v106
    v_exp_f32 v107, v107
    v_cvt_pk_bf16_f32 v48, v104, v105
    v_cvt_pk_bf16_f32 v49, v106, v107
    v_mfma_f32_32x32x16_bf16 v[56:71], v[44:47], v[52:55], v[56:71]
    v_exp_f32 v108, v108
    v_exp_f32 v109, v109
    v_exp_f32 v110, v110
    v_exp_f32 v111, v111
    v_cvt_pk_bf16_f32 v50, v108, v109
    v_cvt_pk_bf16_f32 v51, v110, v111
    s_waitcnt lgkmcnt(0)
    v_mfma_f32_32x32x8bf16_1k v[88:103], v[36:37], v[20:21], v[88:103]
    v_exp_f32 v112, v112
    v_exp_f32 v113, v113
    v_exp_f32 v114, v114
    v_exp_f32 v115, v115
    v_cvt_pk_bf16_f32 v52, v112, v113
    v_cvt_pk_bf16_f32 v53, v114, v115
    v_mfma_f32_32x32x16_bf16 v[72:87], v[40:43], v[48:51], v[72:87]
    ds_read_b128 v[40:43], v10 offset:6144
    v_exp_f32 v116, v116
    v_exp_f32 v117, v117
    v_exp_f32 v118, v118
    v_exp_f32 v119, v119
    v_cvt_pk_bf16_f32 v54, v116, v117
    v_cvt_pk_bf16_f32 v55, v118, v119
    v_mfma_f32_32x32x16_bf16 v[104:119], v[32:35], v[24:27], 0
    ds_read_b128 v[32:35], v8 offset:9216
    v_exp_f32 v88, v88
    v_exp_f32 v89, v89
    v_exp_f32 v90, v90
    v_exp_f32 v91, v91
    v_cvt_pk_bf16_f32 v48, v88, v89
    v_cvt_pk_bf16_f32 v49, v90, v91
    v_mfma_f32_32x32x16_bf16 v[72:87], v[44:47], v[52:55], v[72:87]
    ds_read_b128 v[44:47], v14 offset:6144
    v_exp_f32 v92, v92
    v_exp_f32 v93, v93
    v_exp_f32 v94, v94
    v_exp_f32 v95, v95
    v_cvt_pk_bf16_f32 v50, v92, v93
    v_cvt_pk_bf16_f32 v51, v94, v95
    v_mfma_f32_32x32x8bf16_1k v[104:119], v[36:37], v[28:29], v[104:119]
    ds_read_b64 v[36:37], v9 offset:9216
    v_exp_f32 v96, v96
    v_exp_f32 v97, v97
    v_exp_f32 v98, v98
    v_exp_f32 v99, v99
    v_cvt_pk_bf16_f32 v52, v96, v97
    v_cvt_pk_bf16_f32 v53, v98, v99
    s_waitcnt lgkmcnt(3)
    v_mfma_f32_32x32x16_bf16 v[56:71], v[40:43], v[48:51], v[56:71]
    v_exp_f32 v100, v100
    v_exp_f32 v101, v101
    v_exp_f32 v102, v102
    v_exp_f32 v103, v103
    v_cvt_pk_bf16_f32 v54, v100, v101
    v_cvt_pk_bf16_f32 v55, v102, v103
    s_waitcnt lgkmcnt(1)
    v_mfma_f32_32x32x16_bf16 v[88:103], v[32:35], v[16:19], 0
    v_exp_f32 v104, v104
    v_exp_f32 v105, v105
    v_exp_f32 v106, v106
    v_exp_f32 v107, v107
    v_cvt_pk_bf16_f32 v48, v104, v105
    v_cvt_pk_bf16_f32 v49, v106, v107
    v_mfma_f32_32x32x16_bf16 v[56:71], v[44:47], v[52:55], v[56:71]
    v_exp_f32 v108, v108
    v_exp_f32 v109, v109
    v_exp_f32 v110, v110
    v_exp_f32 v111, v111
    v_cvt_pk_bf16_f32 v50, v108, v109
    v_cvt_pk_bf16_f32 v51, v110, v111
    s_waitcnt lgkmcnt(0)
    v_mfma_f32_32x32x8bf16_1k v[88:103], v[36:37], v[20:21], v[88:103]
    v_exp_f32 v112, v112
    v_exp_f32 v113, v113
    v_exp_f32 v114, v114
    v_exp_f32 v115, v115
    v_cvt_pk_bf16_f32 v52, v112, v113
    v_cvt_pk_bf16_f32 v53, v114, v115
    v_mfma_f32_32x32x16_bf16 v[72:87], v[40:43], v[48:51], v[72:87]
    ds_read_b128 v[40:43], v10 offset:9216
    v_exp_f32 v116, v116
    v_exp_f32 v117, v117
    v_exp_f32 v118, v118
    v_exp_f32 v119, v119
    s_waitcnt vmcnt(0)
    s_barrier
    s_add_u32 m0, s48, 49152
    s_add_u32 s49, s49, 40960
    v_cvt_pk_bf16_f32 v54, v116, v117
    v_cvt_pk_bf16_f32 v55, v118, v119
    v_mfma_f32_32x32x16_bf16 v[104:119], v[32:35], v[24:27], 0
    ds_read_b128 v[32:35], v8 offset:24576
    v_exp_f32 v88, v88
    v_exp_f32 v89, v89
    v_exp_f32 v90, v90
    v_exp_f32 v91, v91
    buffer_load_dwordx4 v5, s[28:31], s49 offen offset:0 sc1 lds
    v_cvt_pk_bf16_f32 v48, v88, v89
    v_cvt_pk_bf16_f32 v49, v90, v91
    v_mfma_f32_32x32x16_bf16 v[72:87], v[44:47], v[52:55], v[72:87]
    ds_read_b128 v[44:47], v14 offset:9216
    v_exp_f32 v92, v92
    v_exp_f32 v93, v93
    v_exp_f32 v94, v94
    v_exp_f32 v95, v95
    buffer_load_dwordx4 v5, s[28:31], s49 offen offset:1024 sc1 lds
    v_cvt_pk_bf16_f32 v50, v92, v93
    v_cvt_pk_bf16_f32 v51, v94, v95
    v_mfma_f32_32x32x8bf16_1k v[104:119], v[36:37], v[28:29], v[104:119]
    ds_read_b64 v[36:37], v9 offset:24576
    v_exp_f32 v96, v96
    v_exp_f32 v97, v97
    v_exp_f32 v98, v98
    v_exp_f32 v99, v99
    s_mov_b32 exec_hi, 0xffff
    buffer_load_dwordx4 v5, s[28:31], s49 offen offset:2048 sc1 lds
    s_mov_b32 exec_hi, -1
    v_cvt_pk_bf16_f32 v52, v96, v97
    v_cvt_pk_bf16_f32 v53, v98, v99
    s_waitcnt lgkmcnt(3)
    v_mfma_f32_32x32x16_bf16 v[56:71], v[40:43], v[48:51], v[56:71]
    v_exp_f32 v100, v100
    v_exp_f32 v101, v101
    v_exp_f32 v102, v102
    v_exp_f32 v103, v103
    v_cvt_pk_bf16_f32 v54, v100, v101
    v_cvt_pk_bf16_f32 v55, v102, v103
    s_waitcnt lgkmcnt(1)
    v_mfma_f32_32x32x16_bf16 v[88:103], v[32:35], v[16:19], 0
    v_exp_f32 v104, v104
    v_exp_f32 v105, v105
    v_exp_f32 v106, v106
    v_exp_f32 v107, v107
    v_cvt_pk_bf16_f32 v48, v104, v105
    v_cvt_pk_bf16_f32 v49, v106, v107
    v_mfma_f32_32x32x16_bf16 v[56:71], v[44:47], v[52:55], v[56:71]
    v_exp_f32 v108, v108
    v_exp_f32 v109, v109
    v_exp_f32 v110, v110
    v_exp_f32 v111, v111
    v_cvt_pk_bf16_f32 v50, v108, v109
    v_cvt_pk_bf16_f32 v51, v110, v111
    s_waitcnt lgkmcnt(0)
    v_mfma_f32_32x32x8bf16_1k v[88:103], v[36:37], v[20:21], v[88:103]
    v_exp_f32 v112, v112
    v_exp_f32 v113, v113
    v_exp_f32 v114, v114
    v_exp_f32 v115, v115
    v_cvt_pk_bf16_f32 v52, v112, v113
    v_cvt_pk_bf16_f32 v53, v114, v115
    v_mfma_f32_32x32x16_bf16 v[72:87], v[40:43], v[48:51], v[72:87]
    ds_read_b128 v[40:43], v10 offset:24576
    v_exp_f32 v116, v116
    v_exp_f32 v117, v117
    v_exp_f32 v118, v118
    v_exp_f32 v119, v119
    v_cvt_pk_bf16_f32 v54, v116, v117
    v_cvt_pk_bf16_f32 v55, v118, v119
    v_mfma_f32_32x32x16_bf16 v[104:119], v[32:35], v[24:27], 0
    ds_read_b128 v[32:35], v8 offset:27648
    v_exp_f32 v88, v88
    v_exp_f32 v89, v89
    v_exp_f32 v90, v90
    v_exp_f32 v91, v91
    v_cvt_pk_bf16_f32 v48, v88, v89
    v_cvt_pk_bf16_f32 v49, v90, v91
    v_mfma_f32_32x32x16_bf16 v[72:87], v[44:47], v[52:55], v[72:87]
    ds_read_b128 v[44:47], v14 offset:24576
    v_exp_f32 v92, v92
    v_exp_f32 v93, v93
    v_exp_f32 v94, v94
    v_exp_f32 v95, v95
    v_cvt_pk_bf16_f32 v50, v92, v93
    v_cvt_pk_bf16_f32 v51, v94, v95
    v_mfma_f32_32x32x8bf16_1k v[104:119], v[36:37], v[28:29], v[104:119]
    ds_read_b64 v[36:37], v9 offset:27648
    v_exp_f32 v96, v96
    v_exp_f32 v97, v97
    v_exp_f32 v98, v98
    v_exp_f32 v99, v99
    v_cvt_pk_bf16_f32 v52, v96, v97
    v_cvt_pk_bf16_f32 v53, v98, v99
    s_waitcnt lgkmcnt(3)
    v_mfma_f32_32x32x16_bf16 v[56:71], v[40:43], v[48:51], v[56:71]
    v_exp_f32 v100, v100
    v_exp_f32 v101, v101
    v_exp_f32 v102, v102
    v_exp_f32 v103, v103
    v_cvt_pk_bf16_f32 v54, v100, v101
    v_cvt_pk_bf16_f32 v55, v102, v103
    s_waitcnt lgkmcnt(1)
    v_mfma_f32_32x32x16_bf16 v[88:103], v[32:35], v[16:19], 0
    v_exp_f32 v104, v104
    v_exp_f32 v105, v105
    v_exp_f32 v106, v106
    v_exp_f32 v107, v107
    v_cvt_pk_bf16_f32 v48, v104, v105
    v_cvt_pk_bf16_f32 v49, v106, v107
    v_mfma_f32_32x32x16_bf16 v[56:71], v[44:47], v[52:55], v[56:71]
    v_exp_f32 v108, v108
    v_exp_f32 v109, v109
    v_exp_f32 v110, v110
    v_exp_f32 v111, v111
    v_cvt_pk_bf16_f32 v50, v108, v109
    v_cvt_pk_bf16_f32 v51, v110, v111
    s_waitcnt lgkmcnt(0)
    v_mfma_f32_32x32x8bf16_1k v[88:103], v[36:37], v[20:21], v[88:103]
    v_exp_f32 v112, v112
    v_exp_f32 v113, v113
    v_exp_f32 v114, v114
    v_exp_f32 v115, v115
    v_cvt_pk_bf16_f32 v52, v112, v113
    v_cvt_pk_bf16_f32 v53, v114, v115
    v_mfma_f32_32x32x16_bf16 v[72:87], v[40:43], v[48:51], v[72:87]
    ds_read_b128 v[40:43], v10 offset:27648
    v_exp_f32 v116, v116
    v_exp_f32 v117, v117
    v_exp_f32 v118, v118
    v_exp_f32 v119, v119
    v_cvt_pk_bf16_f32 v54, v116, v117
    v_cvt_pk_bf16_f32 v55, v118, v119
    v_mfma_f32_32x32x16_bf16 v[104:119], v[32:35], v[24:27], 0
    ds_read_b128 v[32:35], v8 offset:30720
    v_exp_f32 v88, v88
    v_exp_f32 v89, v89
    v_exp_f32 v90, v90
    v_exp_f32 v91, v91
    v_cvt_pk_bf16_f32 v48, v88, v89
    v_cvt_pk_bf16_f32 v49, v90, v91
    v_mfma_f32_32x32x16_bf16 v[72:87], v[44:47], v[52:55], v[72:87]
    ds_read_b128 v[44:47], v14 offset:27648
    v_exp_f32 v92, v92
    v_exp_f32 v93, v93
    v_exp_f32 v94, v94
    v_exp_f32 v95, v95
    v_cvt_pk_bf16_f32 v50, v92, v93
    v_cvt_pk_bf16_f32 v51, v94, v95
    v_mfma_f32_32x32x8bf16_1k v[104:119], v[36:37], v[28:29], v[104:119]
    ds_read_b64 v[36:37], v9 offset:30720
    v_exp_f32 v96, v96
    v_exp_f32 v97, v97
    v_exp_f32 v98, v98
    v_exp_f32 v99, v99
    v_cvt_pk_bf16_f32 v52, v96, v97
    v_cvt_pk_bf16_f32 v53, v98, v99
    s_waitcnt lgkmcnt(3)
    v_mfma_f32_32x32x16_bf16 v[56:71], v[40:43], v[48:51], v[56:71]
    v_exp_f32 v100, v100
    v_exp_f32 v101, v101
    v_exp_f32 v102, v102
    v_exp_f32 v103, v103
    v_cvt_pk_bf16_f32 v54, v100, v101
    v_cvt_pk_bf16_f32 v55, v102, v103
    s_waitcnt lgkmcnt(1)
    v_mfma_f32_32x32x16_bf16 v[88:103], v[32:35], v[16:19], 0
    v_exp_f32 v104, v104
    v_exp_f32 v105, v105
    v_exp_f32 v106, v106
    v_exp_f32 v107, v107
    v_cvt_pk_bf16_f32 v48, v104, v105
    v_cvt_pk_bf16_f32 v49, v106, v107
    v_mfma_f32_32x32x16_bf16 v[56:71], v[44:47], v[52:55], v[56:71]
    v_exp_f32 v108, v108
    v_exp_f32 v109, v109
    v_exp_f32 v110, v110
    v_exp_f32 v111, v111
    v_cvt_pk_bf16_f32 v50, v108, v109
    v_cvt_pk_bf16_f32 v51, v110, v111
    s_waitcnt lgkmcnt(0)
    v_mfma_f32_32x32x8bf16_1k v[88:103], v[36:37], v[20:21], v[88:103]
    v_exp_f32 v112, v112
    v_exp_f32 v113, v113
    v_exp_f32 v114, v114
    v_exp_f32 v115, v115
    v_cvt_pk_bf16_f32 v52, v112, v113
    v_cvt_pk_bf16_f32 v53, v114, v115
    v_mfma_f32_32x32x16_bf16 v[72:87], v[40:43], v[48:51], v[72:87]
    ds_read_b128 v[40:43], v10 offset:30720
    v_exp_f32 v116, v116
    v_exp_f32 v117, v117
    v_exp_f32 v118, v118
    v_exp_f32 v119, v119
    v_cvt_pk_bf16_f32 v54, v116, v117
    v_cvt_pk_bf16_f32 v55, v118, v119
    v_mfma_f32_32x32x16_bf16 v[104:119], v[32:35], v[24:27], 0
    ds_read_b128 v[32:35], v8 offset:33792
    v_exp_f32 v88, v88
    v_exp_f32 v89, v89
    v_exp_f32 v90, v90
    v_exp_f32 v91, v91
    v_cvt_pk_bf16_f32 v48, v88, v89
    v_cvt_pk_bf16_f32 v49, v90, v91
    v_mfma_f32_32x32x16_bf16 v[72:87], v[44:47], v[52:55], v[72:87]
    ds_read_b128 v[44:47], v14 offset:30720
    v_exp_f32 v92, v92
    v_exp_f32 v93, v93
    v_exp_f32 v94, v94
    v_exp_f32 v95, v95
    v_cvt_pk_bf16_f32 v50, v92, v93
    v_cvt_pk_bf16_f32 v51, v94, v95
    v_mfma_f32_32x32x8bf16_1k v[104:119], v[36:37], v[28:29], v[104:119]
    ds_read_b64 v[36:37], v9 offset:33792
    v_exp_f32 v96, v96
    v_exp_f32 v97, v97
    v_exp_f32 v98, v98
    v_exp_f32 v99, v99
    v_cvt_pk_bf16_f32 v52, v96, v97
    v_cvt_pk_bf16_f32 v53, v98, v99
    s_waitcnt lgkmcnt(3)
    v_mfma_f32_32x32x16_bf16 v[56:71], v[40:43], v[48:51], v[56:71]
    v_exp_f32 v100, v100
    v_exp_f32 v101, v101
    v_exp_f32 v102, v102
    v_exp_f32 v103, v103
    v_cvt_pk_bf16_f32 v54, v100, v101
    v_cvt_pk_bf16_f32 v55, v102, v103
    s_waitcnt lgkmcnt(1)
    v_mfma_f32_32x32x16_bf16 v[88:103], v[32:35], v[16:19], 0
    v_exp_f32 v104, v104
    v_exp_f32 v105, v105
    v_exp_f32 v106, v106
    v_exp_f32 v107, v107
    v_cvt_pk_bf16_f32 v48, v104, v105
    v_cvt_pk_bf16_f32 v49, v106, v107
    v_mfma_f32_32x32x16_bf16 v[56:71], v[44:47], v[52:55], v[56:71]
    v_exp_f32 v108, v108
    v_exp_f32 v109, v109
    v_exp_f32 v110, v110
    v_exp_f32 v111, v111
    v_cvt_pk_bf16_f32 v50, v108, v109
    v_cvt_pk_bf16_f32 v51, v110, v111
    s_waitcnt lgkmcnt(0)
    v_mfma_f32_32x32x8bf16_1k v[88:103], v[36:37], v[20:21], v[88:103]
    v_exp_f32 v112, v112
    v_exp_f32 v113, v113
    v_exp_f32 v114, v114
    v_exp_f32 v115, v115
    v_cvt_pk_bf16_f32 v52, v112, v113
    v_cvt_pk_bf16_f32 v53, v114, v115
    v_mfma_f32_32x32x16_bf16 v[72:87], v[40:43], v[48:51], v[72:87]
    ds_read_b128 v[40:43], v10 offset:33792
    v_exp_f32 v116, v116
    v_exp_f32 v117, v117
    v_exp_f32 v118, v118
    v_exp_f32 v119, v119
    s_waitcnt vmcnt(0)
    s_barrier
    s_add_u32 m0, s48, 0
    s_add_u32 s49, s49, 40960
    v_cvt_pk_bf16_f32 v54, v116, v117
    v_cvt_pk_bf16_f32 v55, v118, v119
    v_mfma_f32_32x32x16_bf16 v[104:119], v[32:35], v[24:27], 0
    ds_read_b128 v[32:35], v8 offset:49152
    v_exp_f32 v88, v88
    v_exp_f32 v89, v89
    v_exp_f32 v90, v90
    v_exp_f32 v91, v91
    buffer_load_dwordx4 v5, s[28:31], s49 offen offset:0 sc1 lds
    v_cvt_pk_bf16_f32 v48, v88, v89
    v_cvt_pk_bf16_f32 v49, v90, v91
    v_mfma_f32_32x32x16_bf16 v[72:87], v[44:47], v[52:55], v[72:87]
    ds_read_b128 v[44:47], v14 offset:33792
    v_exp_f32 v92, v92
    v_exp_f32 v93, v93
    v_exp_f32 v94, v94
    v_exp_f32 v95, v95
    buffer_load_dwordx4 v5, s[28:31], s49 offen offset:1024 sc1 lds
    v_cvt_pk_bf16_f32 v50, v92, v93
    v_cvt_pk_bf16_f32 v51, v94, v95
    v_mfma_f32_32x32x8bf16_1k v[104:119], v[36:37], v[28:29], v[104:119]
    ds_read_b64 v[36:37], v9 offset:49152
    v_exp_f32 v96, v96
    v_exp_f32 v97, v97
    v_exp_f32 v98, v98
    v_exp_f32 v99, v99
    s_mov_b32 exec_hi, 0xffff
    buffer_load_dwordx4 v5, s[28:31], s49 offen offset:2048 sc1 lds
    s_mov_b32 exec_hi, -1
    v_cvt_pk_bf16_f32 v52, v96, v97
    v_cvt_pk_bf16_f32 v53, v98, v99
    s_waitcnt lgkmcnt(3)
    v_mfma_f32_32x32x16_bf16 v[56:71], v[40:43], v[48:51], v[56:71]
    v_exp_f32 v100, v100
    v_exp_f32 v101, v101
    v_exp_f32 v102, v102
    v_exp_f32 v103, v103
    v_cvt_pk_bf16_f32 v54, v100, v101
    v_cvt_pk_bf16_f32 v55, v102, v103
    s_waitcnt lgkmcnt(1)
    v_mfma_f32_32x32x16_bf16 v[88:103], v[32:35], v[16:19], 0
    v_exp_f32 v104, v104
    v_exp_f32 v105, v105
    v_exp_f32 v106, v106
    v_exp_f32 v107, v107
    v_cvt_pk_bf16_f32 v48, v104, v105
    v_cvt_pk_bf16_f32 v49, v106, v107
    v_mfma_f32_32x32x16_bf16 v[56:71], v[44:47], v[52:55], v[56:71]
    v_exp_f32 v108, v108
    v_exp_f32 v109, v109
    v_exp_f32 v110, v110
    v_exp_f32 v111, v111
    v_cvt_pk_bf16_f32 v50, v108, v109
    v_cvt_pk_bf16_f32 v51, v110, v111
    s_waitcnt lgkmcnt(0)
    v_mfma_f32_32x32x8bf16_1k v[88:103], v[36:37], v[20:21], v[88:103]
    v_exp_f32 v112, v112
    v_exp_f32 v113, v113
    v_exp_f32 v114, v114
    v_exp_f32 v115, v115
    v_cvt_pk_bf16_f32 v52, v112, v113
    v_cvt_pk_bf16_f32 v53, v114, v115
    v_mfma_f32_32x32x16_bf16 v[72:87], v[40:43], v[48:51], v[72:87]
    ds_read_b128 v[40:43], v10 offset:49152
    v_exp_f32 v116, v116
    v_exp_f32 v117, v117
    v_exp_f32 v118, v118
    v_exp_f32 v119, v119
    v_cvt_pk_bf16_f32 v54, v116, v117
    v_cvt_pk_bf16_f32 v55, v118, v119
    v_mfma_f32_32x32x16_bf16 v[104:119], v[32:35], v[24:27], 0
    ds_read_b128 v[32:35], v8 offset:52224
    v_exp_f32 v88, v88
    v_exp_f32 v89, v89
    v_exp_f32 v90, v90
    v_exp_f32 v91, v91
    v_cvt_pk_bf16_f32 v48, v88, v89
    v_cvt_pk_bf16_f32 v49, v90, v91
    v_mfma_f32_32x32x16_bf16 v[72:87], v[44:47], v[52:55], v[72:87]
    ds_read_b128 v[44:47], v14 offset:49152
    v_exp_f32 v92, v92
    v_exp_f32 v93, v93
    v_exp_f32 v94, v94
    v_exp_f32 v95, v95
    v_cvt_pk_bf16_f32 v50, v92, v93
    v_cvt_pk_bf16_f32 v51, v94, v95
    v_mfma_f32_32x32x8bf16_1k v[104:119], v[36:37], v[28:29], v[104:119]
    ds_read_b64 v[36:37], v9 offset:52224
    v_exp_f32 v96, v96
    v_exp_f32 v97, v97
    v_exp_f32 v98, v98
    v_exp_f32 v99, v99
    v_cvt_pk_bf16_f32 v52, v96, v97
    v_cvt_pk_bf16_f32 v53, v98, v99
    s_waitcnt lgkmcnt(3)
    v_mfma_f32_32x32x16_bf16 v[56:71], v[40:43], v[48:51], v[56:71]
    v_exp_f32 v100, v100
    v_exp_f32 v101, v101
    v_exp_f32 v102, v102
    v_exp_f32 v103, v103
    v_cvt_pk_bf16_f32 v54, v100, v101
    v_cvt_pk_bf16_f32 v55, v102, v103
    s_waitcnt lgkmcnt(1)
    v_mfma_f32_32x32x16_bf16 v[88:103], v[32:35], v[16:19], 0
    v_exp_f32 v104, v104
    v_exp_f32 v105, v105
    v_exp_f32 v106, v106
    v_exp_f32 v107, v107
    v_cvt_pk_bf16_f32 v48, v104, v105
    v_cvt_pk_bf16_f32 v49, v106, v107
    v_mfma_f32_32x32x16_bf16 v[56:71], v[44:47], v[52:55], v[56:71]
    v_exp_f32 v108, v108
    v_exp_f32 v109, v109
    v_exp_f32 v110, v110
    v_exp_f32 v111, v111
    v_cvt_pk_bf16_f32 v50, v108, v109
    v_cvt_pk_bf16_f32 v51, v110, v111
    s_waitcnt lgkmcnt(0)
    v_mfma_f32_32x32x8bf16_1k v[88:103], v[36:37], v[20:21], v[88:103]
    v_exp_f32 v112, v112
    v_exp_f32 v113, v113
    v_exp_f32 v114, v114
    v_exp_f32 v115, v115
    v_cvt_pk_bf16_f32 v52, v112, v113
    v_cvt_pk_bf16_f32 v53, v114, v115
    v_mfma_f32_32x32x16_bf16 v[72:87], v[40:43], v[48:51], v[72:87]
    ds_read_b128 v[40:43], v10 offset:52224
    v_exp_f32 v116, v116
    v_exp_f32 v117, v117
    v_exp_f32 v118, v118
    v_exp_f32 v119, v119
    v_cvt_pk_bf16_f32 v54, v116, v117
    v_cvt_pk_bf16_f32 v55, v118, v119
    v_mfma_f32_32x32x16_bf16 v[104:119], v[32:35], v[24:27], 0
    ds_read_b128 v[32:35], v8 offset:55296
    v_exp_f32 v88, v88
    v_exp_f32 v89, v89
    v_exp_f32 v90, v90
    v_exp_f32 v91, v91
    v_cvt_pk_bf16_f32 v48, v88, v89
    v_cvt_pk_bf16_f32 v49, v90, v91
    v_mfma_f32_32x32x16_bf16 v[72:87], v[44:47], v[52:55], v[72:87]
    ds_read_b128 v[44:47], v14 offset:52224
    v_exp_f32 v92, v92
    v_exp_f32 v93, v93
    v_exp_f32 v94, v94
    v_exp_f32 v95, v95
    v_cvt_pk_bf16_f32 v50, v92, v93
    v_cvt_pk_bf16_f32 v51, v94, v95
    v_mfma_f32_32x32x8bf16_1k v[104:119], v[36:37], v[28:29], v[104:119]
    ds_read_b64 v[36:37], v9 offset:55296
    v_exp_f32 v96, v96
    v_exp_f32 v97, v97
    v_exp_f32 v98, v98
    v_exp_f32 v99, v99
    v_cvt_pk_bf16_f32 v52, v96, v97
    v_cvt_pk_bf16_f32 v53, v98, v99
    s_waitcnt lgkmcnt(3)
    v_mfma_f32_32x32x16_bf16 v[56:71], v[40:43], v[48:51], v[56:71]
    v_exp_f32 v100, v100
    v_exp_f32 v101, v101
    v_exp_f32 v102, v102
    v_exp_f32 v103, v103
    v_cvt_pk_bf16_f32 v54, v100, v101
    v_cvt_pk_bf16_f32 v55, v102, v103
    s_waitcnt lgkmcnt(1)
    v_mfma_f32_32x32x16_bf16 v[88:103], v[32:35], v[16:19], 0
    v_exp_f32 v104, v104
    v_exp_f32 v105, v105
    v_exp_f32 v106, v106
    v_exp_f32 v107, v107
    v_cvt_pk_bf16_f32 v48, v104, v105
    v_cvt_pk_bf16_f32 v49, v106, v107
    v_mfma_f32_32x32x16_bf16 v[56:71], v[44:47], v[52:55], v[56:71]
    v_exp_f32 v108, v108
    v_exp_f32 v109, v109
    v_exp_f32 v110, v110
    v_exp_f32 v111, v111
    v_cvt_pk_bf16_f32 v50, v108, v109
    v_cvt_pk_bf16_f32 v51, v110, v111
    s_waitcnt lgkmcnt(0)
    v_mfma_f32_32x32x8bf16_1k v[88:103], v[36:37], v[20:21], v[88:103]
    v_exp_f32 v112, v112
    v_exp_f32 v113, v113
    v_exp_f32 v114, v114
    v_exp_f32 v115, v115
    v_cvt_pk_bf16_f32 v52, v112, v113
    v_cvt_pk_bf16_f32 v53, v114, v115
    v_mfma_f32_32x32x16_bf16 v[72:87], v[40:43], v[48:51], v[72:87]
    ds_read_b128 v[40:43], v10 offset:55296
    v_exp_f32 v116, v116
    v_exp_f32 v117, v117
    v_exp_f32 v118, v118
    v_exp_f32 v119, v119
    v_cvt_pk_bf16_f32 v54, v116, v117
    v_cvt_pk_bf16_f32 v55, v118, v119
    v_mfma_f32_32x32x16_bf16 v[104:119], v[32:35], v[24:27], 0
    ds_read_b128 v[32:35], v8 offset:58368
    v_exp_f32 v88, v88
    v_exp_f32 v89, v89
    v_exp_f32 v90, v90
    v_exp_f32 v91, v91
    v_cvt_pk_bf16_f32 v48, v88, v89
    v_cvt_pk_bf16_f32 v49, v90, v91
    v_mfma_f32_32x32x16_bf16 v[72:87], v[44:47], v[52:55], v[72:87]
    ds_read_b128 v[44:47], v14 offset:55296
    v_exp_f32 v92, v92
    v_exp_f32 v93, v93
    v_exp_f32 v94, v94
    v_exp_f32 v95, v95
    v_cvt_pk_bf16_f32 v50, v92, v93
    v_cvt_pk_bf16_f32 v51, v94, v95
    v_mfma_f32_32x32x8bf16_1k v[104:119], v[36:37], v[28:29], v[104:119]
    ds_read_b64 v[36:37], v9 offset:58368
    v_exp_f32 v96, v96
    v_exp_f32 v97, v97
    v_exp_f32 v98, v98
    v_exp_f32 v99, v99
    v_cvt_pk_bf16_f32 v52, v96, v97
    v_cvt_pk_bf16_f32 v53, v98, v99
    s_waitcnt lgkmcnt(3)
    v_mfma_f32_32x32x16_bf16 v[56:71], v[40:43], v[48:51], v[56:71]
    v_exp_f32 v100, v100
    v_exp_f32 v101, v101
    v_exp_f32 v102, v102
    v_exp_f32 v103, v103
    v_cvt_pk_bf16_f32 v54, v100, v101
    v_cvt_pk_bf16_f32 v55, v102, v103
    s_waitcnt lgkmcnt(1)
    v_mfma_f32_32x32x16_bf16 v[88:103], v[32:35], v[16:19], 0
    v_exp_f32 v104, v104
    v_exp_f32 v105, v105
    v_exp_f32 v106, v106
    v_exp_f32 v107, v107
    v_cvt_pk_bf16_f32 v48, v104, v105
    v_cvt_pk_bf16_f32 v49, v106, v107
    v_mfma_f32_32x32x16_bf16 v[56:71], v[44:47], v[52:55], v[56:71]
    v_exp_f32 v108, v108
    v_exp_f32 v109, v109
    v_exp_f32 v110, v110
    v_exp_f32 v111, v111
    v_cvt_pk_bf16_f32 v50, v108, v109
    v_cvt_pk_bf16_f32 v51, v110, v111
    s_waitcnt lgkmcnt(0)
    v_mfma_f32_32x32x8bf16_1k v[88:103], v[36:37], v[20:21], v[88:103]
    v_exp_f32 v112, v112
    v_exp_f32 v113, v113
    v_exp_f32 v114, v114
    v_exp_f32 v115, v115
    v_cvt_pk_bf16_f32 v52, v112, v113
    v_cvt_pk_bf16_f32 v53, v114, v115
    v_mfma_f32_32x32x16_bf16 v[72:87], v[40:43], v[48:51], v[72:87]
    ds_read_b128 v[40:43], v10 offset:58368
    v_exp_f32 v116, v116
    v_exp_f32 v117, v117
    v_exp_f32 v118, v118
    v_exp_f32 v119, v119
    s_waitcnt vmcnt(0)
    s_barrier
    s_add_u32 m0, s48, 24576
    s_add_u32 s49, s49, 40960
    v_cvt_pk_bf16_f32 v54, v116, v117
    v_cvt_pk_bf16_f32 v55, v118, v119
    v_mfma_f32_32x32x16_bf16 v[104:119], v[32:35], v[24:27], 0
    ds_read_b128 v[32:35], v8 offset:0
    v_exp_f32 v88, v88
    v_exp_f32 v89, v89
    v_exp_f32 v90, v90
    v_exp_f32 v91, v91
    buffer_load_dwordx4 v5, s[28:31], s49 offen offset:0 sc1 lds
    v_cvt_pk_bf16_f32 v48, v88, v89
    v_cvt_pk_bf16_f32 v49, v90, v91
    v_mfma_f32_32x32x16_bf16 v[72:87], v[44:47], v[52:55], v[72:87]
    ds_read_b128 v[44:47], v14 offset:58368
    v_exp_f32 v92, v92
    v_exp_f32 v93, v93
    v_exp_f32 v94, v94
    v_exp_f32 v95, v95
    buffer_load_dwordx4 v5, s[28:31], s49 offen offset:1024 sc1 lds
    v_cvt_pk_bf16_f32 v50, v92, v93
    v_cvt_pk_bf16_f32 v51, v94, v95
    v_mfma_f32_32x32x8bf16_1k v[104:119], v[36:37], v[28:29], v[104:119]
    ds_read_b64 v[36:37], v9 offset:0
    v_exp_f32 v96, v96
    v_exp_f32 v97, v97
    v_exp_f32 v98, v98
    v_exp_f32 v99, v99
    s_mov_b32 exec_hi, 0xffff
    buffer_load_dwordx4 v5, s[28:31], s49 offen offset:2048 sc1 lds
    s_mov_b32 exec_hi, -1
    s_cmp_eq_u32 s26, 0
    s_cbranch_scc1 La_g5
La_nodma:
    v_cvt_pk_bf16_f32 v52, v96, v97
    v_cvt_pk_bf16_f32 v53, v98, v99
    s_waitcnt lgkmcnt(3)
    v_mfma_f32_32x32x16_bf16 v[56:71], v[40:43], v[48:51], v[56:71]
    v_exp_f32 v100, v100
    v_exp_f32 v101, v101
    v_exp_f32 v102, v102
    v_exp_f32 v103, v103
    v_cvt_pk_bf16_f32 v54, v100, v101
    v_cvt_pk_bf16_f32 v55, v102, v103
    s_waitcnt lgkmcnt(1)
    v_mfma_f32_32x32x16_bf16 v[88:103], v[32:35], v[16:19], 0
    v_exp_f32 v104, v104
    v_exp_f32 v105, v105
    v_exp_f32 v106, v106
    v_exp_f32 v107, v107
    v_cvt_pk_bf16_f32 v48, v104, v105
    v_cvt_pk_bf16_f32 v49, v106, v107
    v_mfma_f32_32x32x16_bf16 v[56:71], v[44:47], v[52:55], v[56:71]
    v_exp_f32 v108, v108
    v_exp_f32 v109, v109
    v_exp_f32 v110, v110
    v_exp_f32 v111, v111
    v_cvt_pk_bf16_f32 v50, v108, v109
    v_cvt_pk_bf16_f32 v51, v110, v111
    s_waitcnt lgkmcnt(0)
    v_mfma_f32_32x32x8bf16_1k v[88:103], v[36:37], v[20:21], v[88:103]
    v_exp_f32 v112, v112
    v_exp_f32 v113, v113
    v_exp_f32 v114, v114
    v_exp_f32 v115, v115
    v_cvt_pk_bf16_f32 v52, v112, v113
    v_cvt_pk_bf16_f32 v53, v114, v115
    v_mfma_f32_32x32x16_bf16 v[72:87], v[40:43], v[48:51], v[72:87]
    ds_read_b128 v[40:43], v10 offset:0
    v_exp_f32 v116, v116
    v_exp_f32 v117, v117
    v_exp_f32 v118, v118
    v_exp_f32 v119, v119
    v_cvt_pk_bf16_f32 v54, v116, v117
    v_cvt_pk_bf16_f32 v55, v118, v119
    v_mfma_f32_32x32x16_bf16 v[104:119], v[32:35], v[24:27], 0
    ds_read_b128 v[32:35], v8 offset:3072
    v_exp_f32 v88, v88
    v_exp_f32 v89, v89
    v_exp_f32 v90, v90
    v_exp_f32 v91, v91
    v_cvt_pk_bf16_f32 v48, v88, v89
    v_cvt_pk_bf16_f32 v49, v90, v91
    v_mfma_f32_32x32x16_bf16 v[72:87], v[44:47], v[52:55], v[72:87]
    ds_read_b128 v[44:47], v14 offset:0
    v_exp_f32 v92, v92
    v_exp_f32 v93, v93
    v_exp_f32 v94, v94
    v_exp_f32 v95, v95
    v_cvt_pk_bf16_f32 v50, v92, v93
    v_cvt_pk_bf16_f32 v51, v94, v95
    v_mfma_f32_32x32x8bf16_1k v[104:119], v[36:37], v[28:29], v[104:119]
    ds_read_b64 v[36:37], v9 offset:3072
    v_exp_f32 v96, v96
    v_exp_f32 v97, v97
    v_exp_f32 v98, v98
    v_exp_f32 v99, v99
    v_cvt_pk_bf16_f32 v52, v96, v97
    v_cvt_pk_bf16_f32 v53, v98, v99
    s_waitcnt lgkmcnt(3)
    v_mfma_f32_32x32x16_bf16 v[56:71], v[40:43], v[48:51], v[56:71]
    v_exp_f32 v100, v100
    v_exp_f32 v101, v101
    v_exp_f32 v102, v102
    v_exp_f32 v103, v103
    v_cvt_pk_bf16_f32 v54, v100, v101
    v_cvt_pk_bf16_f32 v55, v102, v103
    s_waitcnt lgkmcnt(1)
    v_mfma_f32_32x32x16_bf16 v[88:103], v[32:35], v[16:19], 0
    v_exp_f32 v104, v104
    v_exp_f32 v105, v105
    v_exp_f32 v106, v106
    v_exp_f32 v107, v107
    v_cvt_pk_bf16_f32 v48, v104, v105
    v_cvt_pk_bf16_f32 v49, v106, v107
    v_mfma_f32_32x32x16_bf16 v[56:71], v[44:47], v[52:55], v[56:71]
    v_exp_f32 v108, v108
    v_exp_f32 v109, v109
    v_exp_f32 v110, v110
    v_exp_f32 v111, v111
    v_cvt_pk_bf16_f32 v50, v108, v109
    v_cvt_pk_bf16_f32 v51, v110, v111
    s_waitcnt lgkmcnt(0)
    v_mfma_f32_32x32x8bf16_1k v[88:103], v[36:37], v[20:21], v[88:103]
    v_exp_f32 v112, v112
    v_exp_f32 v113, v113
    v_exp_f32 v114, v114
    v_exp_f32 v115, v115
    v_cvt_pk_bf16_f32 v52, v112, v113
    v_cvt_pk_bf16_f32 v53, v114, v115
    v_mfma_f32_32x32x16_bf16 v[72:87], v[40:43], v[48:51], v[72:87]
    ds_read_b128 v[40:43], v10 offset:3072
    v_exp_f32 v116, v116
    v_exp_f32 v117, v117
    v_exp_f32 v118, v118
    v_exp_f32 v119, v119
    v_cvt_pk_bf16_f32 v54, v116, v117
    v_cvt_pk_bf16_f32 v55, v118, v119
    v_mfma_f32_32x32x16_bf16 v[104:119], v[32:35], v[24:27], 0
    ds_read_b128 v[32:35], v8 offset:6144
    v_exp_f32 v88, v88
    v_exp_f32 v89, v89
    v_exp_f32 v90, v90
    v_exp_f32 v91, v91
    v_cvt_pk_bf16_f32 v48, v88, v89
    v_cvt_pk_bf16_f32 v49, v90, v91
    v_mfma_f32_32x32x16_bf16 v[72:87], v[44:47], v[52:55], v[72:87]
    ds_read_b128 v[44:47], v14 offset:3072
    v_exp_f32 v92, v92
    v_exp_f32 v93, v93
    v_exp_f32 v94, v94
    v_exp_f32 v95, v95
    v_cvt_pk_bf16_f32 v50, v92, v93
    v_cvt_pk_bf16_f32 v51, v94, v95
    v_mfma_f32_32x32x8bf16_1k v[104:119], v[36:37], v[28:29], v[104:119]
    ds_read_b64 v[36:37], v9 offset:6144
    v_exp_f32 v96, v96
    v_exp_f32 v97, v97
    v_exp_f32 v98, v98
    v_exp_f32 v99, v99
    v_cvt_pk_bf16_f32 v52, v96, v97
    v_cvt_pk_bf16_f32 v53, v98, v99
    s_waitcnt lgkmcnt(3)
    v_mfma_f32_32x32x16_bf16 v[56:71], v[40:43], v[48:51], v[56:71]
    v_exp_f32 v100, v100
    v_exp_f32 v101, v101
    v_exp_f32 v102, v102
    v_exp_f32 v103, v103
    v_cvt_pk_bf16_f32 v54, v100, v101
    v_cvt_pk_bf16_f32 v55, v102, v103
    s_waitcnt lgkmcnt(1)
    v_mfma_f32_32x32x16_bf16 v[88:103], v[32:35], v[16:19], 0
    v_exp_f32 v104, v104
    v_exp_f32 v105, v105
    v_exp_f32 v106, v106
    v_exp_f32 v107, v107
    v_cvt_pk_bf16_f32 v48, v104, v105
    v_cvt_pk_bf16_f32 v49, v106, v107
    v_mfma_f32_32x32x16_bf16 v[56:71], v[44:47], v[52:55], v[56:71]
    v_exp_f32 v108, v108
    v_exp_f32 v109, v109
    v_exp_f32 v110, v110
    v_exp_f32 v111, v111
    v_cvt_pk_bf16_f32 v50, v108, v109
    v_cvt_pk_bf16_f32 v51, v110, v111
    s_waitcnt lgkmcnt(0)
    v_mfma_f32_32x32x8bf16_1k v[88:103], v[36:37], v[20:21], v[88:103]
    v_exp_f32 v112, v112
    v_exp_f32 v113, v113
    v_exp_f32 v114, v114
    v_exp_f32 v115, v115
    v_cvt_pk_bf16_f32 v52, v112, v113
    v_cvt_pk_bf16_f32 v53, v114, v115
    v_mfma_f32_32x32x16_bf16 v[72:87], v[40:43], v[48:51], v[72:87]
    ds_read_b128 v[40:43], v10 offset:6144
    v_exp_f32 v116, v116
    v_exp_f32 v117, v117
    v_exp_f32 v118, v118
    v_exp_f32 v119, v119
    v_cvt_pk_bf16_f32 v54, v116, v117
    v_cvt_pk_bf16_f32 v55, v118, v119
    v_mfma_f32_32x32x16_bf16 v[104:119], v[32:35], v[24:27], 0
    ds_read_b128 v[32:35], v8 offset:9216
    v_exp_f32 v88, v88
    v_exp_f32 v89, v89
    v_exp_f32 v90, v90
    v_exp_f32 v91, v91
    v_cvt_pk_bf16_f32 v48, v88, v89
    v_cvt_pk_bf16_f32 v49, v90, v91
    v_mfma_f32_32x32x16_bf16 v[72:87], v[44:47], v[52:55], v[72:87]
    ds_read_b128 v[44:47], v14 offset:6144
    v_exp_f32 v92, v92
    v_exp_f32 v93, v93
    v_exp_f32 v94, v94
    v_exp_f32 v95, v95
    v_cvt_pk_bf16_f32 v50, v92, v93
    v_cvt_pk_bf16_f32 v51, v94, v95
    v_mfma_f32_32x32x8bf16_1k v[104:119], v[36:37], v[28:29], v[104:119]
    ds_read_b64 v[36:37], v9 offset:9216
    v_exp_f32 v96, v96
    v_exp_f32 v97, v97
    v_exp_f32 v98, v98
    v_exp_f32 v99, v99
    v_cvt_pk_bf16_f32 v52, v96, v97
    v_cvt_pk_bf16_f32 v53, v98, v99
    s_waitcnt lgkmcnt(3)
    v_mfma_f32_32x32x16_bf16 v[56:71], v[40:43], v[48:51], v[56:71]
    v_exp_f32 v100, v100
    v_exp_f32 v101, v101
    v_exp_f32 v102, v102
    v_exp_f32 v103, v103
    v_cvt_pk_bf16_f32 v54, v100, v101
    v_cvt_pk_bf16_f32 v55, v102, v103
    s_waitcnt lgkmcnt(1)
    v_mfma_f32_32x32x16_bf16 v[88:103], v[32:35], v[16:19], 0
    v_exp_f32 v104, v104
    v_exp_f32 v105, v105
    v_exp_f32 v106, v106
    v_exp_f32 v107, v107
    v_cvt_pk_bf16_f32 v48, v104, v105
    v_cvt_pk_bf16_f32 v49, v106, v107
    v_mfma_f32_32x32x16_bf16 v[56:71], v[44:47], v[52:55], v[56:71]
    v_exp_f32 v108, v108
    v_exp_f32 v109, v109
    v_exp_f32 v110, v110
    v_exp_f32 v111, v111
    v_cvt_pk_bf16_f32 v50, v108, v109
    v_cvt_pk_bf16_f32 v51, v110, v111
    s_waitcnt lgkmcnt(0)
    v_mfma_f32_32x32x8bf16_1k v[88:103], v[36:37], v[20:21], v[88:103]
    v_exp_f32 v112, v112
    v_exp_f32 v113, v113
    v_exp_f32 v114, v114
    v_exp_f32 v115, v115
    v_cvt_pk_bf16_f32 v52, v112, v113
    v_cvt_pk_bf16_f32 v53, v114, v115
    v_mfma_f32_32x32x16_bf16 v[72:87], v[40:43], v[48:51], v[72:87]
    ds_read_b128 v[40:43], v10 offset:9216
    v_exp_f32 v116, v116
    v_exp_f32 v117, v117
    v_exp_f32 v118, v118
    v_exp_f32 v119, v119
    s_waitcnt vmcnt(0)
    s_cmp_eq_u32 s26, 0
    s_cbranch_scc1 La_gchk
La_bar:
    s_barrier
    v_cvt_pk_bf16_f32 v54, v116, v117
    v_cvt_pk_bf16_f32 v55, v118, v119
    v_mfma_f32_32x32x16_bf16 v[104:119], v[32:35], v[24:27], 0
    ds_read_b128 v[32:35], v11 offset:24576
    v_exp_f32 v88, v88
    v_exp_f32 v89, v89
    v_exp_f32 v90, v90
    v_exp_f32 v91, v91
    buffer_load_dword v6, v6, s[36:39], s81 offen sc1
    v_cvt_pk_bf16_f32 v48, v88, v89
    v_cvt_pk_bf16_f32 v49, v90, v91
    v_mfma_f32_32x32x16_bf16 v[72:87], v[44:47], v[52:55], v[72:87]
    ds_read_b128 v[44:47], v14 offset:9216
    v_exp_f32 v92, v92
    v_exp_f32 v93, v93
    v_exp_f32 v94, v94
    v_exp_f32 v95, v95
    v_cvt_pk_bf16_f32 v50, v92, v93
    v_cvt_pk_bf16_f32 v51, v94, v95
    v_mfma_f32_32x32x8bf16_1k v[104:119], v[36:37], v[28:29], v[104:119]
    ds_read_b64 v[36:37], v12 offset:24576
    v_exp_f32 v96, v96
    v_exp_f32 v97, v97
    v_exp_f32 v98, v98
    v_exp_f32 v99, v99
    v_cvt_pk_bf16_f32 v52, v96, v97
    v_cvt_pk_bf16_f32 v53, v98, v99
    s_waitcnt lgkmcnt(3)
    v_mfma_f32_32x32x16_bf16 v[56:71], v[40:43], v[48:51], v[56:71]
    v_exp_f32 v100, v100
    v_exp_f32 v101, v101
    v_exp_f32 v102, v102
    v_exp_f32 v103, v103
    v_cvt_pk_bf16_f32 v54, v100, v101
    v_cvt_pk_bf16_f32 v55, v102, v103
    s_waitcnt lgkmcnt(1)
    v_mfma_f32_32x32x16_bf16 v[88:103], v[32:35], v[16:19], 0
    ds_read_b128 v[32:35], v11 offset:27648
    v_exp_f32 v104, v104
    v_exp_f32 v105, v105
    v_exp_f32 v106, v106
    v_exp_f32 v107, v107
    v_cvt_pk_bf16_f32 v48, v104, v105
    v_cvt_pk_bf16_f32 v49, v106, v107
    v_mfma_f32_32x32x16_bf16 v[56:71], v[44:47], v[52:55], v[56:71]
    v_exp_f32 v108, v108
    v_exp_f32 v109, v109
    v_exp_f32 v110, v110
    v_exp_f32 v111, v111
    v_cvt_pk_bf16_f32 v50, v108, v109
    v_cvt_pk_bf16_f32 v51, v110, v111
    s_waitcnt lgkmcnt(1)
    v_mfma_f32_32x32x8bf16_1k v[88:103], v[36:37], v[20:21], v[88:103]
    ds_read_b64 v[36:37], v12 offset:27648
    v_exp_f32 v112, v112
    v_exp_f32 v113, v113
    v_exp_f32 v114, v114
    v_exp_f32 v115, v115
    v_cvt_pk_bf16_f32 v52, v112, v113
    v_cvt_pk_bf16_f32 v53, v114, v115
    v_mfma_f32_32x32x16_bf16 v[72:87], v[40:43], v[48:51], v[72:87]
    ds_read_b128 v[40:43], v13 offset:24576
    v_exp_f32 v116, v116
    v_exp_f32 v117, v117
    v_exp_f32 v118, v118
    v_exp_f32 v119, v119
    v_cvt_pk_bf16_f32 v54, v116, v117
    v_cvt_pk_bf16_f32 v55, v118, v119
    s_waitcnt lgkmcnt(2)
    v_mfma_f32_32x32x16_bf16 v[104:119], v[32:35], v[16:19], 0
    ds_read_b128 v[32:35], v11 offset:30720
    v_exp_f32 v88, v88
    v_exp_f32 v89, v89
    v_exp_f32 v90, v90
    v_exp_f32 v91, v91
    v_cvt_pk_bf16_f32 v48, v88, v89
    v_cvt_pk_bf16_f32 v49, v90, v91
    v_mfma_f32_32x32x16_bf16 v[72:87], v[44:47], v[52:55], v[72:87]
    ds_read_b128 v[44:47], v15 offset:24576
    v_exp_f32 v92, v92
    v_exp_f32 v93, v93
    v_exp_f32 v94, v94
    v_exp_f32 v95, v95
    v_cvt_pk_bf16_f32 v50, v92, v93
    v_cvt_pk_bf16_f32 v51, v94, v95
    s_waitcnt lgkmcnt(2)
    v_mfma_f32_32x32x8bf16_1k v[104:119], v[36:37], v[20:21], v[104:119]
    ds_read_b64 v[36:37], v12 offset:30720
    v_exp_f32 v96, v96
    v_exp_f32 v97, v97
    v_exp_f32 v98, v98
    v_exp_f32 v99, v99
    s_mul_i32 s46, s26, 3072
    s_xor_b32 s47, s26, 4
    s_mul_i32 s47, s47, 3072
    v_add_u32 v120, s46, v5
    v_add_u32 v121, s47, v5
    v_cvt_pk_bf16_f32 v52, v96, v97
    v_cvt_pk_bf16_f32 v53, v98, v99
    v_mfma_f32_32x32x16_bf16 v[56:71], v[40:43], v[48:51], v[56:71]
    ds_read_b128 v[40:43], v13 offset:27648
    v_exp_f32 v100, v100
    v_exp_f32 v101, v101
    v_exp_f32 v102, v102
    v_exp_f32 v103, v103
    v_cvt_pk_bf16_f32 v54, v100, v101
    v_cvt_pk_bf16_f32 v55, v102, v103
    s_waitcnt lgkmcnt(2)
    v_mfma_f32_32x32x16_bf16 v[88:103], v[32:35], v[16:19], 0
    ds_read_b128 v[32:35], v11 offset:33792
    v_exp_f32 v104, v104
    v_exp_f32 v105, v105
    v_exp_f32 v106, v106
    v_exp_f32 v107, v107
    v_cvt_pk_bf16_f32 v48, v104, v105
    v_cvt_pk_bf16_f32 v49, v106, v107
    v_mfma_f32_32x32x16_bf16 v[56:71], v[44:47], v[52:55], v[56:71]
    ds_read_b128 v[44:47], v15 offset:27648
    v_exp_f32 v108, v108
    v_exp_f32 v109, v109
    v_exp_f32 v110, v110
    v_exp_f32 v111, v111
    ds_write_b128 v120, v[72:75] offset:49152
    v_cvt_pk_bf16_f32 v50, v108, v109
    v_cvt_pk_bf16_f32 v51, v110, v111
    s_waitcnt lgkmcnt(3)
    v_mfma_f32_32x32x8bf16_1k v[88:103], v[36:37], v[20:21], v[88:103]
    ds_read_b64 v[36:37], v12 offset:33792
    v_exp_f32 v112, v112
    v_exp_f32 v113, v113
    v_exp_f32 v114, v114
    v_exp_f32 v115, v115
    ds_write_b128 v120, v[76:79] offset:50176
    v_cvt_pk_bf16_f32 v52, v112, v113
    v_cvt_pk_bf16_f32 v53, v114, v115
    v_mfma_f32_32x32x16_bf16 v[56:71], v[40:43], v[48:51], v[56:71]
    ds_read_b128 v[40:43], v13 offset:30720
    v_exp_f32 v116, v116
    v_exp_f32 v117, v117
    v_exp_f32 v118, v118
    v_exp_f32 v119, v119
    ds_write_b128 v120, v[80:83] offset:51200
    v_cvt_pk_bf16_f32 v54, v116, v117
    v_cvt_pk_bf16_f32 v55, v118, v119
    s_waitcnt lgkmcnt(4)
    v_mfma_f32_32x32x16_bf16 v[104:119], v[32:35], v[16:19], 0
    ds_read_b128 v[32:35], v11 offset:36864
    v_exp_f32 v88, v88
    v_exp_f32 v89, v89
    v_exp_f32 v90, v90
    v_exp_f32 v91, v91
    v_cvt_pk_bf16_f32 v48, v88, v89
    v_cvt_pk_bf16_f32 v49, v90, v91
    v_mfma_f32_32x32x16_bf16 v[56:71], v[44:47], v[52:55], v[56:71]
    ds_read_b128 v[44:47], v15 offset:30720
    v_exp_f32 v92, v92
    v_exp_f32 v93, v93
    v_exp_f32 v94, v94
    v_exp_f32 v95, v95
    v_cvt_pk_bf16_f32 v50, v92, v93
    v_cvt_pk_bf16_f32 v51, v94, v95
    s_waitcnt lgkmcnt(2)
    v_mfma_f32_32x32x8bf16_1k v[104:119], v[36:37], v[20:21], v[104:119]
    ds_read_b64 v[36:37], v12 offset:36864
    v_exp_f32 v96, v96
    v_exp_f32 v97, v97
    v_exp_f32 v98, v98
    v_exp_f32 v99, v99
    v_cvt_pk_bf16_f32 v52, v96, v97
    v_cvt_pk_bf16_f32 v53, v98, v99
    v_mfma_f32_32x32x16_bf16 v[56:71], v[40:43], v[48:51], v[56:71]
    ds_read_b128 v[40:43], v13 offset:33792
    v_exp_f32 v100, v100
    v_exp_f32 v101, v101
    v_exp_f32 v102, v102
    v_exp_f32 v103, v103
    v_cvt_pk_bf16_f32 v54, v100, v101
    v_cvt_pk_bf16_f32 v55, v102, v103
    s_waitcnt lgkmcnt(2)
    v_mfma_f32_32x32x16_bf16 v[88:103], v[32:35], v[16:19], 0
    ds_read_b128 v[32:35], v11 offset:39936
    v_exp_f32 v104, v104
    v_exp_f32 v105, v105
    v_exp_f32 v106, v106
    v_exp_f32 v107, v107
    v_cvt_pk_bf16_f32 v48, v104, v105
    v_cvt_pk_bf16_f32 v49, v106, v107
    v_mfma_f32_32x32x16_bf16 v[56:71], v[44:47], v[52:55], v[56:71]
    ds_read_b128 v[44:47], v15 offset:33792
    v_exp_f32 v108, v108
    v_exp_f32 v109, v109
    v_exp_f32 v110, v110
    v_exp_f32 v111, v111
    v_cvt_pk_bf16_f32 v50, v108, v109
    v_cvt_pk_bf16_f32 v51, v110, v111
    s_waitcnt lgkmcnt(2)
    v_mfma_f32_32x32x8bf16_1k v[88:103], v[36:37], v[20:21], v[88:103]
    ds_read_b64 v[36:37], v12 offset:39936
    v_exp_f32 v112, v112
    v_exp_f32 v113, v113
    v_exp_f32 v114, v114
    v_exp_f32 v115, v115
    v_cvt_pk_bf16_f32 v52, v112, v113
    v_cvt_pk_bf16_f32 v53, v114, v115
    v_mfma_f32_32x32x16_bf16 v[56:71], v[40:43], v[48:51], v[56:71]
    ds_read_b128 v[40:43], v13 offset:36864
    v_exp_f32 v116, v116
    v_exp_f32 v117, v117
    v_exp_f32 v118, v118
    v_exp_f32 v119, v119
    v_cvt_pk_bf16_f32 v54, v116, v117
    v_cvt_pk_bf16_f32 v55, v118, v119
    s_waitcnt lgkmcnt(2)
    v_mfma_f32_32x32x16_bf16 v[104:119], v[32:35], v[16:19], 0
    ds_read_b128 v[32:35], v11 offset:43008
    v_exp_f32 v88, v88
    v_exp_f32 v89, v89
    v_exp_f32 v90, v90
    v_exp_f32 v91, v91
    v_cvt_pk_bf16_f32 v48, v88, v89
    v_cvt_pk_bf16_f32 v49, v90, v91
    v_mfma_f32_32x32x16_bf16 v[56:71], v[44:47], v[52:55], v[56:71]
    ds_read_b128 v[44:47], v15 offset:36864
    v_exp_f32 v92, v92
    v_exp_f32 v93, v93
    v_exp_f32 v94, v94
    v_exp_f32 v95, v95
    v_cvt_pk_bf16_f32 v50, v92, v93
    v_cvt_pk_bf16_f32 v51, v94, v95
    s_waitcnt lgkmcnt(2)
    v_mfma_f32_32x32x8bf16_1k v[104:119], v[36:37], v[20:21], v[104:119]
    ds_read_b64 v[36:37], v12 offset:43008
    v_exp_f32 v96, v96
    v_exp_f32 v97, v97
    v_exp_f32 v98, v98
    v_exp_f32 v99, v99
    v_cvt_pk_bf16_f32 v52, v96, v97
    v_cvt_pk_bf16_f32 v53, v98, v99
    v_mfma_f32_32x32x16_bf16 v[56:71], v[40:43], v[48:51], v[56:71]
    ds_read_b128 v[40:43], v13 offset:39936
    v_exp_f32 v100, v100
    v_exp_f32 v101, v101
    v_exp_f32 v102, v102
    v_exp_f32 v103, v103
    v_cvt_pk_bf16_f32 v54, v100, v101
    v_cvt_pk_bf16_f32 v55, v102, v103
    s_waitcnt lgkmcnt(2)
    v_mfma_f32_32x32x16_bf16 v[88:103], v[32:35], v[16:19], 0
    ds_read_b128 v[32:35], v11 offset:46080
    v_exp_f32 v104, v104
    v_exp_f32 v105, v105
    v_exp_f32 v106, v106
    v_exp_f32 v107, v107
    v_cvt_pk_bf16_f32 v48, v104, v105
    v_cvt_pk_bf16_f32 v49, v106, v107
    v_mfma_f32_32x32x16_bf16 v[56:71], v[44:47], v[52:55], v[56:71]
    ds_read_b128 v[44:47], v15 offset:39936
    v_exp_f32 v108, v108
    v_exp_f32 v109, v109
    v_exp_f32 v110, v110
    v_exp_f32 v111, v111
    v_cvt_pk_bf16_f32 v50, v108, v109
    v_cvt_pk_bf16_f32 v51, v110, v111
    s_waitcnt lgkmcnt(2)
    v_mfma_f32_32x32x8bf16_1k v[88:103], v[36:37], v[20:21], v[88:103]
    ds_read_b64 v[36:37], v12 offset:46080
    v_exp_f32 v112, v112
    v_exp_f32 v113, v113
    v_exp_f32 v114, v114
    v_exp_f32 v115, v115
    v_cvt_pk_bf16_f32 v52, v112, v113
    v_cvt_pk_bf16_f32 v53, v114, v115
    v_mfma_f32_32x32x16_bf16 v[56:71], v[40:43], v[48:51], v[56:71]
    ds_read_b128 v[40:43], v13 offset:43008
    v_exp_f32 v116, v116
    v_exp_f32 v117, v117
    v_exp_f32 v118, v118
    v_exp_f32 v119, v119
    s_waitcnt vmcnt(0)
    s_barrier
    ds_read_b128 v[72:75], v121 offset:49152
    ds_read_b128 v[76:79], v121 offset:50176
    ds_read_b128 v[80:83], v121 offset:51200
    v_cvt_pk_bf16_f32 v54, v116, v117
    v_cvt_pk_bf16_f32 v55, v118, v119
    s_waitcnt lgkmcnt(5)
    v_mfma_f32_32x32x16_bf16 v[104:119], v[32:35], v[16:19], 0
    v_exp_f32 v88, v88
    v_exp_f32 v89, v89
    v_exp_f32 v90, v90
    v_exp_f32 v91, v91
    v_cvt_pk_bf16_f32 v48, v88, v89
    v_cvt_pk_bf16_f32 v49, v90, v91
    v_mfma_f32_32x32x16_bf16 v[56:71], v[44:47], v[52:55], v[56:71]
    ds_read_b128 v[44:47], v15 offset:43008
    v_exp_f32 v92, v92
    v_exp_f32 v93, v93
    v_exp_f32 v94, v94
    v_exp_f32 v95, v95
    v_cvt_pk_bf16_f32 v50, v92, v93
    v_cvt_pk_bf16_f32 v51, v94, v95
    s_waitcnt lgkmcnt(1)
    v_mfma_f32_32x32x8bf16_1k v[104:119], v[36:37], v[20:21], v[104:119]
    v_exp_f32 v96, v96
    v_exp_f32 v97, v97
    v_exp_f32 v98, v98
    v_exp_f32 v99, v99
    v_cvt_pk_bf16_f32 v52, v96, v97
    v_cvt_pk_bf16_f32 v53, v98, v99
    v_mfma_f32_32x32x16_bf16 v[56:71], v[40:43], v[48:51], v[56:71]
    ds_read_b128 v[40:43], v13 offset:46080
    v_exp_f32 v100, v100
    v_exp_f32 v101, v101
    v_exp_f32 v102, v102
    v_exp_f32 v103, v103
    v_cvt_pk_bf16_f32 v54, v100, v101
    v_cvt_pk_bf16_f32 v55, v102, v103
    s_waitcnt lgkmcnt(1)
    v_exp_f32 v104, v104
    v_exp_f32 v105, v105
    v_exp_f32 v106, v106
    v_exp_f32 v107, v107
    v_cvt_pk_bf16_f32 v48, v104, v105
    v_cvt_pk_bf16_f32 v49, v106, v107
    v_mfma_f32_32x32x16_bf16 v[56:71], v[44:47], v[52:55], v[56:71]
    ds_read_b128 v[44:47], v15 offset:46080
    v_exp_f32 v108, v108
    v_exp_f32 v109, v109
    v_exp_f32 v110, v110
    v_exp_f32 v111, v111
    v_cvt_pk_bf16_f32 v50, v108, v109
    v_cvt_pk_bf16_f32 v51, v110, v111
    s_waitcnt lgkmcnt(1)
    v_exp_f32 v112, v112
    v_exp_f32 v113, v113
    v_exp_f32 v114, v114
    v_exp_f32 v115, v115
    v_cvt_pk_bf16_f32 v52, v112, v113
    v_cvt_pk_bf16_f32 v53, v114, v115
    v_mfma_f32_32x32x16_bf16 v[56:71], v[40:43], v[48:51], v[56:71]
    v_exp_f32 v116, v116
    v_exp_f32 v117, v117
    v_exp_f32 v118, v118
    v_exp_f32 v119, v119
    v_cvt_pk_bf16_f32 v54, v116, v117
    v_cvt_pk_bf16_f32 v55, v118, v119
    s_setprio 3
    s_waitcnt lgkmcnt(0)
    v_mfma_f32_32x32x16_bf16 v[56:71], v[44:47], v[52:55], v[56:71]
    s_mov_b32 s51, 0x71800000
    s_mov_b32 s52, 0x30800000
    s_mov_b32 s48, 0x7e800000
    s_nop 8
    v_pk_add_f32 v[64:65], v[64:65], v[80:81]
    v_pk_add_f32 v[66:67], v[66:67], v[82:83]
    v_pk_add_f32 v[56:57], v[56:57], v[72:73]
    v_pk_add_f32 v[58:59], v[58:59], v[74:75]
    v_pk_add_f32 v[60:61], v[60:61], v[76:77]
    v_pk_add_f32 v[62:63], v[62:63], v[78:79]
La_fin:
    s_nop 6
    v_mov_b32 v120, v64
    v_mov_b32 v121, v64
    s_nop 1
    v_permlane32_swap_b32 v120, v121
    s_cmp_lg_u32 s50, 8
    s_cbranch_scc1 La_ok
    v_add_f32 v104, abs(v56), abs(v57)
    v_add_f32 v105, abs(v58), abs(v59)
    v_add_f32 v106, abs(v60), abs(v61)
    v_add_f32 v107, abs(v62), abs(v63)
    v_add_f32 v108, abs(v64), abs(v65)
    v_add_f32 v109, abs(v66), abs(v67)
    v_add_f32 v104, v104, v107
    v_add_f32 v105, v105, v108
    v_add_f32 v106, v106, v109
    v_cmp_nlt_f32 s[60:61], v121, s51
    v_add_f32 v104, v104, v105
    v_cmp_ngt_f32 s[62:63], v121, s52
    v_add_f32 v104, v104, v106
    s_or_b64 s[62:63], s[62:63], s[60:61]
    v_cmp_nlt_f32 s[60:61], v104, s48
    s_nop 0
    s_or_b64 s[62:63], s[62:63], s[60:61]
    s_cbranch_scc1 La_slow
La_ok:
    v_rcp_f32 v122, v121
    s_nop 0
    v_mul_f32 v122, v122, v6
    v_pk_mul_f32 v[56:57], v[56:57], v[122:123] op_sel_hi:[1,0]
    v_pk_mul_f32 v[58:59], v[58:59], v[122:123] op_sel_hi:[1,0]
    v_pk_mul_f32 v[60:61], v[60:61], v[122:123] op_sel_hi:[1,0]
    v_pk_mul_f32 v[62:63], v[62:63], v[122:123] op_sel_hi:[1,0]
    v_pk_mul_f32 v[64:65], v[64:65], v[122:123] op_sel_hi:[1,0]
    v_pk_mul_f32 v[66:67], v[66:67], v[122:123] op_sel_hi:[1,0]
    v_cvt_pk_bf16_f32 v48, v56, v57
    v_cvt_pk_bf16_f32 v49, v58, v59
    v_cvt_pk_bf16_f32 v50, v60, v61
    v_cvt_pk_bf16_f32 v51, v62, v63
    v_cvt_pk_bf16_f32 v52, v64, v65
    v_cvt_pk_bf16_f32 v53, v66, v67
    buffer_store_dwordx4 v[48:51], v125, s[40:43], s56 offen sc1
    s_mov_b64 exec, s[54:55]
    buffer_store_dwordx2 v[52:53], v124, s[40:43], s59 offen sc1
    s_mov_b64 exec, -1
La_sg:
    s_waitcnt vmcnt(0)
    s_barrier
    s_cmp_lg_u32 s26, 0
    s_cbranch_scc1 La_sig
    v_mov_b32 v1, 1
    v_lshlrev_b32 v7, 8, v2
    s_mov_b64 exec, 1
    buffer_atomic_add v1, v7, s[76:79], s57 offen sc1
    s_mov_b64 exec, -1
La_sig:
    s_endpgm
La_g5:
    v_mov_b32 v7, 0
    buffer_load_dword v1, v7, s[76:79], s80 offen sc1
    s_branch La_nodma
La_gchk:
    s_mov_b32 s62, 0
La_gp:
    v_readfirstlane_b32 s63, v1
    s_add_u32 s62, s62, 1
    s_cmp_ge_u32 s63, 16
    s_cbranch_scc1 La_bar
    v_mov_b32 v7, 0
    s_sleep 1
    buffer_load_dword v1, v7, s[76:79], s80 offen sc1
    s_waitcnt vmcnt(0)
    s_cmp_lt_u32 s62, 0x200000
    s_cbranch_scc1 La_gp
    s_branch La_bar
La_slow:
    s_mov_b32 s50, 9
    s_mul_i32 s49, s65, 2304
    v_cndmask_b32 v20, 0, v20, s[54:55]
    v_mov_b32 v14, 0xff7fffff
    v_mov_b32 v56, 0
    v_mov_b32 v57, 0
    v_mov_b32 v58, 0
    v_mov_b32 v59, 0
    v_mov_b32 v60, 0
    v_mov_b32 v61, 0
    v_mov_b32 v62, 0
    v_mov_b32 v63, 0
    v_mov_b32 v64, 0
    v_mov_b32 v65, 0
    v_mov_b32 v66, 0
    v_mov_b32 v67, 0
    v_mov_b32 v68, 0
    v_mov_b32 v69, 0
    v_mov_b32 v70, 0
    v_mov_b32 v71, 0
    s_cmp_eq_u32 s65, 0
    s_mov_b32 s46, 1792
    s_cmov_b32 s46, 0
    s_mov_b32 s47, 8
    s_cmov_b32 s47, 2304
    s_mov_b32 s51, 512
    s_cmov_b32 s51, 1024
    s_mov_b32 s60, 0xfffff
    s_mov_b32 s61, 0xfffff
    v_add_u32 v8, s46, v5
    v_lshlrev_b32 v9, 4, v3
    v_add_u32 v9, s47, v9
    v_lshrrev_b32 v1, 2, v3
    v_xor_b32 v10, v1, v4
    v_and_b32 v10, 3, v10
    v_lshlrev_b32 v10, 6, v10
    v_lshl_add_u32 v10, v1, 8, v10
    v_and_b32 v1, 3, v3
    v_lshl_add_u32 v10, v1, 4, v10
    v_xor_b32 v13, 128, v10
    v_add_u32 v10, s51, v10
    v_add_u32 v13, s51, v13
    s_mov_b32 s52, 0
    v_cmp_eq_u32 vcc, 20, v3
    v_mov_b32 v1, 0x3f803f80
    s_nop 0
    v_cndmask_b32 v40, 0, v1, vcc
    v_cndmask_b32 v41, 0, v1, vcc
    v_cndmask_b32 v42, 0, v1, vcc
    v_cndmask_b32 v43, 0, v1, vcc
    v_cndmask_b32 v44, 0, v1, vcc
    v_cndmask_b32 v45, 0, v1, vcc
    v_cndmask_b32 v46, 0, v1, vcc
    v_cndmask_b32 v47, 0, v1, vcc
La_sloop:
    buffer_load_dwordx4 v[32:35], v8, s[28:31], s49 offen sc1
    buffer_load_dwordx2 v[36:37], v9, s[28:31], s49 offen sc1
    s_mov_b64 exec, s[60:61]
    buffer_load_dwordx4 v[40:43], v10, s[28:31], s49 offen sc1
    buffer_load_dwordx4 v[44:47], v13, s[28:31], s49 offen sc1
    s_mov_b64 exec, -1
    s_waitcnt vmcnt(0)
    v_mfma_f32_32x32x16_bf16 v[88:103], v[32:35], v[16:19], 0
    v_mfma_f32_32x32x8bf16_1k v[88:103], v[36:37], v[20:21], v[88:103]
    s_nop 11
    v_max3_f32 v15, v88, v89, v14
    v_max3_f32 v15, v15, v90, v91
    v_max3_f32 v15, v15, v92, v93
    v_max3_f32 v15, v15, v94, v95
    v_max3_f32 v15, v15, v96, v97
    v_max3_f32 v15, v15, v98, v99
    v_max3_f32 v15, v15, v100, v101
    v_max3_f32 v15, v15, v102, v103
    v_mov_b32 v7, v15
    s_nop 1
    v_permlane32_swap_b32 v15, v7
    v_max_f32 v15, v15, v7
    v_sub_f32 v7, v14, v15
    v_exp_f32 v7, v7
    v_mov_b32 v14, v15
    v_sub_f32 v88, v88, v15
    v_exp_f32 v88, v88
    v_mul_f32 v56, v56, v7
    v_sub_f32 v89, v89, v15
    v_exp_f32 v89, v89
    v_mul_f32 v57, v57, v7
    v_sub_f32 v90, v90, v15
    v_exp_f32 v90, v90
    v_mul_f32 v58, v58, v7
    v_sub_f32 v91, v91, v15
    v_exp_f32 v91, v91
    v_mul_f32 v59, v59, v7
    v_sub_f32 v92, v92, v15
    v_exp_f32 v92, v92
    v_mul_f32 v60, v60, v7
    v_sub_f32 v93, v93, v15
    v_exp_f32 v93, v93
    v_mul_f32 v61, v61, v7
    v_sub_f32 v94, v94, v15
    v_exp_f32 v94, v94
    v_mul_f32 v62, v62, v7
    v_sub_f32 v95, v95, v15
    v_exp_f32 v95, v95
    v_mul_f32 v63, v63, v7
    v_sub_f32 v96, v96, v15
    v_exp_f32 v96, v96
    v_mul_f32 v64, v64, v7
    v_sub_f32 v97, v97, v15
    v_exp_f32 v97, v97
    v_mul_f32 v65, v65, v7
    v_sub_f32 v98, v98, v15
    v_exp_f32 v98, v98
    v_mul_f32 v66, v66, v7
    v_sub_f32 v99, v99, v15
    v_exp_f32 v99, v99
    v_mul_f32 v67, v67, v7
    v_sub_f32 v100, v100, v15
    v_exp_f32 v100, v100
    v_mul_f32 v68, v68, v7
    v_sub_f32 v101, v101, v15
    v_exp_f32 v101, v101
    v_mul_f32 v69, v69, v7
    v_sub_f32 v102, v102, v15
    v_exp_f32 v102, v102
    v_mul_f32 v70, v70, v7
    v_sub_f32 v103, v103, v15
    v_exp_f32 v103, v103
    v_mul_f32 v71, v71, v7
    v_cvt_pk_bf16_f32 v48, v88, v89
    v_cvt_pk_bf16_f32 v49, v90, v91
    v_cvt_pk_bf16_f32 v50, v92, v93
    v_cvt_pk_bf16_f32 v51, v94, v95
    v_cvt_pk_bf16_f32 v52, v96, v97
    v_cvt_pk_bf16_f32 v53, v98, v99
    v_cvt_pk_bf16_f32 v54, v100, v101
    v_cvt_pk_bf16_f32 v55, v102, v103
    v_mfma_f32_32x32x16_bf16 v[56:71], v[40:43], v[48:51], v[56:71]
    s_nop 0
    v_mfma_f32_32x32x16_bf16 v[56:71], v[44:47], v[52:55], v[56:71]
    s_add_u32 s49, s49, 5120
    s_add_u32 s52, s52, 1
    s_cmp_lt_u32 s52, 64
    s_cbranch_scc1 La_sloop
    s_branch La_fin
Lm_g:
    s_cmp_ge_u32 s2, 512
    s_cbranch_scc1 Lm_end
    s_setprio 2
    s_sub_u32 s54, s2, 256
    s_waitcnt lgkmcnt(0)
    s_add_u32 s76, s24, 9502720
    s_addc_u32 s77, s25, 0
    s_mov_b32 s78, 65536
    s_mov_b32 s79, 0x00020000
    s_mov_b32 s84, s22
    s_mov_b32 s85, s23
    s_mov_b32 s86, 256
    s_mov_b32 s87, 0x00020000
    s_add_u32 s80, s24, 20971520
    s_addc_u32 s81, s25, 0
    s_mov_b32 s82, 3031040
    s_mov_b32 s83, 0x00020000
    s_and_b32 s46, s54, 7
    s_lshr_b32 s47, s54, 3
    s_and_b32 s100, s46, 3
    s_lshl_b32 s100, s100, 3
    s_and_b32 s55, s47, 7
    s_add_u32 s100, s100, s55
    s_lshr_b32 s101, s46, 2
    s_lshl_b32 s101, s101, 2
    s_lshr_b32 s55, s47, 3
    s_add_u32 s101, s101, s55
    s_mul_i32 s65, s101, 378880
    s_mul_i32 s64, s26, 2560
    s_add_u32 s65, s65, s64
    s_mov_b32 s98, -1
    s_mov_b32 s99, 0
    s_and_b32 s97, s54, 15
    s_add_u32 s97, s97, 96
    s_lshl_b32 s97, s97, 8
    s_cmp_ge_u32 s54, 224
    s_cbranch_scc1 Lg_idle
    s_and_b32 s46, s54, 7
    s_lshr_b32 s47, s54, 3
    s_lshr_b32 s45, s46, 2
    s_lshl_b32 s45, s45, 1
    s_and_b32 s55, s46, 1
    s_add_u32 s45, s45, s55
    s_mul_i32 s45, s45, 28
    s_add_u32 s45, s45, s47
    s_bfe_u32 s44, s46, 0x10001
    s_lshl_b32 s44, s44, 3
    s_and_b32 s47, s45, 7
    s_add_u32 s44, s44, s47
    s_lshr_b32 s45, s45, 3
    v_lshrrev_b32 v64, 3, v2
    v_lshrrev_b32 v65, 4, v2
    v_and_b32 v66, 7, v2
    v_and_b32 v67, 15, v2
    s_lshl_b32 s46, s44, 7
    s_lshl_b32 s47, s26, 4
    s_add_u32 s46, s46, s47
    v_add_u32 v64, s46, v64
    v_mul_u32_u24 v64, 1280, v64
    v_xor_b32 v66, v66, v65
    v_lshl_add_u32 v3, v66, 4, v64
    v_xor_b32 v66, 4, v66
    v_lshl_add_u32 v4, v66, 4, v64
    v_add_u32 v4, 9216, v4
    s_and_b32 s46, s26, 3
    s_lshl_b32 s46, s46, 3
    s_lshl_b32 s49, s26, 11
    s_and_b32 s47, s26, 1
    s_lshl_b32 s47, s47, 1
    v_lshlrev_b32 v68, 2, v65
    v_xor_b32 v68, v68, v67
    v_xor_b32 v68, s47, v68
    v_lshlrev_b32 v68, 4, v68
    v_add_u32 v69, s46, v65
    v_mul_u32_u24 v69, 3456, v69
    s_lshl_b32 s47, s45, 8
    v_add3_u32 v5, v68, v69, s47
    v_add_u32 v6, 12800, v5
    s_lshl_b32 s48, s26, 11
    s_add_u32 s49, s49, 32768
    s_lshr_b32 s52, s26, 2
    s_and_b32 s53, s26, 3
    s_lshl_b32 s46, s52, 6
    v_add_u32 v64, s46, v67
    v_bfe_u32 v66, v64, 1, 3
    v_xor_b32 v66, v66, v65
    v_lshlrev_b32 v64, 7, v64
    v_lshl_add_u32 v9, v66, 4, v64
    v_xor_b32 v10, 64, v9
    v_bfe_u32 v64, v2, 2, 2
    v_lshl_add_u32 v66, v65, 3, v64
    v_lshlrev_b32 v66, 8, v66
    v_xor_b32 v64, s53, v64
    v_lshl_add_u32 v66, v64, 6, v66
    v_and_b32 v64, 1, v65
    v_lshl_add_u32 v66, v64, 5, v66
    v_and_b32 v64, 3, v2
    v_lshl_add_u32 v66, v64, 3, v66
    v_add_u32 v11, 32768, v66
    v_xor_b32 v12, 32, v11
    s_mov_b32 s28, s4
    s_mov_b32 s29, s5
    s_mov_b32 s30, 2621440
    s_mov_b32 s31, 0x00020000
    s_cmp_ge_u32 s26, 4
    s_cselect_b32 s32, s14, s12
    s_cselect_b32 s33, s15, s13
    s_mov_b32 s34, 2211840
    s_mov_b32 s35, 0x00020000
    s_add_u32 s40, s24, 10485760
    s_addc_u32 s41, s25, 0
    s_mov_b32 s42, 9699328
    s_mov_b32 s43, 0x00020000
    s_lshl_b32 s46, s44, 3
    s_lshl_b32 s47, s52, 2
    s_add_u32 s46, s46, s47
    s_mul_i32 s46, s46, 75776
    s_lshl_b32 s47, s45, 2
    s_add_u32 s47, s47, s53
    s_mov_b32 s57, s47
    s_lshl_b32 s47, s47, 10
    s_add_u32 s55, s46, s47
    s_cmp_ge_u32 s57, 54
    s_cmov_b32 s55, 9699328
    s_lshl_b32 s58, s44, 8
    v_lshlrev_b32 v8, 4, v2
    v_mov_b32 v14, 0
    s_cmp_lg_u32 s26, 0
    s_cbranch_scc1 Lg_stg
    s_lshl_b32 s60, s54, 7
    s_add_u32 s60, s60, 32768
    v_mov_b32 v7, 0
    s_mov_b32 s62, 0
    s_mov_b64 exec, 1
    buffer_store_dword v7, v7, s[76:79], s60 offen sc1
    s_waitcnt vmcnt(0)
Lg_spg:
    buffer_load_dword v1, v7, s[76:79], s60 offen sc1
    s_add_u32 s62, s62, 1
    s_waitcnt vmcnt(0)
    v_readfirstlane_b32 s63, v1
    s_nop 0
    s_cmp_ge_u32 s63, 2
    s_cbranch_scc1 Lg_sog
    s_sleep 2
    s_cmp_lt_u32 s62, 32
    s_cbranch_scc1 Lg_spg
Lg_sog:
    s_mov_b64 exec, -1
Lg_stg:
    s_barrier
    s_add_u32 m0, s48, 0
    s_movk_i32 s50, 0
    buffer_load_dwordx4 v3, s[28:31], s50 offen offset:0 lds
    buffer_load_dwordx4 v4, s[28:31], s50 offen offset:1024 lds
    s_add_u32 m0, s49, 0
    s_mov_b32 s51, 0
    buffer_load_dwordx4 v5, s[32:35], s51 offen offset:0 lds
    buffer_load_dwordx4 v6, s[32:35], s51 offen offset:1024 lds
    s_add_u32 m0, s49, 16384
    s_mov_b32 s51, 110592
    buffer_load_dwordx4 v5, s[32:35], s51 offen offset:0 lds
    buffer_load_dwordx4 v6, s[32:35], s51 offen offset:1024 lds
    s_add_u32 m0, s48, 16384
    s_movk_i32 s50, 128
    buffer_load_dwordx4 v3, s[28:31], s50 offen offset:0 lds
    buffer_load_dwordx4 v4, s[28:31], s50 offen offset:1024 lds
    s_add_u32 m0, s49, 32768
    s_mov_b32 s51, 221184
    buffer_load_dwordx4 v5, s[32:35], s51 offen offset:0 lds
    buffer_load_dwordx4 v6, s[32:35], s51 offen offset:1024 lds
    s_setprio 0
    s_cmp_ge_u32 s57, 54
    s_cbranch_scc1 Lg_feed
    s_waitcnt vmcnt(6)
    s_barrier
    ds_read_b128 v[16:19], v9 offset:0
    ds_read_b128 v[20:23], v9 offset:2048
    ds_read_b128 v[24:27], v9 offset:4096
    ds_read_b128 v[28:31], v9 offset:6144
    ds_read_b64_tr_b16 v[48:49], v11 offset:0
    ds_read_b64_tr_b16 v[50:51], v11 offset:1024
    ds_read_b64_tr_b16 v[52:53], v11 offset:8192
    ds_read_b64_tr_b16 v[54:55], v11 offset:9216
    ds_read_b64_tr_b16 v[56:57], v12 offset:0
    ds_read_b64_tr_b16 v[58:59], v12 offset:1024
    ds_read_b64_tr_b16 v[60:61], v12 offset:8192
    ds_read_b64_tr_b16 v[62:63], v12 offset:9216
    s_waitcnt lgkmcnt(6)
    v_mfma_f32_16x16x32_bf16 v[64:67], v[48:51], v[16:19], 0
    v_mfma_f32_16x16x32_bf16 v[80:83], v[48:51], v[20:23], 0
    v_mfma_f32_16x16x32_bf16 v[96:99], v[48:51], v[24:27], 0
    v_mfma_f32_16x16x32_bf16 v[112:115], v[48:51], v[28:31], 0
    s_waitcnt vmcnt(4) lgkmcnt(0)
    s_barrier
    ds_read_b64_tr_b16 v[48:49], v11 offset:16384
    ds_read_b64_tr_b16 v[50:51], v11 offset:17408
    v_mfma_f32_16x16x32_bf16 v[68:71], v[52:55], v[16:19], 0
    ds_read_b128 v[32:35], v10 offset:0
    v_mfma_f32_16x16x32_bf16 v[84:87], v[52:55], v[20:23], 0
    ds_read_b128 v[36:39], v10 offset:2048
    v_mfma_f32_16x16x32_bf16 v[100:103], v[52:55], v[24:27], 0
    ds_read_b128 v[40:43], v10 offset:4096
    v_mfma_f32_16x16x32_bf16 v[116:119], v[52:55], v[28:31], 0
    ds_read_b128 v[44:47], v10 offset:6144
    ds_read_b64_tr_b16 v[52:53], v11 offset:24576
    ds_read_b64_tr_b16 v[54:55], v11 offset:25600
    v_mfma_f32_16x16x32_bf16 v[72:75], v[56:59], v[16:19], 0
    s_add_u32 m0, s49, 0
    s_mov_b32 s51, 331776
    v_mfma_f32_16x16x32_bf16 v[88:91], v[56:59], v[20:23], 0
    buffer_load_dwordx4 v5, s[32:35], s51 offen offset:0 lds
    v_mfma_f32_16x16x32_bf16 v[104:107], v[56:59], v[24:27], 0
    buffer_load_dwordx4 v6, s[32:35], s51 offen offset:1024 lds
    v_mfma_f32_16x16x32_bf16 v[120:123], v[56:59], v[28:31], 0
    s_setprio 0
    ds_read_b64_tr_b16 v[56:57], v12 offset:16384
    ds_read_b64_tr_b16 v[58:59], v12 offset:17408
    v_mfma_f32_16x16x32_bf16 v[76:79], v[60:63], v[16:19], 0
    v_mfma_f32_16x16x32_bf16 v[92:95], v[60:63], v[20:23], 0
    v_mfma_f32_16x16x32_bf16 v[108:111], v[60:63], v[24:27], 0
    v_mfma_f32_16x16x32_bf16 v[124:127], v[60:63], v[28:31], 0
    ds_read_b64_tr_b16 v[60:61], v12 offset:24576
    ds_read_b64_tr_b16 v[62:63], v12 offset:25600
    s_waitcnt lgkmcnt(6)
    v_mfma_f32_16x16x32_bf16 v[64:67], v[48:51], v[32:35], v[64:67]
    v_mfma_f32_16x16x32_bf16 v[80:83], v[48:51], v[36:39], v[80:83]
    v_mfma_f32_16x16x32_bf16 v[96:99], v[48:51], v[40:43], v[96:99]
    v_mfma_f32_16x16x32_bf16 v[112:115], v[48:51], v[44:47], v[112:115]
    s_waitcnt vmcnt(2) lgkmcnt(0)
    s_barrier
    ds_read_b64_tr_b16 v[48:49], v11 offset:32768
    ds_read_b64_tr_b16 v[50:51], v11 offset:33792
    v_mfma_f32_16x16x32_bf16 v[68:71], v[52:55], v[32:35], v[68:71]
    ds_read_b128 v[16:19], v9 offset:16384
    v_mfma_f32_16x16x32_bf16 v[84:87], v[52:55], v[36:39], v[84:87]
    ds_read_b128 v[20:23], v9 offset:18432
    v_mfma_f32_16x16x32_bf16 v[100:103], v[52:55], v[40:43], v[100:103]
    ds_read_b128 v[24:27], v9 offset:20480
    v_mfma_f32_16x16x32_bf16 v[116:119], v[52:55], v[44:47], v[116:119]
    ds_read_b128 v[28:31], v9 offset:22528
    ds_read_b64_tr_b16 v[52:53], v11 offset:40960
    ds_read_b64_tr_b16 v[54:55], v11 offset:41984
    v_mfma_f32_16x16x32_bf16 v[72:75], v[56:59], v[32:35], v[72:75]
    s_add_u32 m0, s49, 16384
    s_mov_b32 s51, 442368
    buffer_load_dwordx4 v5, s[32:35], s51 offen offset:0 lds
    v_mfma_f32_16x16x32_bf16 v[88:91], v[56:59], v[36:39], v[88:91]
    buffer_load_dwordx4 v6, s[32:35], s51 offen offset:1024 lds
    s_add_u32 m0, s48, 0
    s_movk_i32 s50, 256
    v_mfma_f32_16x16x32_bf16 v[104:107], v[56:59], v[40:43], v[104:107]
    buffer_load_dwordx4 v3, s[28:31], s50 offen offset:0 lds
    buffer_load_dwordx4 v4, s[28:31], s50 offen offset:1024 lds
    v_mfma_f32_16x16x32_bf16 v[120:123], v[56:59], v[44:47], v[120:123]
    s_setprio 0
    ds_read_b64_tr_b16 v[56:57], v12 offset:32768
    ds_read_b64_tr_b16 v[58:59], v12 offset:33792
    v_mfma_f32_16x16x32_bf16 v[76:79], v[60:63], v[32:35], v[76:79]
    v_mfma_f32_16x16x32_bf16 v[92:95], v[60:63], v[36:39], v[92:95]
    v_mfma_f32_16x16x32_bf16 v[108:111], v[60:63], v[40:43], v[108:111]
    v_mfma_f32_16x16x32_bf16 v[124:127], v[60:63], v[44:47], v[124:127]
    ds_read_b64_tr_b16 v[60:61], v12 offset:40960
    ds_read_b64_tr_b16 v[62:63], v12 offset:41984
    s_waitcnt lgkmcnt(6)
    v_mfma_f32_16x16x32_bf16 v[64:67], v[48:51], v[16:19], v[64:67]
    v_mfma_f32_16x16x32_bf16 v[80:83], v[48:51], v[20:23], v[80:83]
    v_mfma_f32_16x16x32_bf16 v[96:99], v[48:51], v[24:27], v[96:99]
    v_mfma_f32_16x16x32_bf16 v[112:115], v[48:51], v[28:31], v[112:115]
    s_waitcnt vmcnt(4) lgkmcnt(0)
    s_barrier
    ds_read_b64_tr_b16 v[48:49], v11 offset:0
    ds_read_b64_tr_b16 v[50:51], v11 offset:1024
    v_mfma_f32_16x16x32_bf16 v[68:71], v[52:55], v[16:19], v[68:71]
    ds_read_b128 v[32:35], v10 offset:16384
    v_mfma_f32_16x16x32_bf16 v[84:87], v[52:55], v[20:23], v[84:87]
    ds_read_b128 v[36:39], v10 offset:18432
    v_mfma_f32_16x16x32_bf16 v[100:103], v[52:55], v[24:27], v[100:103]
    ds_read_b128 v[40:43], v10 offset:20480
    v_mfma_f32_16x16x32_bf16 v[116:119], v[52:55], v[28:31], v[116:119]
    ds_read_b128 v[44:47], v10 offset:22528
    ds_read_b64_tr_b16 v[52:53], v11 offset:8192
    ds_read_b64_tr_b16 v[54:55], v11 offset:9216
    v_mfma_f32_16x16x32_bf16 v[72:75], v[56:59], v[16:19], v[72:75]
    s_add_u32 m0, s49, 32768
    s_mov_b32 s51, 552960
    v_mfma_f32_16x16x32_bf16 v[88:91], v[56:59], v[20:23], v[88:91]
    buffer_load_dwordx4 v5, s[32:35], s51 offen offset:0 lds
    v_mfma_f32_16x16x32_bf16 v[104:107], v[56:59], v[24:27], v[104:107]
    buffer_load_dwordx4 v6, s[32:35], s51 offen offset:1024 lds
    v_mfma_f32_16x16x32_bf16 v[120:123], v[56:59], v[28:31], v[120:123]
    s_setprio 2
    ds_read_b64_tr_b16 v[56:57], v12 offset:0
    ds_read_b64_tr_b16 v[58:59], v12 offset:1024
    v_mfma_f32_16x16x32_bf16 v[76:79], v[60:63], v[16:19], v[76:79]
    v_mfma_f32_16x16x32_bf16 v[92:95], v[60:63], v[20:23], v[92:95]
    v_mfma_f32_16x16x32_bf16 v[108:111], v[60:63], v[24:27], v[108:111]
    v_mfma_f32_16x16x32_bf16 v[124:127], v[60:63], v[28:31], v[124:127]
    ds_read_b64_tr_b16 v[60:61], v12 offset:8192
    ds_read_b64_tr_b16 v[62:63], v12 offset:9216
    s_waitcnt lgkmcnt(6)
    v_mfma_f32_16x16x32_bf16 v[64:67], v[48:51], v[32:35], v[64:67]
    v_mfma_f32_16x16x32_bf16 v[80:83], v[48:51], v[36:39], v[80:83]
    v_mfma_f32_16x16x32_bf16 v[96:99], v[48:51], v[40:43], v[96:99]
    v_mfma_f32_16x16x32_bf16 v[112:115], v[48:51], v[44:47], v[112:115]
    s_waitcnt vmcnt(2) lgkmcnt(0)
    s_barrier
    ds_read_b64_tr_b16 v[48:49], v11 offset:16384
    ds_read_b64_tr_b16 v[50:51], v11 offset:17408
    v_mfma_f32_16x16x32_bf16 v[68:71], v[52:55], v[32:35], v[68:71]
    ds_read_b128 v[16:19], v9 offset:0
    v_mfma_f32_16x16x32_bf16 v[84:87], v[52:55], v[36:39], v[84:87]
    ds_read_b128 v[20:23], v9 offset:2048
    v_mfma_f32_16x16x32_bf16 v[100:103], v[52:55], v[40:43], v[100:103]
    ds_read_b128 v[24:27], v9 offset:4096
    v_mfma_f32_16x16x32_bf16 v[116:119], v[52:55], v[44:47], v[116:119]
    ds_read_b128 v[28:31], v9 offset:6144
    ds_read_b64_tr_b16 v[52:53], v11 offset:24576
    ds_read_b64_tr_b16 v[54:55], v11 offset:25600
    v_mfma_f32_16x16x32_bf16 v[72:75], v[56:59], v[32:35], v[72:75]
    s_add_u32 m0, s49, 0
    s_mov_b32 s51, 663552
    buffer_load_dwordx4 v5, s[32:35], s51 offen offset:0 lds
    v_mfma_f32_16x16x32_bf16 v[88:91], v[56:59], v[36:39], v[88:91]
    buffer_load_dwordx4 v6, s[32:35], s51 offen offset:1024 lds
    s_add_u32 m0, s48, 16384
    s_movk_i32 s50, 384
    v_mfma_f32_16x16x32_bf16 v[104:107], v[56:59], v[40:43], v[104:107]
    buffer_load_dwordx4 v3, s[28:31], s50 offen offset:0 lds
    buffer_load_dwordx4 v4, s[28:31], s50 offen offset:1024 lds
    v_mfma_f32_16x16x32_bf16 v[120:123], v[56:59], v[44:47], v[120:123]
    s_setprio 0
    ds_read_b64_tr_b16 v[56:57], v12 offset:16384
    ds_read_b64_tr_b16 v[58:59], v12 offset:17408
    v_mfma_f32_16x16x32_bf16 v[76:79], v[60:63], v[32:35], v[76:79]
    v_mfma_f32_16x16x32_bf16 v[92:95], v[60:63], v[36:39], v[92:95]
    v_mfma_f32_16x16x32_bf16 v[108:111], v[60:63], v[40:43], v[108:111]
    v_mfma_f32_16x16x32_bf16 v[124:127], v[60:63], v[44:47], v[124:127]
    ds_read_b64_tr_b16 v[60:61], v12 offset:24576
    ds_read_b64_tr_b16 v[62:63], v12 offset:25600
    s_waitcnt lgkmcnt(6)
    v_mfma_f32_16x16x32_bf16 v[64:67], v[48:51], v[16:19], v[64:67]
    v_mfma_f32_16x16x32_bf16 v[80:83], v[48:51], v[20:23], v[80:83]
    v_mfma_f32_16x16x32_bf16 v[96:99], v[48:51], v[24:27], v[96:99]
    v_mfma_f32_16x16x32_bf16 v[112:115], v[48:51], v[28:31], v[112:115]
    s_waitcnt vmcnt(4) lgkmcnt(0)
    s_barrier
    ds_read_b64_tr_b16 v[48:49], v11 offset:32768
    ds_read_b64_tr_b16 v[50:51], v11 offset:33792
    v_mfma_f32_16x16x32_bf16 v[68:71], v[52:55], v[16:19], v[68:71]
    ds_read_b128 v[32:35], v10 offset:0
    v_mfma_f32_16x16x32_bf16 v[84:87], v[52:55], v[20:23], v[84:87]
    ds_read_b128 v[36:39], v10 offset:2048
    v_mfma_f32_16x16x32_bf16 v[100:103], v[52:55], v[24:27], v[100:103]
    ds_read_b128 v[40:43], v10 offset:4096
    v_mfma_f32_16x16x32_bf16 v[116:119], v[52:55], v[28:31], v[116:119]
    ds_read_b128 v[44:47], v10 offset:6144
    ds_read_b64_tr_b16 v[52:53], v11 offset:40960
    ds_read_b64_tr_b16 v[54:55], v11 offset:41984
    v_mfma_f32_16x16x32_bf16 v[72:75], v[56:59], v[16:19], v[72:75]
    s_add_u32 m0, s49, 16384
    s_mov_b32 s51, 774144
    buffer_load_dwordx4 v5, s[32:35], s51 offen offset:0 lds
    v_mfma_f32_16x16x32_bf16 v[88:91], v[56:59], v[20:23], v[88:91]
    buffer_load_dwordx4 v6, s[32:35], s51 offen offset:1024 lds
    s_setprio 0
    v_mfma_f32_16x16x32_bf16 v[104:107], v[56:59], v[24:27], v[104:107]
    s_cmp_lg_u32 s26, 0
    s_cbranch_scc1 Lg_ha
    s_mov_b32 s62, 0
    buffer_load_dword v13, v14, s[84:87], 0 offen sc1
Lg_ha:
    v_mfma_f32_16x16x32_bf16 v[120:123], v[56:59], v[28:31], v[120:123]
    ds_read_b64_tr_b16 v[56:57], v12 offset:32768
    ds_read_b64_tr_b16 v[58:59], v12 offset:33792
    v_mfma_f32_16x16x32_bf16 v[76:79], v[60:63], v[16:19], v[76:79]
    v_mfma_f32_16x16x32_bf16 v[92:95], v[60:63], v[20:23], v[92:95]
    v_mfma_f32_16x16x32_bf16 v[108:111], v[60:63], v[24:27], v[108:111]
    v_mfma_f32_16x16x32_bf16 v[124:127], v[60:63], v[28:31], v[124:127]
    ds_read_b64_tr_b16 v[60:61], v12 offset:40960
    ds_read_b64_tr_b16 v[62:63], v12 offset:41984
    s_waitcnt lgkmcnt(6)
    v_mfma_f32_16x16x32_bf16 v[64:67], v[48:51], v[32:35], v[64:67]
    v_mfma_f32_16x16x32_bf16 v[80:83], v[48:51], v[36:39], v[80:83]
    v_mfma_f32_16x16x32_bf16 v[96:99], v[48:51], v[40:43], v[96:99]
    v_mfma_f32_16x16x32_bf16 v[112:115], v[48:51], v[44:47], v[112:115]
    s_waitcnt vmcnt(2) lgkmcnt(0)
    s_barrier
    ds_read_b64_tr_b16 v[48:49], v11 offset:0
    ds_read_b64_tr_b16 v[50:51], v11 offset:1024
    v_mfma_f32_16x16x32_bf16 v[68:71], v[52:55], v[32:35], v[68:71]
    ds_read_b128 v[16:19], v9 offset:16384
    v_mfma_f32_16x16x32_bf16 v[84:87], v[52:55], v[36:39], v[84:87]
    ds_read_b128 v[20:23], v9 offset:18432
    v_mfma_f32_16x16x32_bf16 v[100:103], v[52:55], v[40:43], v[100:103]
    ds_read_b128 v[24:27], v9 offset:20480
    v_mfma_f32_16x16x32_bf16 v[116:119], v[52:55], v[44:47], v[116:119]
    ds_read_b128 v[28:31], v9 offset:22528
    ds_read_b64_tr_b16 v[52:53], v11 offset:8192
    ds_read_b64_tr_b16 v[54:55], v11 offset:9216
    v_mfma_f32_16x16x32_bf16 v[72:75], v[56:59], v[32:35], v[72:75]
    s_add_u32 m0, s49, 32768
    s_mov_b32 s51, 884736
    buffer_load_dwordx4 v5, s[32:35], s51 offen offset:0 lds
    v_mfma_f32_16x16x32_bf16 v[88:91], v[56:59], v[36:39], v[88:91]
    buffer_load_dwordx4 v6, s[32:35], s51 offen offset:1024 lds
    s_add_u32 m0, s48, 0
    s_movk_i32 s50, 512
    v_mfma_f32_16x16x32_bf16 v[104:107], v[56:59], v[40:43], v[104:107]
    buffer_load_dwordx4 v3, s[28:31], s50 offen offset:0 lds
    buffer_load_dwordx4 v4, s[28:31], s50 offen offset:1024 lds
    v_mfma_f32_16x16x32_bf16 v[120:123], v[56:59], v[44:47], v[120:123]
    s_setprio 0
    ds_read_b64_tr_b16 v[56:57], v12 offset:0
    ds_read_b64_tr_b16 v[58:59], v12 offset:1024
    v_mfma_f32_16x16x32_bf16 v[76:79], v[60:63], v[32:35], v[76:79]
    v_mfma_f32_16x16x32_bf16 v[92:95], v[60:63], v[36:39], v[92:95]
    v_mfma_f32_16x16x32_bf16 v[108:111], v[60:63], v[40:43], v[108:111]
    v_mfma_f32_16x16x32_bf16 v[124:127], v[60:63], v[44:47], v[124:127]
    ds_read_b64_tr_b16 v[60:61], v12 offset:8192
    ds_read_b64_tr_b16 v[62:63], v12 offset:9216
    s_waitcnt lgkmcnt(6)
    v_mfma_f32_16x16x32_bf16 v[64:67], v[48:51], v[16:19], v[64:67]
    v_mfma_f32_16x16x32_bf16 v[80:83], v[48:51], v[20:23], v[80:83]
    v_mfma_f32_16x16x32_bf16 v[96:99], v[48:51], v[24:27], v[96:99]
    v_mfma_f32_16x16x32_bf16 v[112:115], v[48:51], v[28:31], v[112:115]
    s_waitcnt vmcnt(4) lgkmcnt(0)
    s_barrier
    ds_read_b64_tr_b16 v[48:49], v11 offset:16384
    ds_read_b64_tr_b16 v[50:51], v11 offset:17408
    v_mfma_f32_16x16x32_bf16 v[68:71], v[52:55], v[16:19], v[68:71]
    ds_read_b128 v[32:35], v10 offset:16384
    v_mfma_f32_16x16x32_bf16 v[84:87], v[52:55], v[20:23], v[84:87]
    ds_read_b128 v[36:39], v10 offset:18432
    v_mfma_f32_16x16x32_bf16 v[100:103], v[52:55], v[24:27], v[100:103]
    ds_read_b128 v[40:43], v10 offset:20480
    v_mfma_f32_16x16x32_bf16 v[116:119], v[52:55], v[28:31], v[116:119]
    ds_read_b128 v[44:47], v10 offset:22528
    ds_read_b64_tr_b16 v[52:53], v11 offset:24576
    ds_read_b64_tr_b16 v[54:55], v11 offset:25600
    v_mfma_f32_16x16x32_bf16 v[72:75], v[56:59], v[16:19], v[72:75]
    s_add_u32 m0, s49, 0
    s_mov_b32 s51, 995328
    v_mfma_f32_16x16x32_bf16 v[88:91], v[56:59], v[20:23], v[88:91]
    buffer_load_dwordx4 v5, s[32:35], s51 offen offset:0 lds
    v_mfma_f32_16x16x32_bf16 v[104:107], v[56:59], v[24:27], v[104:107]
    buffer_load_dwordx4 v6, s[32:35], s51 offen offset:1024 lds
    v_mfma_f32_16x16x32_bf16 v[120:123], v[56:59], v[28:31], v[120:123]
    s_setprio 2
    ds_read_b64_tr_b16 v[56:57], v12 offset:16384
    ds_read_b64_tr_b16 v[58:59], v12 offset:17408
    v_mfma_f32_16x16x32_bf16 v[76:79], v[60:63], v[16:19], v[76:79]
    v_mfma_f32_16x16x32_bf16 v[92:95], v[60:63], v[20:23], v[92:95]
    v_mfma_f32_16x16x32_bf16 v[108:111], v[60:63], v[24:27], v[108:111]
    v_mfma_f32_16x16x32_bf16 v[124:127], v[60:63], v[28:31], v[124:127]
    ds_read_b64_tr_b16 v[60:61], v12 offset:24576
    ds_read_b64_tr_b16 v[62:63], v12 offset:25600
    s_waitcnt lgkmcnt(6)
    v_mfma_f32_16x16x32_bf16 v[64:67], v[48:51], v[32:35], v[64:67]
    v_mfma_f32_16x16x32_bf16 v[80:83], v[48:51], v[36:39], v[80:83]
    v_mfma_f32_16x16x32_bf16 v[96:99], v[48:51], v[40:43], v[96:99]
    v_mfma_f32_16x16x32_bf16 v[112:115], v[48:51], v[44:47], v[112:115]
    s_waitcnt vmcnt(2) lgkmcnt(0)
    s_barrier
    ds_read_b64_tr_b16 v[48:49], v11 offset:32768
    ds_read_b64_tr_b16 v[50:51], v11 offset:33792
    v_mfma_f32_16x16x32_bf16 v[68:71], v[52:55], v[32:35], v[68:71]
    ds_read_b128 v[16:19], v9 offset:0
    v_mfma_f32_16x16x32_bf16 v[84:87], v[52:55], v[36:39], v[84:87]
    ds_read_b128 v[20:23], v9 offset:2048
    v_mfma_f32_16x16x32_bf16 v[100:103], v[52:55], v[40:43], v[100:103]
    ds_read_b128 v[24:27], v9 offset:4096
    v_mfma_f32_16x16x32_bf16 v[116:119], v[52:55], v[44:47], v[116:119]
    ds_read_b128 v[28:31], v9 offset:6144
    ds_read_b64_tr_b16 v[52:53], v11 offset:40960
    ds_read_b64_tr_b16 v[54:55], v11 offset:41984
    v_mfma_f32_16x16x32_bf16 v[72:75], v[56:59], v[32:35], v[72:75]
    s_add_u32 m0, s49, 16384
    s_mov_b32 s51, 1105920
    buffer_load_dwordx4 v5, s[32:35], s51 offen offset:0 lds
    v_mfma_f32_16x16x32_bf16 v[88:91], v[56:59], v[36:39], v[88:91]
    buffer_load_dwordx4 v6, s[32:35], s51 offen offset:1024 lds
    s_add_u32 m0, s48, 16384
    s_movk_i32 s50, 640
    v_mfma_f32_16x16x32_bf16 v[104:107], v[56:59], v[40:43], v[104:107]
    buffer_load_dwordx4 v3, s[28:31], s50 offen offset:0 lds
    buffer_load_dwordx4 v4, s[28:31], s50 offen offset:1024 lds
    v_mfma_f32_16x16x32_bf16 v[120:123], v[56:59], v[44:47], v[120:123]
    s_setprio 0
    ds_read_b64_tr_b16 v[56:57], v12 offset:32768
    ds_read_b64_tr_b16 v[58:59], v12 offset:33792
    v_mfma_f32_16x16x32_bf16 v[76:79], v[60:63], v[32:35], v[76:79]
    v_mfma_f32_16x16x32_bf16 v[92:95], v[60:63], v[36:39], v[92:95]
    v_mfma_f32_16x16x32_bf16 v[108:111], v[60:63], v[40:43], v[108:111]
    v_mfma_f32_16x16x32_bf16 v[124:127], v[60:63], v[44:47], v[124:127]
    ds_read_b64_tr_b16 v[60:61], v12 offset:40960
    ds_read_b64_tr_b16 v[62:63], v12 offset:41984
    s_waitcnt lgkmcnt(6)
    v_mfma_f32_16x16x32_bf16 v[64:67], v[48:51], v[16:19], v[64:67]
    v_mfma_f32_16x16x32_bf16 v[80:83], v[48:51], v[20:23], v[80:83]
    v_mfma_f32_16x16x32_bf16 v[96:99], v[48:51], v[24:27], v[96:99]
    v_mfma_f32_16x16x32_bf16 v[112:115], v[48:51], v[28:31], v[112:115]
    s_waitcnt vmcnt(4) lgkmcnt(0)
    s_barrier
    ds_read_b64_tr_b16 v[48:49], v11 offset:0
    ds_read_b64_tr_b16 v[50:51], v11 offset:1024
    v_mfma_f32_16x16x32_bf16 v[68:71], v[52:55], v[16:19], v[68:71]
    ds_read_b128 v[32:35], v10 offset:0
    v_mfma_f32_16x16x32_bf16 v[84:87], v[52:55], v[20:23], v[84:87]
    ds_read_b128 v[36:39], v10 offset:2048
    v_mfma_f32_16x16x32_bf16 v[100:103], v[52:55], v[24:27], v[100:103]
    ds_read_b128 v[40:43], v10 offset:4096
    v_mfma_f32_16x16x32_bf16 v[116:119], v[52:55], v[28:31], v[116:119]
    ds_read_b128 v[44:47], v10 offset:6144
    ds_read_b64_tr_b16 v[52:53], v11 offset:8192
    ds_read_b64_tr_b16 v[54:55], v11 offset:9216
    v_mfma_f32_16x16x32_bf16 v[72:75], v[56:59], v[16:19], v[72:75]
    s_add_u32 m0, s49, 32768
    s_mov_b32 s51, 1216512
    v_mfma_f32_16x16x32_bf16 v[88:91], v[56:59], v[20:23], v[88:91]
    buffer_load_dwordx4 v5, s[32:35], s51 offen offset:0 lds
    v_mfma_f32_16x16x32_bf16 v[104:107], v[56:59], v[24:27], v[104:107]
    buffer_load_dwordx4 v6, s[32:35], s51 offen offset:1024 lds
    v_mfma_f32_16x16x32_bf16 v[120:123], v[56:59], v[28:31], v[120:123]
    s_setprio 0
    ds_read_b64_tr_b16 v[56:57], v12 offset:0
    ds_read_b64_tr_b16 v[58:59], v12 offset:1024
    v_mfma_f32_16x16x32_bf16 v[76:79], v[60:63], v[16:19], v[76:79]
    v_mfma_f32_16x16x32_bf16 v[92:95], v[60:63], v[20:23], v[92:95]
    v_mfma_f32_16x16x32_bf16 v[108:111], v[60:63], v[24:27], v[108:111]
    v_mfma_f32_16x16x32_bf16 v[124:127], v[60:63], v[28:31], v[124:127]
    ds_read_b64_tr_b16 v[60:61], v12 offset:8192
    ds_read_b64_tr_b16 v[62:63], v12 offset:9216
    s_waitcnt lgkmcnt(6)
    v_mfma_f32_16x16x32_bf16 v[64:67], v[48:51], v[32:35], v[64:67]
    v_mfma_f32_16x16x32_bf16 v[80:83], v[48:51], v[36:39], v[80:83]
    v_mfma_f32_16x16x32_bf16 v[96:99], v[48:51], v[40:43], v[96:99]
    v_mfma_f32_16x16x32_bf16 v[112:115], v[48:51], v[44:47], v[112:115]
    s_waitcnt vmcnt(2) lgkmcnt(0)
    s_barrier
    ds_read_b64_tr_b16 v[48:49], v11 offset:16384
    ds_read_b64_tr_b16 v[50:51], v11 offset:17408
    v_mfma_f32_16x16x32_bf16 v[68:71], v[52:55], v[32:35], v[68:71]
    ds_read_b128 v[16:19], v9 offset:16384
    v_mfma_f32_16x16x32_bf16 v[84:87], v[52:55], v[36:39], v[84:87]
    ds_read_b128 v[20:23], v9 offset:18432
    v_mfma_f32_16x16x32_bf16 v[100:103], v[52:55], v[40:43], v[100:103]
    ds_read_b128 v[24:27], v9 offset:20480
    v_mfma_f32_16x16x32_bf16 v[116:119], v[52:55], v[44:47], v[116:119]
    ds_read_b128 v[28:31], v9 offset:22528
    ds_read_b64_tr_b16 v[52:53], v11 offset:24576
    ds_read_b64_tr_b16 v[54:55], v11 offset:25600
    v_mfma_f32_16x16x32_bf16 v[72:75], v[56:59], v[32:35], v[72:75]
    s_add_u32 m0, s49, 0
    s_mov_b32 s51, 1327104
    buffer_load_dwordx4 v5, s[32:35], s51 offen offset:0 lds
    v_mfma_f32_16x16x32_bf16 v[88:91], v[56:59], v[36:39], v[88:91]
    buffer_load_dwordx4 v6, s[32:35], s51 offen offset:1024 lds
    s_add_u32 m0, s48, 0
    s_movk_i32 s50, 768
    v_mfma_f32_16x16x32_bf16 v[104:107], v[56:59], v[40:43], v[104:107]
    buffer_load_dwordx4 v3, s[28:31], s50 offen offset:0 lds
    buffer_load_dwordx4 v4, s[28:31], s50 offen offset:1024 lds
    v_mfma_f32_16x16x32_bf16 v[120:123], v[56:59], v[44:47], v[120:123]
    s_setprio 0
    ds_read_b64_tr_b16 v[56:57], v12 offset:16384
    ds_read_b64_tr_b16 v[58:59], v12 offset:17408
    v_mfma_f32_16x16x32_bf16 v[76:79], v[60:63], v[32:35], v[76:79]
    v_mfma_f32_16x16x32_bf16 v[92:95], v[60:63], v[36:39], v[92:95]
    v_mfma_f32_16x16x32_bf16 v[108:111], v[60:63], v[40:43], v[108:111]
    v_mfma_f32_16x16x32_bf16 v[124:127], v[60:63], v[44:47], v[124:127]
    ds_read_b64_tr_b16 v[60:61], v12 offset:24576
    ds_read_b64_tr_b16 v[62:63], v12 offset:25600
    s_waitcnt lgkmcnt(6)
    v_mfma_f32_16x16x32_bf16 v[64:67], v[48:51], v[16:19], v[64:67]
    v_mfma_f32_16x16x32_bf16 v[80:83], v[48:51], v[20:23], v[80:83]
    v_mfma_f32_16x16x32_bf16 v[96:99], v[48:51], v[24:27], v[96:99]
    v_mfma_f32_16x16x32_bf16 v[112:115], v[48:51], v[28:31], v[112:115]
    s_waitcnt vmcnt(4) lgkmcnt(0)
    s_barrier
    ds_read_b64_tr_b16 v[48:49], v11 offset:32768
    ds_read_b64_tr_b16 v[50:51], v11 offset:33792
    v_mfma_f32_16x16x32_bf16 v[68:71], v[52:55], v[16:19], v[68:71]
    ds_read_b128 v[32:35], v10 offset:16384
    v_mfma_f32_16x16x32_bf16 v[84:87], v[52:55], v[20:23], v[84:87]
    ds_read_b128 v[36:39], v10 offset:18432
    v_mfma_f32_16x16x32_bf16 v[100:103], v[52:55], v[24:27], v[100:103]
    ds_read_b128 v[40:43], v10 offset:20480
    v_mfma_f32_16x16x32_bf16 v[116:119], v[52:55], v[28:31], v[116:119]
    ds_read_b128 v[44:47], v10 offset:22528
    ds_read_b64_tr_b16 v[52:53], v11 offset:40960
    ds_read_b64_tr_b16 v[54:55], v11 offset:41984
    v_mfma_f32_16x16x32_bf16 v[72:75], v[56:59], v[16:19], v[72:75]
    s_add_u32 m0, s49, 16384
    s_mov_b32 s51, 1437696
    v_mfma_f32_16x16x32_bf16 v[88:91], v[56:59], v[20:23], v[88:91]
    buffer_load_dwordx4 v5, s[32:35], s51 offen offset:0 lds
    v_mfma_f32_16x16x32_bf16 v[104:107], v[56:59], v[24:27], v[104:107]
    buffer_load_dwordx4 v6, s[32:35], s51 offen offset:1024 lds
    v_mfma_f32_16x16x32_bf16 v[120:123], v[56:59], v[28:31], v[120:123]
    s_setprio 2
    ds_read_b64_tr_b16 v[56:57], v12 offset:32768
    ds_read_b64_tr_b16 v[58:59], v12 offset:33792
    v_mfma_f32_16x16x32_bf16 v[76:79], v[60:63], v[16:19], v[76:79]
    v_mfma_f32_16x16x32_bf16 v[92:95], v[60:63], v[20:23], v[92:95]
    v_mfma_f32_16x16x32_bf16 v[108:111], v[60:63], v[24:27], v[108:111]
    v_mfma_f32_16x16x32_bf16 v[124:127], v[60:63], v[28:31], v[124:127]
    ds_read_b64_tr_b16 v[60:61], v12 offset:40960
    ds_read_b64_tr_b16 v[62:63], v12 offset:41984
    s_waitcnt lgkmcnt(6)
    v_mfma_f32_16x16x32_bf16 v[64:67], v[48:51], v[32:35], v[64:67]
    v_mfma_f32_16x16x32_bf16 v[80:83], v[48:51], v[36:39], v[80:83]
    v_mfma_f32_16x16x32_bf16 v[96:99], v[48:51], v[40:43], v[96:99]
    v_mfma_f32_16x16x32_bf16 v[112:115], v[48:51], v[44:47], v[112:115]
    s_waitcnt vmcnt(2) lgkmcnt(0)
    s_barrier
    ds_read_b64_tr_b16 v[48:49], v11 offset:0
    ds_read_b64_tr_b16 v[50:51], v11 offset:1024
    v_mfma_f32_16x16x32_bf16 v[68:71], v[52:55], v[32:35], v[68:71]
    ds_read_b128 v[16:19], v9 offset:0
    v_mfma_f32_16x16x32_bf16 v[84:87], v[52:55], v[36:39], v[84:87]
    ds_read_b128 v[20:23], v9 offset:2048
    v_mfma_f32_16x16x32_bf16 v[100:103], v[52:55], v[40:43], v[100:103]
    ds_read_b128 v[24:27], v9 offset:4096
    v_mfma_f32_16x16x32_bf16 v[116:119], v[52:55], v[44:47], v[116:119]
    ds_read_b128 v[28:31], v9 offset:6144
    ds_read_b64_tr_b16 v[52:53], v11 offset:8192
    ds_read_b64_tr_b16 v[54:55], v11 offset:9216
    v_mfma_f32_16x16x32_bf16 v[72:75], v[56:59], v[32:35], v[72:75]
    s_add_u32 m0, s49, 32768
    s_mov_b32 s51, 1548288
    buffer_load_dwordx4 v5, s[32:35], s51 offen offset:0 lds
    v_mfma_f32_16x16x32_bf16 v[88:91], v[56:59], v[36:39], v[88:91]
    buffer_load_dwordx4 v6, s[32:35], s51 offen offset:1024 lds
    s_add_u32 m0, s48, 16384
    s_movk_i32 s50, 896
    v_mfma_f32_16x16x32_bf16 v[104:107], v[56:59], v[40:43], v[104:107]
    buffer_load_dwordx4 v3, s[28:31], s50 offen offset:0 lds
    buffer_load_dwordx4 v4, s[28:31], s50 offen offset:1024 lds
    v_mfma_f32_16x16x32_bf16 v[120:123], v[56:59], v[44:47], v[120:123]
    s_setprio 0
    ds_read_b64_tr_b16 v[56:57], v12 offset:0
    ds_read_b64_tr_b16 v[58:59], v12 offset:1024
    v_mfma_f32_16x16x32_bf16 v[76:79], v[60:63], v[32:35], v[76:79]
    v_mfma_f32_16x16x32_bf16 v[92:95], v[60:63], v[36:39], v[92:95]
    v_mfma_f32_16x16x32_bf16 v[108:111], v[60:63], v[40:43], v[108:111]
    v_mfma_f32_16x16x32_bf16 v[124:127], v[60:63], v[44:47], v[124:127]
    ds_read_b64_tr_b16 v[60:61], v12 offset:8192
    ds_read_b64_tr_b16 v[62:63], v12 offset:9216
    s_waitcnt lgkmcnt(6)
    v_mfma_f32_16x16x32_bf16 v[64:67], v[48:51], v[16:19], v[64:67]
    v_mfma_f32_16x16x32_bf16 v[80:83], v[48:51], v[20:23], v[80:83]
    v_mfma_f32_16x16x32_bf16 v[96:99], v[48:51], v[24:27], v[96:99]
    v_mfma_f32_16x16x32_bf16 v[112:115], v[48:51], v[28:31], v[112:115]
    s_waitcnt vmcnt(4) lgkmcnt(0)
    s_barrier
    ds_read_b64_tr_b16 v[48:49], v11 offset:16384
    ds_read_b64_tr_b16 v[50:51], v11 offset:17408
    v_mfma_f32_16x16x32_bf16 v[68:71], v[52:55], v[16:19], v[68:71]
    ds_read_b128 v[32:35], v10 offset:0
    v_mfma_f32_16x16x32_bf16 v[84:87], v[52:55], v[20:23], v[84:87]
    ds_read_b128 v[36:39], v10 offset:2048
    v_mfma_f32_16x16x32_bf16 v[100:103], v[52:55], v[24:27], v[100:103]
    ds_read_b128 v[40:43], v10 offset:4096
    v_mfma_f32_16x16x32_bf16 v[116:119], v[52:55], v[28:31], v[116:119]
    ds_read_b128 v[44:47], v10 offset:6144
    ds_read_b64_tr_b16 v[52:53], v11 offset:24576
    ds_read_b64_tr_b16 v[54:55], v11 offset:25600
    v_mfma_f32_16x16x32_bf16 v[72:75], v[56:59], v[16:19], v[72:75]
    s_add_u32 m0, s49, 0
    s_mov_b32 s51, 1658880
    v_mfma_f32_16x16x32_bf16 v[88:91], v[56:59], v[20:23], v[88:91]
    buffer_load_dwordx4 v5, s[32:35], s51 offen offset:0 lds
    v_mfma_f32_16x16x32_bf16 v[104:107], v[56:59], v[24:27], v[104:107]
    buffer_load_dwordx4 v6, s[32:35], s51 offen offset:1024 lds
    v_mfma_f32_16x16x32_bf16 v[120:123], v[56:59], v[28:31], v[120:123]
    s_setprio 0
    ds_read_b64_tr_b16 v[56:57], v12 offset:16384
    ds_read_b64_tr_b16 v[58:59], v12 offset:17408
    v_mfma_f32_16x16x32_bf16 v[76:79], v[60:63], v[16:19], v[76:79]
    v_mfma_f32_16x16x32_bf16 v[92:95], v[60:63], v[20:23], v[92:95]
    v_mfma_f32_16x16x32_bf16 v[108:111], v[60:63], v[24:27], v[108:111]
    v_mfma_f32_16x16x32_bf16 v[124:127], v[60:63], v[28:31], v[124:127]
    ds_read_b64_tr_b16 v[60:61], v12 offset:24576
    ds_read_b64_tr_b16 v[62:63], v12 offset:25600
    s_waitcnt lgkmcnt(6)
    v_mfma_f32_16x16x32_bf16 v[64:67], v[48:51], v[32:35], v[64:67]
    v_mfma_f32_16x16x32_bf16 v[80:83], v[48:51], v[36:39], v[80:83]
    v_mfma_f32_16x16x32_bf16 v[96:99], v[48:51], v[40:43], v[96:99]
    v_mfma_f32_16x16x32_bf16 v[112:115], v[48:51], v[44:47], v[112:115]
    s_waitcnt vmcnt(2) lgkmcnt(0)
    s_barrier
    ds_read_b64_tr_b16 v[48:49], v11 offset:32768
    ds_read_b64_tr_b16 v[50:51], v11 offset:33792
    v_mfma_f32_16x16x32_bf16 v[68:71], v[52:55], v[32:35], v[68:71]
    ds_read_b128 v[16:19], v9 offset:16384
    v_mfma_f32_16x16x32_bf16 v[84:87], v[52:55], v[36:39], v[84:87]
    ds_read_b128 v[20:23], v9 offset:18432
    v_mfma_f32_16x16x32_bf16 v[100:103], v[52:55], v[40:43], v[100:103]
    ds_read_b128 v[24:27], v9 offset:20480
    v_mfma_f32_16x16x32_bf16 v[116:119], v[52:55], v[44:47], v[116:119]
    ds_read_b128 v[28:31], v9 offset:22528
    ds_read_b64_tr_b16 v[52:53], v11 offset:40960
    ds_read_b64_tr_b16 v[54:55], v11 offset:41984
    v_mfma_f32_16x16x32_bf16 v[72:75], v[56:59], v[32:35], v[72:75]
    s_add_u32 m0, s49, 16384
    s_mov_b32 s51, 1769472
    buffer_load_dwordx4 v5, s[32:35], s51 offen offset:0 lds
    v_mfma_f32_16x16x32_bf16 v[88:91], v[56:59], v[36:39], v[88:91]
    buffer_load_dwordx4 v6, s[32:35], s51 offen offset:1024 lds
    s_add_u32 m0, s48, 0
    s_movk_i32 s50, 1024
    v_mfma_f32_16x16x32_bf16 v[104:107], v[56:59], v[40:43], v[104:107]
    buffer_load_dwordx4 v3, s[28:31], s50 offen offset:0 lds
    buffer_load_dwordx4 v4, s[28:31], s50 offen offset:1024 lds
    v_mfma_f32_16x16x32_bf16 v[120:123], v[56:59], v[44:47], v[120:123]
    s_setprio 0
    ds_read_b64_tr_b16 v[56:57], v12 offset:32768
    ds_read_b64_tr_b16 v[58:59], v12 offset:33792
    v_mfma_f32_16x16x32_bf16 v[76:79], v[60:63], v[32:35], v[76:79]
    v_mfma_f32_16x16x32_bf16 v[92:95], v[60:63], v[36:39], v[92:95]
    v_mfma_f32_16x16x32_bf16 v[108:111], v[60:63], v[40:43], v[108:111]
    v_mfma_f32_16x16x32_bf16 v[124:127], v[60:63], v[44:47], v[124:127]
    ds_read_b64_tr_b16 v[60:61], v12 offset:40960
    ds_read_b64_tr_b16 v[62:63], v12 offset:41984
    s_waitcnt lgkmcnt(6)
    v_mfma_f32_16x16x32_bf16 v[64:67], v[48:51], v[16:19], v[64:67]
    v_mfma_f32_16x16x32_bf16 v[80:83], v[48:51], v[20:23], v[80:83]
    v_mfma_f32_16x16x32_bf16 v[96:99], v[48:51], v[24:27], v[96:99]
    v_mfma_f32_16x16x32_bf16 v[112:115], v[48:51], v[28:31], v[112:115]
    s_waitcnt vmcnt(4) lgkmcnt(0)
    s_barrier
    ds_read_b64_tr_b16 v[48:49], v11 offset:0
    ds_read_b64_tr_b16 v[50:51], v11 offset:1024
    v_mfma_f32_16x16x32_bf16 v[68:71], v[52:55], v[16:19], v[68:71]
    ds_read_b128 v[32:35], v10 offset:16384
    v_mfma_f32_16x16x32_bf16 v[84:87], v[52:55], v[20:23], v[84:87]
    ds_read_b128 v[36:39], v10 offset:18432
    v_mfma_f32_16x16x32_bf16 v[100:103], v[52:55], v[24:27], v[100:103]
    ds_read_b128 v[40:43], v10 offset:20480
    v_mfma_f32_16x16x32_bf16 v[116:119], v[52:55], v[28:31], v[116:119]
    ds_read_b128 v[44:47], v10 offset:22528
    ds_read_b64_tr_b16 v[52:53], v11 offset:8192
    ds_read_b64_tr_b16 v[54:55], v11 offset:9216
    v_mfma_f32_16x16x32_bf16 v[72:75], v[56:59], v[16:19], v[72:75]
    s_add_u32 m0, s49, 32768
    s_mov_b32 s51, 1880064
    v_mfma_f32_16x16x32_bf16 v[88:91], v[56:59], v[20:23], v[88:91]
    buffer_load_dwordx4 v5, s[32:35], s51 offen offset:0 lds
    v_mfma_f32_16x16x32_bf16 v[104:107], v[56:59], v[24:27], v[104:107]
    buffer_load_dwordx4 v6, s[32:35], s51 offen offset:1024 lds
    v_mfma_f32_16x16x32_bf16 v[120:123], v[56:59], v[28:31], v[120:123]
    s_setprio 2
    ds_read_b64_tr_b16 v[56:57], v12 offset:0
    ds_read_b64_tr_b16 v[58:59], v12 offset:1024
    v_mfma_f32_16x16x32_bf16 v[76:79], v[60:63], v[16:19], v[76:79]
    v_mfma_f32_16x16x32_bf16 v[92:95], v[60:63], v[20:23], v[92:95]
    v_mfma_f32_16x16x32_bf16 v[108:111], v[60:63], v[24:27], v[108:111]
    v_mfma_f32_16x16x32_bf16 v[124:127], v[60:63], v[28:31], v[124:127]
    ds_read_b64_tr_b16 v[60:61], v12 offset:8192
    ds_read_b64_tr_b16 v[62:63], v12 offset:9216
    s_waitcnt lgkmcnt(6)
    v_mfma_f32_16x16x32_bf16 v[64:67], v[48:51], v[32:35], v[64:67]
    v_mfma_f32_16x16x32_bf16 v[80:83], v[48:51], v[36:39], v[80:83]
    v_mfma_f32_16x16x32_bf16 v[96:99], v[48:51], v[40:43], v[96:99]
    v_mfma_f32_16x16x32_bf16 v[112:115], v[48:51], v[44:47], v[112:115]
    s_waitcnt vmcnt(2) lgkmcnt(0)
    s_barrier
    ds_read_b64_tr_b16 v[48:49], v11 offset:16384
    ds_read_b64_tr_b16 v[50:51], v11 offset:17408
    v_mfma_f32_16x16x32_bf16 v[68:71], v[52:55], v[32:35], v[68:71]
    ds_read_b128 v[16:19], v9 offset:0
    v_mfma_f32_16x16x32_bf16 v[84:87], v[52:55], v[36:39], v[84:87]
    ds_read_b128 v[20:23], v9 offset:2048
    v_mfma_f32_16x16x32_bf16 v[100:103], v[52:55], v[40:43], v[100:103]
    ds_read_b128 v[24:27], v9 offset:4096
    v_mfma_f32_16x16x32_bf16 v[116:119], v[52:55], v[44:47], v[116:119]
    ds_read_b128 v[28:31], v9 offset:6144
    ds_read_b64_tr_b16 v[52:53], v11 offset:24576
    ds_read_b64_tr_b16 v[54:55], v11 offset:25600
    v_mfma_f32_16x16x32_bf16 v[72:75], v[56:59], v[32:35], v[72:75]
    s_add_u32 m0, s49, 0
    s_mov_b32 s51, 1990656
    buffer_load_dwordx4 v5, s[32:35], s51 offen offset:0 lds
    v_mfma_f32_16x16x32_bf16 v[88:91], v[56:59], v[36:39], v[88:91]
    buffer_load_dwordx4 v6, s[32:35], s51 offen offset:1024 lds
    s_add_u32 m0, s48, 16384
    s_movk_i32 s50, 1152
    v_mfma_f32_16x16x32_bf16 v[104:107], v[56:59], v[40:43], v[104:107]
    buffer_load_dwordx4 v3, s[28:31], s50 offen offset:0 lds
    buffer_load_dwordx4 v4, s[28:31], s50 offen offset:1024 lds
    v_mfma_f32_16x16x32_bf16 v[120:123], v[56:59], v[44:47], v[120:123]
    s_setprio 0
    s_cmp_lg_u32 s26, 0
    s_cbranch_scc1 Lg_hb
Lg_cb:
    v_readfirstlane_b32 s63, v13
    s_add_u32 s62, s62, 1
    s_cmp_ge_u32 s63, 1
    s_cbranch_scc1 Lg_kb
    s_sleep 1
    buffer_load_dword v13, v14, s[84:87], 0 offen sc1
    s_waitcnt vmcnt(0)
    s_cmp_lt_u32 s62, 0x200000
    s_cbranch_scc1 Lg_cb
Lg_kb:
    buffer_load_dword v13, v14, s[76:79], s97 offen sc1
Lg_hb:
    ds_read_b64_tr_b16 v[56:57], v12 offset:16384
    ds_read_b64_tr_b16 v[58:59], v12 offset:17408
    v_mfma_f32_16x16x32_bf16 v[76:79], v[60:63], v[32:35], v[76:79]
    v_mfma_f32_16x16x32_bf16 v[92:95], v[60:63], v[36:39], v[92:95]
    v_mfma_f32_16x16x32_bf16 v[108:111], v[60:63], v[40:43], v[108:111]
    v_mfma_f32_16x16x32_bf16 v[124:127], v[60:63], v[44:47], v[124:127]
    ds_read_b64_tr_b16 v[60:61], v12 offset:24576
    ds_read_b64_tr_b16 v[62:63], v12 offset:25600
    s_waitcnt lgkmcnt(6)
    v_mfma_f32_16x16x32_bf16 v[64:67], v[48:51], v[16:19], v[64:67]
    v_mfma_f32_16x16x32_bf16 v[80:83], v[48:51], v[20:23], v[80:83]
    v_mfma_f32_16x16x32_bf16 v[96:99], v[48:51], v[24:27], v[96:99]
    v_mfma_f32_16x16x32_bf16 v[112:115], v[48:51], v[28:31], v[112:115]
    s_waitcnt vmcnt(4) lgkmcnt(0)
    s_barrier
    ds_read_b64_tr_b16 v[48:49], v11 offset:32768
    ds_read_b64_tr_b16 v[50:51], v11 offset:33792
    v_mfma_f32_16x16x32_bf16 v[68:71], v[52:55], v[16:19], v[68:71]
    ds_read_b128 v[32:35], v10 offset:0
    v_mfma_f32_16x16x32_bf16 v[84:87], v[52:55], v[20:23], v[84:87]
    ds_read_b128 v[36:39], v10 offset:2048
    v_mfma_f32_16x16x32_bf16 v[100:103], v[52:55], v[24:27], v[100:103]
    ds_read_b128 v[40:43], v10 offset:4096
    v_mfma_f32_16x16x32_bf16 v[116:119], v[52:55], v[28:31], v[116:119]
    ds_read_b128 v[44:47], v10 offset:6144
    ds_read_b64_tr_b16 v[52:53], v11 offset:40960
    ds_read_b64_tr_b16 v[54:55], v11 offset:41984
    v_mfma_f32_16x16x32_bf16 v[72:75], v[56:59], v[16:19], v[72:75]
    s_add_u32 m0, s49, 16384
    s_mov_b32 s51, 2101248
    v_mfma_f32_16x16x32_bf16 v[88:91], v[56:59], v[20:23], v[88:91]
    buffer_load_dwordx4 v5, s[32:35], s51 offen offset:0 lds
    v_mfma_f32_16x16x32_bf16 v[104:107], v[56:59], v[24:27], v[104:107]
    buffer_load_dwordx4 v6, s[32:35], s51 offen offset:1024 lds
    v_mfma_f32_16x16x32_bf16 v[120:123], v[56:59], v[28:31], v[120:123]
    s_setprio 0
    ds_read_b64_tr_b16 v[56:57], v12 offset:32768
    ds_read_b64_tr_b16 v[58:59], v12 offset:33792
    v_mfma_f32_16x16x32_bf16 v[76:79], v[60:63], v[16:19], v[76:79]
    v_mfma_f32_16x16x32_bf16 v[92:95], v[60:63], v[20:23], v[92:95]
    v_mfma_f32_16x16x32_bf16 v[108:111], v[60:63], v[24:27], v[108:111]
    v_mfma_f32_16x16x32_bf16 v[124:127], v[60:63], v[28:31], v[124:127]
    ds_read_b64_tr_b16 v[60:61], v12 offset:40960
    ds_read_b64_tr_b16 v[62:63], v12 offset:41984
    s_waitcnt lgkmcnt(6)
    v_mfma_f32_16x16x32_bf16 v[64:67], v[48:51], v[32:35], v[64:67]
    v_mfma_f32_16x16x32_bf16 v[80:83], v[48:51], v[36:39], v[80:83]
    v_mfma_f32_16x16x32_bf16 v[96:99], v[48:51], v[40:43], v[96:99]
    v_mfma_f32_16x16x32_bf16 v[112:115], v[48:51], v[44:47], v[112:115]
    s_waitcnt vmcnt(2) lgkmcnt(0)
    s_barrier
    ds_read_b64_tr_b16 v[48:49], v11 offset:0
    ds_read_b64_tr_b16 v[50:51], v11 offset:1024
    v_mfma_f32_16x16x32_bf16 v[68:71], v[52:55], v[32:35], v[68:71]
    ds_read_b128 v[16:19], v9 offset:16384
    v_mfma_f32_16x16x32_bf16 v[84:87], v[52:55], v[36:39], v[84:87]
    ds_read_b128 v[20:23], v9 offset:18432
    v_mfma_f32_16x16x32_bf16 v[100:103], v[52:55], v[40:43], v[100:103]
    ds_read_b128 v[24:27], v9 offset:20480
    v_mfma_f32_16x16x32_bf16 v[116:119], v[52:55], v[44:47], v[116:119]
    ds_read_b128 v[28:31], v9 offset:22528
    ds_read_b64_tr_b16 v[52:53], v11 offset:8192
    ds_read_b64_tr_b16 v[54:55], v11 offset:9216
    v_mfma_f32_16x16x32_bf16 v[72:75], v[56:59], v[32:35], v[72:75]
    s_setprio 0
    v_mfma_f32_16x16x32_bf16 v[88:91], v[56:59], v[36:39], v[88:91]
    v_mfma_f32_16x16x32_bf16 v[104:107], v[56:59], v[40:43], v[104:107]
    v_mfma_f32_16x16x32_bf16 v[120:123], v[56:59], v[44:47], v[120:123]
    ds_read_b64_tr_b16 v[56:57], v12 offset:0
    ds_read_b64_tr_b16 v[58:59], v12 offset:1024
    v_mfma_f32_16x16x32_bf16 v[76:79], v[60:63], v[32:35], v[76:79]
    v_mfma_f32_16x16x32_bf16 v[92:95], v[60:63], v[36:39], v[92:95]
    v_mfma_f32_16x16x32_bf16 v[108:111], v[60:63], v[40:43], v[108:111]
    v_mfma_f32_16x16x32_bf16 v[124:127], v[60:63], v[44:47], v[124:127]
    ds_read_b64_tr_b16 v[60:61], v12 offset:8192
    ds_read_b64_tr_b16 v[62:63], v12 offset:9216
    s_waitcnt lgkmcnt(6)
    v_mfma_f32_16x16x32_bf16 v[64:67], v[48:51], v[16:19], v[64:67]
    v_mfma_f32_16x16x32_bf16 v[80:83], v[48:51], v[20:23], v[80:83]
    v_mfma_f32_16x16x32_bf16 v[96:99], v[48:51], v[24:27], v[96:99]
    v_mfma_f32_16x16x32_bf16 v[112:115], v[48:51], v[28:31], v[112:115]
    s_waitcnt vmcnt(0) lgkmcnt(0)
    s_barrier
    ds_read_b64_tr_b16 v[48:49], v11 offset:16384
    ds_read_b64_tr_b16 v[50:51], v11 offset:17408
    v_mfma_f32_16x16x32_bf16 v[68:71], v[52:55], v[16:19], v[68:71]
    ds_read_b128 v[32:35], v10 offset:16384
    v_mfma_f32_16x16x32_bf16 v[84:87], v[52:55], v[20:23], v[84:87]
    ds_read_b128 v[36:39], v10 offset:18432
    v_mfma_f32_16x16x32_bf16 v[100:103], v[52:55], v[24:27], v[100:103]
    ds_read_b128 v[40:43], v10 offset:20480
    v_mfma_f32_16x16x32_bf16 v[116:119], v[52:55], v[28:31], v[116:119]
    ds_read_b128 v[44:47], v10 offset:22528
    ds_read_b64_tr_b16 v[52:53], v11 offset:24576
    ds_read_b64_tr_b16 v[54:55], v11 offset:25600
    v_mfma_f32_16x16x32_bf16 v[72:75], v[56:59], v[16:19], v[72:75]
    s_setprio 2
    v_mfma_f32_16x16x32_bf16 v[88:91], v[56:59], v[20:23], v[88:91]
    v_mfma_f32_16x16x32_bf16 v[104:107], v[56:59], v[24:27], v[104:107]
    v_mfma_f32_16x16x32_bf16 v[120:123], v[56:59], v[28:31], v[120:123]
    ds_read_b64_tr_b16 v[56:57], v12 offset:16384
    ds_read_b64_tr_b16 v[58:59], v12 offset:17408
    v_mfma_f32_16x16x32_bf16 v[76:79], v[60:63], v[16:19], v[76:79]
    v_mfma_f32_16x16x32_bf16 v[92:95], v[60:63], v[20:23], v[92:95]
    v_mfma_f32_16x16x32_bf16 v[108:111], v[60:63], v[24:27], v[108:111]
    v_mfma_f32_16x16x32_bf16 v[124:127], v[60:63], v[28:31], v[124:127]
    ds_read_b64_tr_b16 v[60:61], v12 offset:24576
    ds_read_b64_tr_b16 v[62:63], v12 offset:25600
    s_waitcnt lgkmcnt(0)
    v_mfma_f32_16x16x32_bf16 v[64:67], v[48:51], v[32:35], v[64:67]
    v_mfma_f32_16x16x32_bf16 v[68:71], v[52:55], v[32:35], v[68:71]
    v_mfma_f32_16x16x32_bf16 v[72:75], v[56:59], v[32:35], v[72:75]
    v_mfma_f32_16x16x32_bf16 v[76:79], v[60:63], v[32:35], v[76:79]
    s_setprio 2
    s_cmp_lg_u32 s26, 0
    s_cbranch_scc1 Lg_hc
Lg_cc:
    v_readfirstlane_b32 s63, v13
    s_add_u32 s62, s62, 1
    s_cmp_ge_u32 s63, 32
    s_cbranch_scc1 Lg_kc
    s_sleep 1
    buffer_load_dword v13, v14, s[76:79], s97 offen sc1
    s_waitcnt vmcnt(0)
    s_cmp_lt_u32 s62, 0x200000
    s_cbranch_scc1 Lg_cc
Lg_kc:
Lg_hc:
    v_mfma_f32_16x16x32_bf16 v[80:83], v[48:51], v[36:39], v[80:83]
    v_mfma_f32_16x16x32_bf16 v[84:87], v[52:55], v[36:39], v[84:87]
    v_mfma_f32_16x16x32_bf16 v[88:91], v[56:59], v[36:39], v[88:91]
    v_mfma_f32_16x16x32_bf16 v[92:95], v[60:63], v[36:39], v[92:95]
    v_mfma_f32_16x16x32_bf16 v[96:99], v[48:51], v[40:43], v[96:99]
    v_pk_mul_f32 v[64:65], v[64:65], v[68:69]
    v_pk_mul_f32 v[66:67], v[66:67], v[70:71]
    v_cvt_pk_bf16_f32 v16, v64, v65
    v_mfma_f32_16x16x32_bf16 v[100:103], v[52:55], v[40:43], v[100:103]
    v_cvt_pk_bf16_f32 v17, v66, v67
    v_pk_mul_f32 v[72:73], v[72:73], v[76:77]
    v_pk_mul_f32 v[74:75], v[74:75], v[78:79]
    v_mfma_f32_16x16x32_bf16 v[104:107], v[56:59], v[40:43], v[104:107]
    v_cvt_pk_bf16_f32 v18, v72, v73
    v_cvt_pk_bf16_f32 v19, v74, v75
    buffer_store_dwordx4 v[16:19], v8, s[40:43], s55 offen sc1
    s_add_u32 s55, s55, 75776
    v_mfma_f32_16x16x32_bf16 v[108:111], v[60:63], v[40:43], v[108:111]
    v_mfma_f32_16x16x32_bf16 v[112:115], v[48:51], v[44:47], v[112:115]
    v_pk_mul_f32 v[80:81], v[80:81], v[84:85]
    v_pk_mul_f32 v[82:83], v[82:83], v[86:87]
    v_cvt_pk_bf16_f32 v20, v80, v81
    v_mfma_f32_16x16x32_bf16 v[116:119], v[52:55], v[44:47], v[116:119]
    v_cvt_pk_bf16_f32 v21, v82, v83
    v_pk_mul_f32 v[88:89], v[88:89], v[92:93]
    v_pk_mul_f32 v[90:91], v[90:91], v[94:95]
    v_mfma_f32_16x16x32_bf16 v[120:123], v[56:59], v[44:47], v[120:123]
    v_cvt_pk_bf16_f32 v22, v88, v89
    v_cvt_pk_bf16_f32 v23, v90, v91
    buffer_store_dwordx4 v[20:23], v8, s[40:43], s55 offen sc1
    s_add_u32 s55, s55, 75776
    v_mfma_f32_16x16x32_bf16 v[124:127], v[60:63], v[44:47], v[124:127]
    v_pk_mul_f32 v[96:97], v[96:97], v[100:101]
    v_pk_mul_f32 v[98:99], v[98:99], v[102:103]
    v_cvt_pk_bf16_f32 v24, v96, v97
    v_cvt_pk_bf16_f32 v25, v98, v99
    v_pk_mul_f32 v[104:105], v[104:105], v[108:109]
    v_pk_mul_f32 v[106:107], v[106:107], v[110:111]
    v_cvt_pk_bf16_f32 v26, v104, v105
    v_cvt_pk_bf16_f32 v27, v106, v107
    buffer_store_dwordx4 v[24:27], v8, s[40:43], s55 offen sc1
    s_add_u32 s55, s55, 75776
    v_pk_mul_f32 v[112:113], v[112:113], v[116:117]
    v_pk_mul_f32 v[114:115], v[114:115], v[118:119]
    v_cvt_pk_bf16_f32 v28, v112, v113
    v_cvt_pk_bf16_f32 v29, v114, v115
    v_pk_mul_f32 v[120:121], v[120:121], v[124:125]
    v_pk_mul_f32 v[122:123], v[122:123], v[126:127]
    v_cvt_pk_bf16_f32 v30, v120, v121
    v_cvt_pk_bf16_f32 v31, v122, v123
    buffer_store_dwordx4 v[28:31], v8, s[40:43], s55 offen sc1
    s_add_u32 s55, s55, 75776
Lg_nost:
    s_waitcnt vmcnt(0)
    s_barrier
    s_cmp_lg_u32 s26, 0
    s_cbranch_scc1 Lg_sig
    v_mov_b32 v1, 1
    v_lshlrev_b32 v7, 8, v2
    s_mov_b64 exec, 1
    buffer_atomic_add v1, v7, s[76:79], s58 offen sc1
    s_mov_b64 exec, -1
Lg_sig:
    v_lshlrev_b32 v8, 4, v2
    s_add_u32 m0, s64, 0
    s_add_u32 s46, s65, 0
    buffer_load_dwordx4 v8, s[80:83], s46 offen sc1 lds
    buffer_load_dwordx4 v8, s[80:83], s46 offen offset:1024 sc1 lds
    s_mov_b64 exec, s[98:99]
    buffer_load_dwordx4 v8, s[80:83], s46 offen offset:2048 sc1 lds
    s_mov_b64 exec, -1
    s_add_u32 m0, s64, 20480
    s_add_u32 s46, s65, 20480
    buffer_load_dwordx4 v8, s[80:83], s46 offen sc1 lds
    buffer_load_dwordx4 v8, s[80:83], s46 offen offset:1024 sc1 lds
    s_mov_b64 exec, s[98:99]
    buffer_load_dwordx4 v8, s[80:83], s46 offen offset:2048 sc1 lds
    s_mov_b64 exec, -1
    s_add_u32 m0, s64, 40960
    s_add_u32 s46, s65, 40960
    buffer_load_dwordx4 v8, s[80:83], s46 offen sc1 lds
    buffer_load_dwordx4 v8, s[80:83], s46 offen offset:1024 sc1 lds
    s_mov_b64 exec, s[98:99]
    buffer_load_dwordx4 v8, s[80:83], s46 offen offset:2048 sc1 lds
    s_mov_b64 exec, -1
    s_branch Lg_dn
Lg_feed:
    s_waitcnt vmcnt(6)
    s_barrier
    s_waitcnt vmcnt(4)
    s_barrier
    s_add_u32 m0, s49, 0
    s_mov_b32 s51, 331776
    buffer_load_dwordx4 v5, s[32:35], s51 offen offset:0 lds
    buffer_load_dwordx4 v6, s[32:35], s51 offen offset:1024 lds
    s_waitcnt vmcnt(2)
    s_barrier
    s_add_u32 m0, s49, 16384
    s_mov_b32 s51, 442368
    buffer_load_dwordx4 v5, s[32:35], s51 offen offset:0 lds
    buffer_load_dwordx4 v6, s[32:35], s51 offen offset:1024 lds
    s_add_u32 m0, s48, 0
    s_movk_i32 s50, 256
    buffer_load_dwordx4 v3, s[28:31], s50 offen offset:0 lds
    buffer_load_dwordx4 v4, s[28:31], s50 offen offset:1024 lds
    s_waitcnt vmcnt(4)
    s_barrier
    s_add_u32 m0, s49, 32768
    s_mov_b32 s51, 552960
    buffer_load_dwordx4 v5, s[32:35], s51 offen offset:0 lds
    buffer_load_dwordx4 v6, s[32:35], s51 offen offset:1024 lds
    s_waitcnt vmcnt(2)
    s_barrier
    s_add_u32 m0, s49, 0
    s_mov_b32 s51, 663552
    buffer_load_dwordx4 v5, s[32:35], s51 offen offset:0 lds
    buffer_load_dwordx4 v6, s[32:35], s51 offen offset:1024 lds
    s_add_u32 m0, s48, 16384
    s_movk_i32 s50, 384
    buffer_load_dwordx4 v3, s[28:31], s50 offen offset:0 lds
    buffer_load_dwordx4 v4, s[28:31], s50 offen offset:1024 lds
    s_waitcnt vmcnt(4)
    s_barrier
    s_add_u32 m0, s49, 16384
    s_mov_b32 s51, 774144
    buffer_load_dwordx4 v5, s[32:35], s51 offen offset:0 lds
    buffer_load_dwordx4 v6, s[32:35], s51 offen offset:1024 lds
    s_waitcnt vmcnt(2)
    s_barrier
    s_add_u32 m0, s49, 32768
    s_mov_b32 s51, 884736
    buffer_load_dwordx4 v5, s[32:35], s51 offen offset:0 lds
    buffer_load_dwordx4 v6, s[32:35], s51 offen offset:1024 lds
    s_add_u32 m0, s48, 0
    s_movk_i32 s50, 512
    buffer_load_dwordx4 v3, s[28:31], s50 offen offset:0 lds
    buffer_load_dwordx4 v4, s[28:31], s50 offen offset:1024 lds
    s_waitcnt vmcnt(4)
    s_barrier
    s_add_u32 m0, s49, 0
    s_mov_b32 s51, 995328
    buffer_load_dwordx4 v5, s[32:35], s51 offen offset:0 lds
    buffer_load_dwordx4 v6, s[32:35], s51 offen offset:1024 lds
    s_waitcnt vmcnt(2)
    s_barrier
    s_add_u32 m0, s49, 16384
    s_mov_b32 s51, 1105920
    buffer_load_dwordx4 v5, s[32:35], s51 offen offset:0 lds
    buffer_load_dwordx4 v6, s[32:35], s51 offen offset:1024 lds
    s_add_u32 m0, s48, 16384
    s_movk_i32 s50, 640
    buffer_load_dwordx4 v3, s[28:31], s50 offen offset:0 lds
    buffer_load_dwordx4 v4, s[28:31], s50 offen offset:1024 lds
    s_waitcnt vmcnt(4)
    s_barrier
    s_add_u32 m0, s49, 32768
    s_mov_b32 s51, 1216512
    buffer_load_dwordx4 v5, s[32:35], s51 offen offset:0 lds
    buffer_load_dwordx4 v6, s[32:35], s51 offen offset:1024 lds
    s_waitcnt vmcnt(2)
    s_barrier
    s_add_u32 m0, s49, 0
    s_mov_b32 s51, 1327104
    buffer_load_dwordx4 v5, s[32:35], s51 offen offset:0 lds
    buffer_load_dwordx4 v6, s[32:35], s51 offen offset:1024 lds
    s_add_u32 m0, s48, 0
    s_movk_i32 s50, 768
    buffer_load_dwordx4 v3, s[28:31], s50 offen offset:0 lds
    buffer_load_dwordx4 v4, s[28:31], s50 offen offset:1024 lds
    s_waitcnt vmcnt(4)
    s_barrier
    s_add_u32 m0, s49, 16384
    s_mov_b32 s51, 1437696
    buffer_load_dwordx4 v5, s[32:35], s51 offen offset:0 lds
    buffer_load_dwordx4 v6, s[32:35], s51 offen offset:1024 lds
    s_waitcnt vmcnt(2)
    s_barrier
    s_add_u32 m0, s49, 32768
    s_mov_b32 s51, 1548288
    buffer_load_dwordx4 v5, s[32:35], s51 offen offset:0 lds
    buffer_load_dwordx4 v6, s[32:35], s51 offen offset:1024 lds
    s_add_u32 m0, s48, 16384
    s_movk_i32 s50, 896
    buffer_load_dwordx4 v3, s[28:31], s50 offen offset:0 lds
    buffer_load_dwordx4 v4, s[28:31], s50 offen offset:1024 lds
    s_waitcnt vmcnt(4)
    s_barrier
    s_add_u32 m0, s49, 0
    s_mov_b32 s51, 1658880
    buffer_load_dwordx4 v5, s[32:35], s51 offen offset:0 lds
    buffer_load_dwordx4 v6, s[32:35], s51 offen offset:1024 lds
    s_waitcnt vmcnt(2)
    s_barrier
    s_add_u32 m0, s49, 16384
    s_mov_b32 s51, 1769472
    buffer_load_dwordx4 v5, s[32:35], s51 offen offset:0 lds
    buffer_load_dwordx4 v6, s[32:35], s51 offen offset:1024 lds
    s_add_u32 m0, s48, 0
    s_movk_i32 s50, 1024
    buffer_load_dwordx4 v3, s[28:31], s50 offen offset:0 lds
    buffer_load_dwordx4 v4, s[28:31], s50 offen offset:1024 lds
    s_waitcnt vmcnt(4)
    s_barrier
    s_add_u32 m0, s49, 32768
    s_mov_b32 s51, 1880064
    buffer_load_dwordx4 v5, s[32:35], s51 offen offset:0 lds
    buffer_load_dwordx4 v6, s[32:35], s51 offen offset:1024 lds
    s_waitcnt vmcnt(2)
    s_barrier
    s_add_u32 m0, s49, 0
    s_mov_b32 s51, 1990656
    buffer_load_dwordx4 v5, s[32:35], s51 offen offset:0 lds
    buffer_load_dwordx4 v6, s[32:35], s51 offen offset:1024 lds
    s_add_u32 m0, s48, 16384
    s_movk_i32 s50, 1152
    buffer_load_dwordx4 v3, s[28:31], s50 offen offset:0 lds
    buffer_load_dwordx4 v4, s[28:31], s50 offen offset:1024 lds
    s_waitcnt vmcnt(4)
    s_barrier
    s_add_u32 m0, s49, 16384
    s_mov_b32 s51, 2101248
    buffer_load_dwordx4 v5, s[32:35], s51 offen offset:0 lds
    buffer_load_dwordx4 v6, s[32:35], s51 offen offset:1024 lds
    s_waitcnt vmcnt(2)
    s_barrier
    s_waitcnt vmcnt(0)
    s_barrier
    s_setprio 2
    s_branch Lg_nost
Lg_idle:
    s_add_u32 s40, s24, 10485760
    s_addc_u32 s41, s25, 0
    s_mov_b32 s42, 9699328
    s_mov_b32 s43, 0x00020000
    s_setprio 2
    s_cmp_lg_u32 s26, 0
    s_cbranch_scc1 Lg_sti
    s_lshl_b32 s60, s54, 7
    s_add_u32 s60, s60, 32768
    v_mov_b32 v7, 0
    s_mov_b32 s62, 0
    s_mov_b64 exec, 1
    buffer_store_dword v7, v7, s[76:79], s60 offen sc1
    s_waitcnt vmcnt(0)
Lg_spi:
    buffer_load_dword v1, v7, s[76:79], s60 offen sc1
    s_add_u32 s62, s62, 1
    s_waitcnt vmcnt(0)
    v_readfirstlane_b32 s63, v1
    s_nop 0
    s_cmp_ge_u32 s63, 3
    s_cbranch_scc1 Lg_soi
    s_sleep 2
    s_cmp_lt_u32 s62, 32
    s_cbranch_scc1 Lg_spi
Lg_soi:
    s_mov_b64 exec, -1
Lg_sti:
    s_barrier
    s_cmp_lg_u32 s26, 0
    s_cbranch_scc1 Lg_ri_r
    s_mov_b32 s62, 0
    v_mov_b32 v7, 0
Lg_ri_p:
    buffer_load_dword v1, v7, s[84:87], 0 offen sc1
    s_waitcnt vmcnt(0)
    v_readfirstlane_b32 s63, v1
    s_add_u32 s62, s62, 1
    s_cmp_lg_u32 s63, 0
    s_cbranch_scc1 Lg_ri_r
    s_sleep 8
    s_cmp_lt_u32 s62, 0x200000
    s_cbranch_scc1 Lg_ri_p
Lg_ri_r:
    s_mov_b32 s28, s16
    s_mov_b32 s29, s17
    s_mov_b32 s30, 2211840
    s_mov_b32 s31, 0x00020000
    s_mov_b32 s32, s8
    s_mov_b32 s33, s9
    s_mov_b32 s34, 819200
    s_mov_b32 s35, 0x00020000
    s_sub_u32 s46, s54, 224
    s_mul_i32 s55, s26, 160
    s_mul_i32 s56, s26, 378880
    v_lshlrev_b32 v8, 4, v2
    v_add_u32 v3, 0, v2
    v_mul_u32_u24 v110, 6554, v3
    v_lshrrev_b32 v110, 16, v110
    v_mul_u32_u24 v5, 10, v110
    v_sub_u32 v3, v3, v5
    v_lshlrev_b32 v3, 4, v3
    v_add_u32 v115, s55, v3
    v_mul_u32_u24 v5, 1280, v110
    v_add_u32 v10, v5, v115
    v_add_u32 v3, 64, v2
    v_mul_u32_u24 v111, 6554, v3
    v_lshrrev_b32 v111, 16, v111
    v_mul_u32_u24 v5, 10, v111
    v_sub_u32 v3, v3, v5
    v_lshlrev_b32 v3, 4, v3
    v_add_u32 v116, s55, v3
    v_mul_u32_u24 v5, 1280, v111
    v_add_u32 v11, v5, v116
    v_add_u32 v3, 128, v2
    v_mul_u32_u24 v112, 6554, v3
    v_lshrrev_b32 v112, 16, v112
    v_mul_u32_u24 v5, 10, v112
    v_sub_u32 v3, v3, v5
    v_lshlrev_b32 v3, 4, v3
    v_add_u32 v117, s55, v3
    v_mul_u32_u24 v5, 1280, v112
    v_add_u32 v12, v5, v117
    v_add_u32 v3, 192, v2
    v_mul_u32_u24 v113, 6554, v3
    v_lshrrev_b32 v113, 16, v113
    v_mul_u32_u24 v5, 10, v113
    v_sub_u32 v3, v3, v5
    v_lshlrev_b32 v3, 4, v3
    v_add_u32 v118, s55, v3
    v_mul_u32_u24 v5, 1280, v113
    v_add_u32 v13, v5, v118
    v_add_u32 v3, 256, v2
    v_mul_u32_u24 v114, 6554, v3
    v_lshrrev_b32 v114, 16, v114
    v_mul_u32_u24 v5, 10, v114
    v_sub_u32 v3, v3, v5
    v_lshlrev_b32 v3, 4, v3
    v_add_u32 v119, s55, v3
    v_mul_u32_u24 v5, 1280, v114
    v_add_u32 v14, v5, v119
    s_mul_i32 s57, s46, 40960
    buffer_load_dwordx4 v[16:19], v10, s[28:31], s57 offen
    s_waitcnt vmcnt(1)
    buffer_load_dwordx4 v[20:23], v11, s[28:31], s57 offen
    s_waitcnt vmcnt(1)
    buffer_load_dwordx4 v[24:27], v12, s[28:31], s57 offen
    s_waitcnt vmcnt(1)
    buffer_load_dwordx4 v[28:31], v13, s[28:31], s57 offen
    s_waitcnt vmcnt(1)
    buffer_load_dwordx4 v[32:35], v14, s[28:31], s57 offen
    s_waitcnt vmcnt(1)
    s_mul_i32 s58, s46, 5120
    s_add_u32 s58, s58, s56
    s_mov_b32 s60, 3031040
    s_cmp_ge_u32 s46, 22
    s_cbranch_scc1 Lg_wo
    s_add_u32 s57, s57, 1310720
    buffer_load_dwordx4 v[36:39], v10, s[28:31], s57 offen
    s_waitcnt vmcnt(1)
    buffer_load_dwordx4 v[40:43], v11, s[28:31], s57 offen
    s_waitcnt vmcnt(1)
    buffer_load_dwordx4 v[44:47], v12, s[28:31], s57 offen
    s_waitcnt vmcnt(1)
    buffer_load_dwordx4 v[48:51], v13, s[28:31], s57 offen
    s_waitcnt vmcnt(1)
    buffer_load_dwordx4 v[52:55], v14, s[28:31], s57 offen
    s_waitcnt vmcnt(1)
    s_add_u32 s59, s58, 163840
    s_branch Lg_we
Lg_wo:
    s_sub_u32 s61, s46, 22
    s_lshl_b32 s61, s61, 1
    s_add_u32 s61, s61, 0
    s_add_u32 s59, s61, 54
    s_mul_i32 s59, s59, 5120
    s_add_u32 s59, s59, s56
    s_mul_i32 s62, s61, 52429
    s_lshr_b32 s62, s62, 18
    s_mul_i32 s63, s62, 5
    s_sub_u32 s61, s61, s63
    s_mul_i32 s62, s62, 204800
    s_mul_i32 s63, s61, 51200
    s_cmp_eq_u32 s61, 4
    s_cbranch_scc1 Lg_t1
    s_add_u32 s62, s62, s63
    v_lshrrev_b32 v3, 4, v110
    v_lshl_add_u32 v3, v3, 2, v110
    v_mul_u32_u24 v3, 1280, v3
    v_add_u32 v120, v3, v115
    v_lshrrev_b32 v3, 4, v111
    v_lshl_add_u32 v3, v3, 2, v111
    v_mul_u32_u24 v3, 1280, v3
    v_add_u32 v121, v3, v116
    v_lshrrev_b32 v3, 4, v112
    v_lshl_add_u32 v3, v3, 2, v112
    v_mul_u32_u24 v3, 1280, v3
    v_add_u32 v122, v3, v117
    v_lshrrev_b32 v3, 4, v113
    v_lshl_add_u32 v3, v3, 2, v113
    v_mul_u32_u24 v3, 1280, v3
    v_add_u32 v123, v3, v118
    v_lshrrev_b32 v3, 4, v114
    v_lshl_add_u32 v3, v3, 2, v114
    v_mul_u32_u24 v3, 1280, v3
    v_add_u32 v124, v3, v119
    s_branch Lg_l1
Lg_t1:
    v_lshrrev_b32 v3, 4, v110
    v_lshlrev_b32 v3, 2, v3
    v_bfe_u32 v4, v110, 2, 1
    v_lshl_add_u32 v3, v4, 1, v3
    v_bfe_u32 v4, v110, 3, 1
    v_add_u32 v3, v3, v4
    v_mul_u32_u24 v3, 20, v3
    v_and_b32 v4, 3, v110
    v_add3_u32 v3, v3, v4, 16
    v_mul_u32_u24 v3, 1280, v3
    v_add_u32 v120, v3, v115
    v_lshrrev_b32 v3, 4, v111
    v_lshlrev_b32 v3, 2, v3
    v_bfe_u32 v4, v111, 2, 1
    v_lshl_add_u32 v3, v4, 1, v3
    v_bfe_u32 v4, v111, 3, 1
    v_add_u32 v3, v3, v4
    v_mul_u32_u24 v3, 20, v3
    v_and_b32 v4, 3, v111
    v_add3_u32 v3, v3, v4, 16
    v_mul_u32_u24 v3, 1280, v3
    v_add_u32 v121, v3, v116
    v_lshrrev_b32 v3, 4, v112
    v_lshlrev_b32 v3, 2, v3
    v_bfe_u32 v4, v112, 2, 1
    v_lshl_add_u32 v3, v4, 1, v3
    v_bfe_u32 v4, v112, 3, 1
    v_add_u32 v3, v3, v4
    v_mul_u32_u24 v3, 20, v3
    v_and_b32 v4, 3, v112
    v_add3_u32 v3, v3, v4, 16
    v_mul_u32_u24 v3, 1280, v3
    v_add_u32 v122, v3, v117
    v_lshrrev_b32 v3, 4, v113
    v_lshlrev_b32 v3, 2, v3
    v_bfe_u32 v4, v113, 2, 1
    v_lshl_add_u32 v3, v4, 1, v3
    v_bfe_u32 v4, v113, 3, 1
    v_add_u32 v3, v3, v4
    v_mul_u32_u24 v3, 20, v3
    v_and_b32 v4, 3, v113
    v_add3_u32 v3, v3, v4, 16
    v_mul_u32_u24 v3, 1280, v3
    v_add_u32 v123, v3, v118
    v_lshrrev_b32 v3, 4, v114
    v_lshlrev_b32 v3, 2, v3
    v_bfe_u32 v4, v114, 2, 1
    v_lshl_add_u32 v3, v4, 1, v3
    v_bfe_u32 v4, v114, 3, 1
    v_add_u32 v3, v3, v4
    v_mul_u32_u24 v3, 20, v3
    v_and_b32 v4, 3, v114
    v_add3_u32 v3, v3, v4, 16
    v_mul_u32_u24 v3, 1280, v3
    v_add_u32 v124, v3, v119
Lg_l1:
    buffer_load_dwordx4 v[36:39], v120, s[32:35], s62 offen
    s_waitcnt vmcnt(1)
    buffer_load_dwordx4 v[40:43], v121, s[32:35], s62 offen
    s_waitcnt vmcnt(1)
    buffer_load_dwordx4 v[44:47], v122, s[32:35], s62 offen
    s_waitcnt vmcnt(1)
    buffer_load_dwordx4 v[48:51], v123, s[32:35], s62 offen
    s_waitcnt vmcnt(1)
    buffer_load_dwordx4 v[52:55], v124, s[32:35], s62 offen
    s_waitcnt vmcnt(1)
    s_sub_u32 s61, s46, 22
    s_lshl_b32 s61, s61, 1
    s_add_u32 s61, s61, 1
    s_add_u32 s60, s61, 54
    s_mul_i32 s60, s60, 5120
    s_add_u32 s60, s60, s56
    s_mul_i32 s62, s61, 52429
    s_lshr_b32 s62, s62, 18
    s_mul_i32 s63, s62, 5
    s_sub_u32 s61, s61, s63
    s_mul_i32 s62, s62, 204800
    s_mul_i32 s63, s61, 51200
    s_cmp_eq_u32 s61, 4
    s_cbranch_scc1 Lg_t2
    s_add_u32 s62, s62, s63
    v_lshrrev_b32 v3, 4, v110
    v_lshl_add_u32 v3, v3, 2, v110
    v_mul_u32_u24 v3, 1280, v3
    v_add_u32 v120, v3, v115
    v_lshrrev_b32 v3, 4, v111
    v_lshl_add_u32 v3, v3, 2, v111
    v_mul_u32_u24 v3, 1280, v3
    v_add_u32 v121, v3, v116
    v_lshrrev_b32 v3, 4, v112
    v_lshl_add_u32 v3, v3, 2, v112
    v_mul_u32_u24 v3, 1280, v3
    v_add_u32 v122, v3, v117
    v_lshrrev_b32 v3, 4, v113
    v_lshl_add_u32 v3, v3, 2, v113
    v_mul_u32_u24 v3, 1280, v3
    v_add_u32 v123, v3, v118
    v_lshrrev_b32 v3, 4, v114
    v_lshl_add_u32 v3, v3, 2, v114
    v_mul_u32_u24 v3, 1280, v3
    v_add_u32 v124, v3, v119
    s_branch Lg_l2
Lg_t2:
    v_lshrrev_b32 v3, 4, v110
    v_lshlrev_b32 v3, 2, v3
    v_bfe_u32 v4, v110, 2, 1
    v_lshl_add_u32 v3, v4, 1, v3
    v_bfe_u32 v4, v110, 3, 1
    v_add_u32 v3, v3, v4
    v_mul_u32_u24 v3, 20, v3
    v_and_b32 v4, 3, v110
    v_add3_u32 v3, v3, v4, 16
    v_mul_u32_u24 v3, 1280, v3
    v_add_u32 v120, v3, v115
    v_lshrrev_b32 v3, 4, v111
    v_lshlrev_b32 v3, 2, v3
    v_bfe_u32 v4, v111, 2, 1
    v_lshl_add_u32 v3, v4, 1, v3
    v_bfe_u32 v4, v111, 3, 1
    v_add_u32 v3, v3, v4
    v_mul_u32_u24 v3, 20, v3
    v_and_b32 v4, 3, v111
    v_add3_u32 v3, v3, v4, 16
    v_mul_u32_u24 v3, 1280, v3
    v_add_u32 v121, v3, v116
    v_lshrrev_b32 v3, 4, v112
    v_lshlrev_b32 v3, 2, v3
    v_bfe_u32 v4, v112, 2, 1
    v_lshl_add_u32 v3, v4, 1, v3
    v_bfe_u32 v4, v112, 3, 1
    v_add_u32 v3, v3, v4
    v_mul_u32_u24 v3, 20, v3
    v_and_b32 v4, 3, v112
    v_add3_u32 v3, v3, v4, 16
    v_mul_u32_u24 v3, 1280, v3
    v_add_u32 v122, v3, v117
    v_lshrrev_b32 v3, 4, v113
    v_lshlrev_b32 v3, 2, v3
    v_bfe_u32 v4, v113, 2, 1
    v_lshl_add_u32 v3, v4, 1, v3
    v_bfe_u32 v4, v113, 3, 1
    v_add_u32 v3, v3, v4
    v_mul_u32_u24 v3, 20, v3
    v_and_b32 v4, 3, v113
    v_add3_u32 v3, v3, v4, 16
    v_mul_u32_u24 v3, 1280, v3
    v_add_u32 v123, v3, v118
    v_lshrrev_b32 v3, 4, v114
    v_lshlrev_b32 v3, 2, v3
    v_bfe_u32 v4, v114, 2, 1
    v_lshl_add_u32 v3, v4, 1, v3
    v_bfe_u32 v4, v114, 3, 1
    v_add_u32 v3, v3, v4
    v_mul_u32_u24 v3, 20, v3
    v_and_b32 v4, 3, v114
    v_add3_u32 v3, v3, v4, 16
    v_mul_u32_u24 v3, 1280, v3
    v_add_u32 v124, v3, v119
Lg_l2:
    buffer_load_dwordx4 v[56:59], v120, s[32:35], s62 offen
    s_waitcnt vmcnt(1)
    buffer_load_dwordx4 v[60:63], v121, s[32:35], s62 offen
    s_waitcnt vmcnt(1)
    buffer_load_dwordx4 v[64:67], v122, s[32:35], s62 offen
    s_waitcnt vmcnt(1)
    buffer_load_dwordx4 v[68:71], v123, s[32:35], s62 offen
    s_waitcnt vmcnt(1)
    buffer_load_dwordx4 v[72:75], v124, s[32:35], s62 offen
    s_waitcnt vmcnt(1)
Lg_we:
    s_waitcnt vmcnt(0)
    s_mul_i32 s61, s26, 5120
    v_add_u32 v9, s61, v8
    v_lshrrev_b32 v3, 5, v2
    v_lshlrev_b32 v3, 4, v3
    v_bfe_u32 v4, v2, 4, 1
    v_lshl_add_u32 v3, v4, 2, v3
    v_bfe_u32 v4, v2, 2, 2
    v_add_u32 v3, v3, v4
    v_mul_u32_u24 v3, 160, v3
    v_and_b32 v4, 3, v2
    v_lshl_add_u32 v3, v4, 3, v3
    v_add_u32 v3, s61, v3
    v_lshrrev_b32 v4, 2, v2
    v_mul_u32_u24 v4, 160, v4
    v_and_b32 v5, 3, v2
    v_lshl_add_u32 v4, v5, 3, v4
    v_add_u32 v4, s61, v4
    v_add_u32 v5, 1280, v3
    v_add_u32 v6, 2560, v4
    s_sub_u32 s61, s54, 224
    s_cmp_lt_u32 s61, 22
    s_cselect_b64 vcc, -1, 0
    v_cndmask_b32 v10, v3, v4, vcc
    v_cndmask_b32 v11, v5, v6, vcc
    ds_write_b128 v9, v[16:19] offset:0
    ds_write_b128 v9, v[20:23] offset:1024
    ds_write_b128 v9, v[24:27] offset:2048
    ds_write_b128 v9, v[28:31] offset:3072
    ds_write_b128 v9, v[32:35] offset:4096
    s_waitcnt lgkmcnt(0)
    ds_read_b64_tr_b16 v[16:17], v4 offset:0
    ds_read_b64_tr_b16 v[18:19], v6 offset:0
    ds_read_b64_tr_b16 v[20:21], v4 offset:32
    ds_read_b64_tr_b16 v[22:23], v6 offset:32
    ds_read_b64_tr_b16 v[24:25], v4 offset:64
    ds_read_b64_tr_b16 v[26:27], v6 offset:64
    ds_read_b64_tr_b16 v[28:29], v4 offset:96
    ds_read_b64_tr_b16 v[30:31], v6 offset:96
    ds_read_b64_tr_b16 v[32:33], v4 offset:128
    ds_read_b64_tr_b16 v[34:35], v6 offset:128
    s_waitcnt lgkmcnt(0)
    buffer_store_dwordx4 v[16:19], v8, s[80:83], s58 offen offset:0 sc1
    buffer_store_dwordx4 v[20:23], v8, s[80:83], s58 offen offset:1024 sc1
    buffer_store_dwordx4 v[24:27], v8, s[80:83], s58 offen offset:2048 sc1
    buffer_store_dwordx4 v[28:31], v8, s[80:83], s58 offen offset:3072 sc1
    s_add_u32 s58, s58, 4096
    buffer_store_dwordx4 v[32:35], v8, s[80:83], s58 offen sc1
    ds_write_b128 v9, v[36:39] offset:0
    ds_write_b128 v9, v[40:43] offset:1024
    ds_write_b128 v9, v[44:47] offset:2048
    ds_write_b128 v9, v[48:51] offset:3072
    ds_write_b128 v9, v[52:55] offset:4096
    s_waitcnt lgkmcnt(0)
    ds_read_b64_tr_b16 v[36:37], v10 offset:0
    ds_read_b64_tr_b16 v[38:39], v11 offset:0
    ds_read_b64_tr_b16 v[40:41], v10 offset:32
    ds_read_b64_tr_b16 v[42:43], v11 offset:32
    ds_read_b64_tr_b16 v[44:45], v10 offset:64
    ds_read_b64_tr_b16 v[46:47], v11 offset:64
    ds_read_b64_tr_b16 v[48:49], v10 offset:96
    ds_read_b64_tr_b16 v[50:51], v11 offset:96
    ds_read_b64_tr_b16 v[52:53], v10 offset:128
    ds_read_b64_tr_b16 v[54:55], v11 offset:128
    s_waitcnt lgkmcnt(0)
    buffer_store_dwordx4 v[36:39], v8, s[80:83], s59 offen offset:0 sc1
    buffer_store_dwordx4 v[40:43], v8, s[80:83], s59 offen offset:1024 sc1
    buffer_store_dwordx4 v[44:47], v8, s[80:83], s59 offen offset:2048 sc1
    buffer_store_dwordx4 v[48:51], v8, s[80:83], s59 offen offset:3072 sc1
    s_add_u32 s59, s59, 4096
    buffer_store_dwordx4 v[52:55], v8, s[80:83], s59 offen sc1
    ds_write_b128 v9, v[56:59] offset:0
    ds_write_b128 v9, v[60:63] offset:1024
    ds_write_b128 v9, v[64:67] offset:2048
    ds_write_b128 v9, v[68:71] offset:3072
    ds_write_b128 v9, v[72:75] offset:4096
    s_waitcnt lgkmcnt(0)
    ds_read_b64_tr_b16 v[56:57], v3 offset:0
    ds_read_b64_tr_b16 v[58:59], v5 offset:0
    ds_read_b64_tr_b16 v[60:61], v3 offset:32
    ds_read_b64_tr_b16 v[62:63], v5 offset:32
    ds_read_b64_tr_b16 v[64:65], v3 offset:64
    ds_read_b64_tr_b16 v[66:67], v5 offset:64
    ds_read_b64_tr_b16 v[68:69], v3 offset:96
    ds_read_b64_tr_b16 v[70:71], v5 offset:96
    ds_read_b64_tr_b16 v[72:73], v3 offset:128
    ds_read_b64_tr_b16 v[74:75], v5 offset:128
    s_waitcnt lgkmcnt(0)
    buffer_store_dwordx4 v[56:59], v8, s[80:83], s60 offen offset:0 sc1
    buffer_store_dwordx4 v[60:63], v8, s[80:83], s60 offen offset:1024 sc1
    buffer_store_dwordx4 v[64:67], v8, s[80:83], s60 offen offset:2048 sc1
    buffer_store_dwordx4 v[68:71], v8, s[80:83], s60 offen offset:3072 sc1
    s_add_u32 s60, s60, 4096
    buffer_store_dwordx4 v[72:75], v8, s[80:83], s60 offen sc1
    s_movk_i32 s58, 24576
    s_waitcnt vmcnt(0)
    s_barrier
    s_cmp_lg_u32 s26, 0
    s_cbranch_scc1 Lg_sig2
    v_mov_b32 v1, 1
    v_lshlrev_b32 v7, 8, v2
    s_mov_b64 exec, 65535
    buffer_atomic_add v1, v7, s[76:79], s58 offen sc1
    s_mov_b64 exec, -1
Lg_sig2:
Lg_nowt:
    s_cmp_lg_u32 s26, 0
    s_cbranch_scc1 Lg_fw_d
    s_mov_b32 s62, 0
    v_mov_b32 v14, 0
    v_writelane_b32 v14, s97, 0
    v_writelane_b32 v15, 32, 0
    s_mov_b64 exec, 1
Lg_fw:
    buffer_load_dword v1, v14, s[76:79], 0 offen sc1
    s_add_u32 s62, s62, 1
    s_waitcnt vmcnt(0)
    v_cmp_lt_u32 vcc, v1, v15
    s_nop 0
    s_cmp_eq_u64 vcc, 0
    s_cbranch_scc1 Lg_fw_o
    s_sleep 8
    s_cmp_lt_u32 s62, 0x200000
    s_cbranch_scc1 Lg_fw
Lg_fw_o:
    s_mov_b64 exec, -1
Lg_fw_d:
    s_waitcnt vmcnt(0)
    s_barrier
    v_lshlrev_b32 v8, 4, v2
    s_add_u32 m0, s64, 0
    s_add_u32 s46, s65, 0
    buffer_load_dwordx4 v8, s[80:83], s46 offen sc1 lds
    buffer_load_dwordx4 v8, s[80:83], s46 offen offset:1024 sc1 lds
    s_mov_b64 exec, s[98:99]
    buffer_load_dwordx4 v8, s[80:83], s46 offen offset:2048 sc1 lds
    s_mov_b64 exec, -1
    s_add_u32 m0, s64, 20480
    s_add_u32 s46, s65, 20480
    buffer_load_dwordx4 v8, s[80:83], s46 offen sc1 lds
    buffer_load_dwordx4 v8, s[80:83], s46 offen offset:1024 sc1 lds
    s_mov_b64 exec, s[98:99]
    buffer_load_dwordx4 v8, s[80:83], s46 offen offset:2048 sc1 lds
    s_mov_b64 exec, -1
    s_add_u32 m0, s64, 40960
    s_add_u32 s46, s65, 40960
    buffer_load_dwordx4 v8, s[80:83], s46 offen sc1 lds
    buffer_load_dwordx4 v8, s[80:83], s46 offen offset:1024 sc1 lds
    s_mov_b64 exec, s[98:99]
    buffer_load_dwordx4 v8, s[80:83], s46 offen offset:2048 sc1 lds
    s_mov_b64 exec, -1
    s_lshr_b32 s58, s100, 1
    s_lshl_b32 s58, s58, 8
    s_cmp_lg_u32 s26, 0
    s_cbranch_scc1 Lg_fl_d
    s_mov_b32 s62, 0
    v_mov_b32 v14, 0
    v_writelane_b32 v14, s58, 0
    v_writelane_b32 v15, 1, 0
    s_mov_b64 exec, 1
Lg_fl:
    buffer_load_dword v1, v14, s[76:79], 0 offen sc1
    s_add_u32 s62, s62, 1
    s_waitcnt vmcnt(0)
    v_cmp_lt_u32 vcc, v1, v15
    s_nop 0
    s_cmp_eq_u64 vcc, 0
    s_cbranch_scc1 Lg_fl_o
    s_sleep 32
    s_cmp_lt_u32 s62, 0x200000
    s_cbranch_scc1 Lg_fl
Lg_fl_o:
    s_mov_b64 exec, -1
Lg_fl_d:
    s_waitcnt vmcnt(0)
    s_barrier
    s_setprio 2
Lg_dn:
    s_mov_b32 s36, s20
    s_mov_b32 s37, s21
    s_mov_b32 s38, 2621440
    s_mov_b32 s39, 0x00020000
    s_add_u32 s28, s24, 9437184
    s_addc_u32 s29, s25, 0
    s_mov_b32 s30, 8192
    s_mov_b32 s31, 0x00020000
    s_lshr_b32 s58, s100, 1
    s_lshl_b32 s58, s58, 8
    s_bfe_u32 s52, s26, 0x10001
    s_and_b32 s53, s26, 1
    s_lshl_b32 s46, s100, 1
    s_add_u32 s46, s46, s53
    s_lshl_b32 s61, s46, 7
    s_mul_i32 s46, s46, 151552
    s_lshl_b32 s47, s52, 10
    s_add_u32 s49, s46, s47
    s_add_u32 s48, s49, 75776
    s_lshr_b32 s59, s100, 2
    s_lshl_b32 s59, s59, 8
    s_add_u32 s59, s59, 4096
    s_mul_i32 s46, s52, 5120
    v_add_u32 v9, s46, v8
    v_add_u32 v10, 40960, v9
    s_mul_i32 s35, s100, 81920
    s_mul_i32 s47, s101, 160
    s_add_u32 s35, s35, s47
    s_and_b32 s50, s26, 3
    s_mul_i32 s50, s50, 5120
    s_sub_u32 s51, s65, s64
    s_add_u32 s51, s51, s50
    v_and_b32 v3, 15, v2
    v_lshlrev_b32 v4, 2, v3
    s_and_b32 s60, s2, 15
    s_add_u32 s60, s60, 32
    s_lshl_b32 s60, s60, 8
    s_cmp_lg_u32 s26, 0
    s_cbranch_scc1 Lg_fh_d
    s_mov_b32 s62, 0
    v_mov_b32 v14, 0
    v_writelane_b32 v14, s58, 0
    v_writelane_b32 v15, 14, 0
    v_writelane_b32 v14, s60, 1
    v_writelane_b32 v15, 16, 1
    s_mov_b64 exec, 3
Lg_fh:
    buffer_load_dword v1, v14, s[76:79], 0 offen sc1
    s_add_u32 s62, s62, 1
    s_waitcnt vmcnt(0)
    v_cmp_lt_u32 vcc, v1, v15
    s_nop 0
    s_cmp_eq_u64 vcc, 0
    s_cbranch_scc1 Lg_fh_o
    s_sleep 1
    s_cmp_lt_u32 s62, 0x200000
    s_cbranch_scc1 Lg_fh
Lg_fh_o:
    s_mov_b64 exec, -1
Lg_fh_d:
    s_waitcnt vmcnt(0)
    s_barrier
    s_cmp_ge_u32 s26, 4
    s_cbranch_scc1 Lg_ld
    buffer_load_dword v5, v4, s[28:31], s61 offen offset:64 sc1
    buffer_load_dword v4, v4, s[28:31], s61 offen sc1
    s_add_u32 s55, s49, 0
    s_add_u32 s56, s48, 0
    buffer_load_dwordx4 v[16:19], v8, s[40:43], s55 offen sc1
    buffer_load_dwordx4 v[20:23], v8, s[40:43], s56 offen sc1
    s_add_u32 s55, s49, 2048
    s_add_u32 s56, s48, 2048
    buffer_load_dwordx4 v[24:27], v8, s[40:43], s55 offen sc1
    buffer_load_dwordx4 v[28:31], v8, s[40:43], s56 offen sc1
    s_add_u32 s55, s49, 4096
    s_add_u32 s56, s48, 4096
    buffer_load_dwordx4 v[32:35], v8, s[40:43], s55 offen sc1
    buffer_load_dwordx4 v[36:39], v8, s[40:43], s56 offen sc1
    s_add_u32 s55, s49, 6144
    s_add_u32 s56, s48, 6144
    buffer_load_dwordx4 v[40:43], v8, s[40:43], s55 offen sc1
    buffer_load_dwordx4 v[44:47], v8, s[40:43], s56 offen sc1
    s_add_u32 s55, s49, 8192
    s_add_u32 s56, s48, 8192
    buffer_load_dwordx4 v[48:51], v8, s[40:43], s55 offen sc1
    buffer_load_dwordx4 v[52:55], v8, s[40:43], s56 offen sc1
    ds_read_b128 v[64:67], v9 offset:0
    ds_read_b128 v[68:71], v9 offset:1024
    ds_read_b128 v[72:75], v9 offset:2048
    ds_read_b128 v[76:79], v9 offset:3072
    ds_read_b128 v[80:83], v9 offset:4096
    v_lshrrev_b32 v6, 4, v2
    v_lshlrev_b32 v7, 8, v6
    v_lshl_add_u32 v7, v3, 3, v7
    v_add_u32 v15, 128, v7
    v_add_u32 v1, 8, v8
    s_cmp_eq_u32 s52, 0
    s_cselect_b64 vcc, -1, 0
    v_cndmask_b32 v11, v8, v7, vcc
    v_cndmask_b32 v12, v1, v15, vcc
    v_cndmask_b32 v13, v7, v8, vcc
    v_cndmask_b32 v14, v15, v1, vcc
    s_lshl_b32 s46, s53, 5
    v_add_u32 v3, s46, v3
    v_mul_u32_u24 v3, 336, v3
    v_lshl_add_u32 v3, v6, 4, v3
    s_mul_i32 s46, s52, 51200
    v_add_u32 v3, s46, v3
    s_setprio 0
    s_waitcnt vmcnt(8)
    s_waitcnt lgkmcnt(4)
    v_mfma_f32_16x16x32_bf16 v[88:91], v[64:67], v[16:19], 0
    v_mfma_f32_16x16x32_bf16 v[92:95], v[64:67], v[20:23], 0
    ds_read_b128 v[64:67], v9 offset:10240
    s_waitcnt lgkmcnt(4)
    v_mfma_f32_16x16x32_bf16 v[96:99], v[68:71], v[16:19], 0
    v_mfma_f32_16x16x32_bf16 v[100:103], v[68:71], v[20:23], 0
    ds_read_b128 v[68:71], v9 offset:11264
    s_waitcnt lgkmcnt(4)
    v_mfma_f32_16x16x32_bf16 v[104:107], v[72:75], v[16:19], 0
    v_mfma_f32_16x16x32_bf16 v[108:111], v[72:75], v[20:23], 0
    ds_read_b128 v[72:75], v9 offset:12288
    s_waitcnt lgkmcnt(4)
    v_mfma_f32_16x16x32_bf16 v[112:115], v[76:79], v[16:19], 0
    v_mfma_f32_16x16x32_bf16 v[116:119], v[76:79], v[20:23], 0
    ds_read_b128 v[76:79], v9 offset:13312
    s_waitcnt lgkmcnt(4)
    v_mfma_f32_16x16x32_bf16 v[120:123], v[80:83], v[16:19], 0
    v_mfma_f32_16x16x32_bf16 v[124:127], v[80:83], v[20:23], 0
    ds_read_b128 v[80:83], v9 offset:14336
    s_add_u32 s55, s49, 10240
    s_add_u32 s56, s48, 10240
    buffer_load_dwordx4 v[56:59], v8, s[40:43], s55 offen sc1
    buffer_load_dwordx4 v[60:63], v8, s[40:43], s56 offen sc1
    s_waitcnt vmcnt(8)
    s_barrier
    s_waitcnt lgkmcnt(4)
    v_mfma_f32_16x16x32_bf16 v[88:91], v[64:67], v[24:27], v[88:91]
    v_mfma_f32_16x16x32_bf16 v[92:95], v[64:67], v[28:31], v[92:95]
    ds_read_b128 v[64:67], v9 offset:20480
    s_waitcnt lgkmcnt(4)
    v_mfma_f32_16x16x32_bf16 v[96:99], v[68:71], v[24:27], v[96:99]
    v_mfma_f32_16x16x32_bf16 v[100:103], v[68:71], v[28:31], v[100:103]
    ds_read_b128 v[68:71], v9 offset:21504
    s_waitcnt lgkmcnt(4)
    v_mfma_f32_16x16x32_bf16 v[104:107], v[72:75], v[24:27], v[104:107]
    v_mfma_f32_16x16x32_bf16 v[108:111], v[72:75], v[28:31], v[108:111]
    ds_read_b128 v[72:75], v9 offset:22528
    s_waitcnt lgkmcnt(4)
    v_mfma_f32_16x16x32_bf16 v[112:115], v[76:79], v[24:27], v[112:115]
    v_mfma_f32_16x16x32_bf16 v[116:119], v[76:79], v[28:31], v[116:119]
    ds_read_b128 v[76:79], v9 offset:23552
    s_waitcnt lgkmcnt(4)
    v_mfma_f32_16x16x32_bf16 v[120:123], v[80:83], v[24:27], v[120:123]
    v_mfma_f32_16x16x32_bf16 v[124:127], v[80:83], v[28:31], v[124:127]
    ds_read_b128 v[80:83], v9 offset:24576
    s_add_u32 s55, s49, 12288
    s_add_u32 s56, s48, 12288
    buffer_load_dwordx4 v[16:19], v8, s[40:43], s55 offen sc1
    buffer_load_dwordx4 v[20:23], v8, s[40:43], s56 offen sc1
    s_waitcnt vmcnt(8)
    s_waitcnt lgkmcnt(4)
    v_mfma_f32_16x16x32_bf16 v[88:91], v[64:67], v[32:35], v[88:91]
    v_mfma_f32_16x16x32_bf16 v[92:95], v[64:67], v[36:39], v[92:95]
    ds_read_b128 v[64:67], v9 offset:30720
    s_waitcnt lgkmcnt(4)
    v_mfma_f32_16x16x32_bf16 v[96:99], v[68:71], v[32:35], v[96:99]
    v_mfma_f32_16x16x32_bf16 v[100:103], v[68:71], v[36:39], v[100:103]
    ds_read_b128 v[68:71], v9 offset:31744
    s_waitcnt lgkmcnt(4)
    v_mfma_f32_16x16x32_bf16 v[104:107], v[72:75], v[32:35], v[104:107]
    v_mfma_f32_16x16x32_bf16 v[108:111], v[72:75], v[36:39], v[108:111]
    ds_read_b128 v[72:75], v9 offset:32768
    s_waitcnt lgkmcnt(4)
    v_mfma_f32_16x16x32_bf16 v[112:115], v[76:79], v[32:35], v[112:115]
    v_mfma_f32_16x16x32_bf16 v[116:119], v[76:79], v[36:39], v[116:119]
    ds_read_b128 v[76:79], v9 offset:33792
    s_waitcnt lgkmcnt(4)
    v_mfma_f32_16x16x32_bf16 v[120:123], v[80:83], v[32:35], v[120:123]
    v_mfma_f32_16x16x32_bf16 v[124:127], v[80:83], v[36:39], v[124:127]
    ds_read_b128 v[80:83], v9 offset:34816
    s_add_u32 s55, s49, 14336
    s_add_u32 s56, s48, 14336
    buffer_load_dwordx4 v[24:27], v8, s[40:43], s55 offen sc1
    buffer_load_dwordx4 v[28:31], v8, s[40:43], s56 offen sc1
    s_waitcnt vmcnt(8)
    s_barrier
    s_waitcnt lgkmcnt(4)
    v_mfma_f32_16x16x32_bf16 v[88:91], v[64:67], v[40:43], v[88:91]
    v_mfma_f32_16x16x32_bf16 v[92:95], v[64:67], v[44:47], v[92:95]
    ds_read_b128 v[64:67], v10 offset:0
    s_waitcnt lgkmcnt(4)
    v_mfma_f32_16x16x32_bf16 v[96:99], v[68:71], v[40:43], v[96:99]
    v_mfma_f32_16x16x32_bf16 v[100:103], v[68:71], v[44:47], v[100:103]
    ds_read_b128 v[68:71], v10 offset:1024
    s_waitcnt lgkmcnt(4)
    v_mfma_f32_16x16x32_bf16 v[104:107], v[72:75], v[40:43], v[104:107]
    v_mfma_f32_16x16x32_bf16 v[108:111], v[72:75], v[44:47], v[108:111]
    ds_read_b128 v[72:75], v10 offset:2048
    s_waitcnt lgkmcnt(4)
    v_mfma_f32_16x16x32_bf16 v[112:115], v[76:79], v[40:43], v[112:115]
    v_mfma_f32_16x16x32_bf16 v[116:119], v[76:79], v[44:47], v[116:119]
    ds_read_b128 v[76:79], v10 offset:3072
    s_waitcnt lgkmcnt(4)
    v_mfma_f32_16x16x32_bf16 v[120:123], v[80:83], v[40:43], v[120:123]
    v_mfma_f32_16x16x32_bf16 v[124:127], v[80:83], v[44:47], v[124:127]
    ds_read_b128 v[80:83], v10 offset:4096
    s_add_u32 s55, s49, 16384
    s_add_u32 s56, s48, 16384
    buffer_load_dwordx4 v[32:35], v8, s[40:43], s55 offen sc1
    buffer_load_dwordx4 v[36:39], v8, s[40:43], s56 offen sc1
    s_waitcnt vmcnt(8)
    s_waitcnt lgkmcnt(4)
    v_mfma_f32_16x16x32_bf16 v[88:91], v[64:67], v[48:51], v[88:91]
    v_mfma_f32_16x16x32_bf16 v[92:95], v[64:67], v[52:55], v[92:95]
    ds_read_b128 v[64:67], v10 offset:10240
    s_waitcnt lgkmcnt(4)
    v_mfma_f32_16x16x32_bf16 v[96:99], v[68:71], v[48:51], v[96:99]
    v_mfma_f32_16x16x32_bf16 v[100:103], v[68:71], v[52:55], v[100:103]
    ds_read_b128 v[68:71], v10 offset:11264
    s_waitcnt lgkmcnt(4)
    v_mfma_f32_16x16x32_bf16 v[104:107], v[72:75], v[48:51], v[104:107]
    v_mfma_f32_16x16x32_bf16 v[108:111], v[72:75], v[52:55], v[108:111]
    ds_read_b128 v[72:75], v10 offset:12288
    s_waitcnt lgkmcnt(4)
    v_mfma_f32_16x16x32_bf16 v[112:115], v[76:79], v[48:51], v[112:115]
    v_mfma_f32_16x16x32_bf16 v[116:119], v[76:79], v[52:55], v[116:119]
    ds_read_b128 v[76:79], v10 offset:13312
    s_waitcnt lgkmcnt(4)
    v_mfma_f32_16x16x32_bf16 v[120:123], v[80:83], v[48:51], v[120:123]
    v_mfma_f32_16x16x32_bf16 v[124:127], v[80:83], v[52:55], v[124:127]
    ds_read_b128 v[80:83], v10 offset:14336
    s_add_u32 s55, s49, 18432
    s_add_u32 s56, s48, 18432
    buffer_load_dwordx4 v[40:43], v8, s[40:43], s55 offen sc1
    buffer_load_dwordx4 v[44:47], v8, s[40:43], s56 offen sc1
    s_waitcnt vmcnt(8)
    s_barrier
    s_waitcnt lgkmcnt(4)
    v_mfma_f32_16x16x32_bf16 v[88:91], v[64:67], v[56:59], v[88:91]
    v_mfma_f32_16x16x32_bf16 v[92:95], v[64:67], v[60:63], v[92:95]
    ds_read_b128 v[64:67], v10 offset:20480
    s_waitcnt lgkmcnt(4)
    v_mfma_f32_16x16x32_bf16 v[96:99], v[68:71], v[56:59], v[96:99]
    v_mfma_f32_16x16x32_bf16 v[100:103], v[68:71], v[60:63], v[100:103]
    ds_read_b128 v[68:71], v10 offset:21504
    s_waitcnt lgkmcnt(4)
    v_mfma_f32_16x16x32_bf16 v[104:107], v[72:75], v[56:59], v[104:107]
    v_mfma_f32_16x16x32_bf16 v[108:111], v[72:75], v[60:63], v[108:111]
    ds_read_b128 v[72:75], v10 offset:22528
    s_waitcnt lgkmcnt(4)
    v_mfma_f32_16x16x32_bf16 v[112:115], v[76:79], v[56:59], v[112:115]
    v_mfma_f32_16x16x32_bf16 v[116:119], v[76:79], v[60:63], v[116:119]
    ds_read_b128 v[76:79], v10 offset:23552
    s_waitcnt lgkmcnt(4)
    v_mfma_f32_16x16x32_bf16 v[120:123], v[80:83], v[56:59], v[120:123]
    v_mfma_f32_16x16x32_bf16 v[124:127], v[80:83], v[60:63], v[124:127]
    ds_read_b128 v[80:83], v10 offset:24576
    s_add_u32 s55, s49, 20480
    s_add_u32 s56, s48, 20480
    buffer_load_dwordx4 v[48:51], v8, s[40:43], s55 offen sc1
    buffer_load_dwordx4 v[52:55], v8, s[40:43], s56 offen sc1
    s_waitcnt vmcnt(8)
    s_waitcnt lgkmcnt(4)
    v_mfma_f32_16x16x32_bf16 v[88:91], v[64:67], v[16:19], v[88:91]
    v_mfma_f32_16x16x32_bf16 v[92:95], v[64:67], v[20:23], v[92:95]
    ds_read_b128 v[64:67], v10 offset:30720
    s_waitcnt lgkmcnt(4)
    v_mfma_f32_16x16x32_bf16 v[96:99], v[68:71], v[16:19], v[96:99]
    v_mfma_f32_16x16x32_bf16 v[100:103], v[68:71], v[20:23], v[100:103]
    ds_read_b128 v[68:71], v10 offset:31744
    s_waitcnt lgkmcnt(4)
    v_mfma_f32_16x16x32_bf16 v[104:107], v[72:75], v[16:19], v[104:107]
    v_mfma_f32_16x16x32_bf16 v[108:111], v[72:75], v[20:23], v[108:111]
    ds_read_b128 v[72:75], v10 offset:32768
    s_waitcnt lgkmcnt(4)
    v_mfma_f32_16x16x32_bf16 v[112:115], v[76:79], v[16:19], v[112:115]
    v_mfma_f32_16x16x32_bf16 v[116:119], v[76:79], v[20:23], v[116:119]
    ds_read_b128 v[76:79], v10 offset:33792
    s_waitcnt lgkmcnt(4)
    v_mfma_f32_16x16x32_bf16 v[120:123], v[80:83], v[16:19], v[120:123]
    v_mfma_f32_16x16x32_bf16 v[124:127], v[80:83], v[20:23], v[124:127]
    ds_read_b128 v[80:83], v10 offset:34816
    s_add_u32 s55, s49, 22528
    s_add_u32 s56, s48, 22528
    buffer_load_dwordx4 v[56:59], v8, s[40:43], s55 offen sc1
    buffer_load_dwordx4 v[60:63], v8, s[40:43], s56 offen sc1
    s_waitcnt vmcnt(8)
    s_barrier
    s_waitcnt lgkmcnt(4)
    v_mfma_f32_16x16x32_bf16 v[88:91], v[64:67], v[24:27], v[88:91]
    v_mfma_f32_16x16x32_bf16 v[92:95], v[64:67], v[28:31], v[92:95]
    ds_read_b128 v[64:67], v9 offset:0
    s_waitcnt lgkmcnt(4)
    v_mfma_f32_16x16x32_bf16 v[96:99], v[68:71], v[24:27], v[96:99]
    v_mfma_f32_16x16x32_bf16 v[100:103], v[68:71], v[28:31], v[100:103]
    ds_read_b128 v[68:71], v9 offset:1024
    s_waitcnt lgkmcnt(4)
    v_mfma_f32_16x16x32_bf16 v[104:107], v[72:75], v[24:27], v[104:107]
    v_mfma_f32_16x16x32_bf16 v[108:111], v[72:75], v[28:31], v[108:111]
    ds_read_b128 v[72:75], v9 offset:2048
    s_waitcnt lgkmcnt(4)
    v_mfma_f32_16x16x32_bf16 v[112:115], v[76:79], v[24:27], v[112:115]
    v_mfma_f32_16x16x32_bf16 v[116:119], v[76:79], v[28:31], v[116:119]
    ds_read_b128 v[76:79], v9 offset:3072
    s_waitcnt lgkmcnt(4)
    v_mfma_f32_16x16x32_bf16 v[120:123], v[80:83], v[24:27], v[120:123]
    v_mfma_f32_16x16x32_bf16 v[124:127], v[80:83], v[28:31], v[124:127]
    ds_read_b128 v[80:83], v9 offset:4096
    s_add_u32 s55, s49, 24576
    s_add_u32 s56, s48, 24576
    buffer_load_dwordx4 v[16:19], v8, s[40:43], s55 offen sc1
    buffer_load_dwordx4 v[20:23], v8, s[40:43], s56 offen sc1
    s_waitcnt vmcnt(8)
    s_waitcnt lgkmcnt(4)
    v_mfma_f32_16x16x32_bf16 v[88:91], v[64:67], v[32:35], v[88:91]
    v_mfma_f32_16x16x32_bf16 v[92:95], v[64:67], v[36:39], v[92:95]
    ds_read_b128 v[64:67], v9 offset:10240
    s_waitcnt lgkmcnt(4)
    v_mfma_f32_16x16x32_bf16 v[96:99], v[68:71], v[32:35], v[96:99]
    v_mfma_f32_16x16x32_bf16 v[100:103], v[68:71], v[36:39], v[100:103]
    ds_read_b128 v[68:71], v9 offset:11264
    s_waitcnt lgkmcnt(4)
    v_mfma_f32_16x16x32_bf16 v[104:107], v[72:75], v[32:35], v[104:107]
    v_mfma_f32_16x16x32_bf16 v[108:111], v[72:75], v[36:39], v[108:111]
    ds_read_b128 v[72:75], v9 offset:12288
    s_waitcnt lgkmcnt(4)
    v_mfma_f32_16x16x32_bf16 v[112:115], v[76:79], v[32:35], v[112:115]
    v_mfma_f32_16x16x32_bf16 v[116:119], v[76:79], v[36:39], v[116:119]
    ds_read_b128 v[76:79], v9 offset:13312
    s_waitcnt lgkmcnt(4)
    v_mfma_f32_16x16x32_bf16 v[120:123], v[80:83], v[32:35], v[120:123]
    v_mfma_f32_16x16x32_bf16 v[124:127], v[80:83], v[36:39], v[124:127]
    ds_read_b128 v[80:83], v9 offset:14336
    s_add_u32 s55, s49, 26624
    s_add_u32 s56, s48, 26624
    buffer_load_dwordx4 v[24:27], v8, s[40:43], s55 offen sc1
    buffer_load_dwordx4 v[28:31], v8, s[40:43], s56 offen sc1
    s_waitcnt vmcnt(8)
    s_barrier
    s_waitcnt lgkmcnt(4)
    v_mfma_f32_16x16x32_bf16 v[88:91], v[64:67], v[40:43], v[88:91]
    v_mfma_f32_16x16x32_bf16 v[92:95], v[64:67], v[44:47], v[92:95]
    ds_read_b128 v[64:67], v9 offset:20480
    s_waitcnt lgkmcnt(4)
    v_mfma_f32_16x16x32_bf16 v[96:99], v[68:71], v[40:43], v[96:99]
    v_mfma_f32_16x16x32_bf16 v[100:103], v[68:71], v[44:47], v[100:103]
    ds_read_b128 v[68:71], v9 offset:21504
    s_waitcnt lgkmcnt(4)
    v_mfma_f32_16x16x32_bf16 v[104:107], v[72:75], v[40:43], v[104:107]
    v_mfma_f32_16x16x32_bf16 v[108:111], v[72:75], v[44:47], v[108:111]
    ds_read_b128 v[72:75], v9 offset:22528
    s_waitcnt lgkmcnt(4)
    v_mfma_f32_16x16x32_bf16 v[112:115], v[76:79], v[40:43], v[112:115]
    v_mfma_f32_16x16x32_bf16 v[116:119], v[76:79], v[44:47], v[116:119]
    ds_read_b128 v[76:79], v9 offset:23552
    s_waitcnt lgkmcnt(4)
    v_mfma_f32_16x16x32_bf16 v[120:123], v[80:83], v[40:43], v[120:123]
    v_mfma_f32_16x16x32_bf16 v[124:127], v[80:83], v[44:47], v[124:127]
    ds_read_b128 v[80:83], v9 offset:24576
    s_add_u32 s55, s49, 28672
    s_add_u32 s56, s48, 28672
    buffer_load_dwordx4 v[32:35], v8, s[40:43], s55 offen sc1
    buffer_load_dwordx4 v[36:39], v8, s[40:43], s56 offen sc1
    s_waitcnt vmcnt(8)
    s_waitcnt lgkmcnt(4)
    v_mfma_f32_16x16x32_bf16 v[88:91], v[64:67], v[48:51], v[88:91]
    v_mfma_f32_16x16x32_bf16 v[92:95], v[64:67], v[52:55], v[92:95]
    ds_read_b128 v[64:67], v9 offset:30720
    s_waitcnt lgkmcnt(4)
    v_mfma_f32_16x16x32_bf16 v[96:99], v[68:71], v[48:51], v[96:99]
    v_mfma_f32_16x16x32_bf16 v[100:103], v[68:71], v[52:55], v[100:103]
    ds_read_b128 v[68:71], v9 offset:31744
    s_waitcnt lgkmcnt(4)
    v_mfma_f32_16x16x32_bf16 v[104:107], v[72:75], v[48:51], v[104:107]
    v_mfma_f32_16x16x32_bf16 v[108:111], v[72:75], v[52:55], v[108:111]
    ds_read_b128 v[72:75], v9 offset:32768
    s_waitcnt lgkmcnt(4)
    v_mfma_f32_16x16x32_bf16 v[112:115], v[76:79], v[48:51], v[112:115]
    v_mfma_f32_16x16x32_bf16 v[116:119], v[76:79], v[52:55], v[116:119]
    ds_read_b128 v[76:79], v9 offset:33792
    s_waitcnt lgkmcnt(4)
    v_mfma_f32_16x16x32_bf16 v[120:123], v[80:83], v[48:51], v[120:123]
    v_mfma_f32_16x16x32_bf16 v[124:127], v[80:83], v[52:55], v[124:127]
    ds_read_b128 v[80:83], v9 offset:34816
    s_add_u32 s55, s49, 30720
    s_add_u32 s56, s48, 30720
    buffer_load_dwordx4 v[40:43], v8, s[40:43], s55 offen sc1
    buffer_load_dwordx4 v[44:47], v8, s[40:43], s56 offen sc1
    s_waitcnt vmcnt(8)
    s_barrier
    s_waitcnt lgkmcnt(4)
    v_mfma_f32_16x16x32_bf16 v[88:91], v[64:67], v[56:59], v[88:91]
    v_mfma_f32_16x16x32_bf16 v[92:95], v[64:67], v[60:63], v[92:95]
    ds_read_b128 v[64:67], v10 offset:0
    s_waitcnt lgkmcnt(4)
    v_mfma_f32_16x16x32_bf16 v[96:99], v[68:71], v[56:59], v[96:99]
    v_mfma_f32_16x16x32_bf16 v[100:103], v[68:71], v[60:63], v[100:103]
    ds_read_b128 v[68:71], v10 offset:1024
    s_waitcnt lgkmcnt(4)
    v_mfma_f32_16x16x32_bf16 v[104:107], v[72:75], v[56:59], v[104:107]
    v_mfma_f32_16x16x32_bf16 v[108:111], v[72:75], v[60:63], v[108:111]
    ds_read_b128 v[72:75], v10 offset:2048
    s_waitcnt lgkmcnt(4)
    v_mfma_f32_16x16x32_bf16 v[112:115], v[76:79], v[56:59], v[112:115]
    v_mfma_f32_16x16x32_bf16 v[116:119], v[76:79], v[60:63], v[116:119]
    ds_read_b128 v[76:79], v10 offset:3072
    s_waitcnt lgkmcnt(4)
    v_mfma_f32_16x16x32_bf16 v[120:123], v[80:83], v[56:59], v[120:123]
    v_mfma_f32_16x16x32_bf16 v[124:127], v[80:83], v[60:63], v[124:127]
    ds_read_b128 v[80:83], v10 offset:4096
    s_add_u32 s55, s49, 32768
    s_add_u32 s56, s48, 32768
    buffer_load_dwordx4 v[48:51], v8, s[40:43], s55 offen sc1
    buffer_load_dwordx4 v[52:55], v8, s[40:43], s56 offen sc1
    s_waitcnt vmcnt(8)
    s_waitcnt lgkmcnt(4)
    v_mfma_f32_16x16x32_bf16 v[88:91], v[64:67], v[16:19], v[88:91]
    v_mfma_f32_16x16x32_bf16 v[92:95], v[64:67], v[20:23], v[92:95]
    ds_read_b128 v[64:67], v10 offset:10240
    s_waitcnt lgkmcnt(4)
    v_mfma_f32_16x16x32_bf16 v[96:99], v[68:71], v[16:19], v[96:99]
    v_mfma_f32_16x16x32_bf16 v[100:103], v[68:71], v[20:23], v[100:103]
    ds_read_b128 v[68:71], v10 offset:11264
    s_waitcnt lgkmcnt(4)
    v_mfma_f32_16x16x32_bf16 v[104:107], v[72:75], v[16:19], v[104:107]
    v_mfma_f32_16x16x32_bf16 v[108:111], v[72:75], v[20:23], v[108:111]
    ds_read_b128 v[72:75], v10 offset:12288
    s_waitcnt lgkmcnt(4)
    v_mfma_f32_16x16x32_bf16 v[112:115], v[76:79], v[16:19], v[112:115]
    v_mfma_f32_16x16x32_bf16 v[116:119], v[76:79], v[20:23], v[116:119]
    ds_read_b128 v[76:79], v10 offset:13312
    s_waitcnt lgkmcnt(4)
    v_mfma_f32_16x16x32_bf16 v[120:123], v[80:83], v[16:19], v[120:123]
    v_mfma_f32_16x16x32_bf16 v[124:127], v[80:83], v[20:23], v[124:127]
    ds_read_b128 v[80:83], v10 offset:14336
    s_add_u32 s55, s49, 34816
    s_add_u32 s56, s48, 34816
    buffer_load_dwordx4 v[56:59], v8, s[40:43], s55 offen sc1
    buffer_load_dwordx4 v[60:63], v8, s[40:43], s56 offen sc1
    s_waitcnt vmcnt(8)
    s_barrier
    s_waitcnt lgkmcnt(4)
    v_mfma_f32_16x16x32_bf16 v[88:91], v[64:67], v[24:27], v[88:91]
    v_mfma_f32_16x16x32_bf16 v[92:95], v[64:67], v[28:31], v[92:95]
    ds_read_b128 v[64:67], v10 offset:20480
    s_waitcnt lgkmcnt(4)
    v_mfma_f32_16x16x32_bf16 v[96:99], v[68:71], v[24:27], v[96:99]
    v_mfma_f32_16x16x32_bf16 v[100:103], v[68:71], v[28:31], v[100:103]
    ds_read_b128 v[68:71], v10 offset:21504
    s_waitcnt lgkmcnt(4)
    v_mfma_f32_16x16x32_bf16 v[104:107], v[72:75], v[24:27], v[104:107]
    v_mfma_f32_16x16x32_bf16 v[108:111], v[72:75], v[28:31], v[108:111]
    ds_read_b128 v[72:75], v10 offset:22528
    s_waitcnt lgkmcnt(4)
    v_mfma_f32_16x16x32_bf16 v[112:115], v[76:79], v[24:27], v[112:115]
    v_mfma_f32_16x16x32_bf16 v[116:119], v[76:79], v[28:31], v[116:119]
    ds_read_b128 v[76:79], v10 offset:23552
    s_waitcnt lgkmcnt(4)
    v_mfma_f32_16x16x32_bf16 v[120:123], v[80:83], v[24:27], v[120:123]
    v_mfma_f32_16x16x32_bf16 v[124:127], v[80:83], v[28:31], v[124:127]
    ds_read_b128 v[80:83], v10 offset:24576
    s_add_u32 s55, s49, 36864
    s_add_u32 s56, s48, 36864
    buffer_load_dwordx4 v[16:19], v8, s[40:43], s55 offen sc1
    buffer_load_dwordx4 v[20:23], v8, s[40:43], s56 offen sc1
    s_waitcnt vmcnt(8)
    s_waitcnt lgkmcnt(4)
    v_mfma_f32_16x16x32_bf16 v[88:91], v[64:67], v[32:35], v[88:91]
    v_mfma_f32_16x16x32_bf16 v[92:95], v[64:67], v[36:39], v[92:95]
    ds_read_b128 v[64:67], v10 offset:30720
    s_waitcnt lgkmcnt(4)
    v_mfma_f32_16x16x32_bf16 v[96:99], v[68:71], v[32:35], v[96:99]
    v_mfma_f32_16x16x32_bf16 v[100:103], v[68:71], v[36:39], v[100:103]
    ds_read_b128 v[68:71], v10 offset:31744
    s_waitcnt lgkmcnt(4)
    v_mfma_f32_16x16x32_bf16 v[104:107], v[72:75], v[32:35], v[104:107]
    v_mfma_f32_16x16x32_bf16 v[108:111], v[72:75], v[36:39], v[108:111]
    ds_read_b128 v[72:75], v10 offset:32768
    s_waitcnt lgkmcnt(4)
    v_mfma_f32_16x16x32_bf16 v[112:115], v[76:79], v[32:35], v[112:115]
    v_mfma_f32_16x16x32_bf16 v[116:119], v[76:79], v[36:39], v[116:119]
    ds_read_b128 v[76:79], v10 offset:33792
    s_waitcnt lgkmcnt(4)
    v_mfma_f32_16x16x32_bf16 v[120:123], v[80:83], v[32:35], v[120:123]
    v_mfma_f32_16x16x32_bf16 v[124:127], v[80:83], v[36:39], v[124:127]
    ds_read_b128 v[80:83], v10 offset:34816
    s_add_u32 s55, s49, 38912
    s_add_u32 s56, s48, 38912
    buffer_load_dwordx4 v[24:27], v8, s[40:43], s55 offen sc1
    buffer_load_dwordx4 v[28:31], v8, s[40:43], s56 offen sc1
    s_waitcnt vmcnt(8)
    s_barrier
    s_waitcnt lgkmcnt(4)
    v_mfma_f32_16x16x32_bf16 v[88:91], v[64:67], v[40:43], v[88:91]
    v_mfma_f32_16x16x32_bf16 v[92:95], v[64:67], v[44:47], v[92:95]
    ds_read_b128 v[64:67], v9 offset:0
    s_waitcnt lgkmcnt(4)
    v_mfma_f32_16x16x32_bf16 v[96:99], v[68:71], v[40:43], v[96:99]
    v_mfma_f32_16x16x32_bf16 v[100:103], v[68:71], v[44:47], v[100:103]
    ds_read_b128 v[68:71], v9 offset:1024
    s_waitcnt lgkmcnt(4)
    v_mfma_f32_16x16x32_bf16 v[104:107], v[72:75], v[40:43], v[104:107]
    v_mfma_f32_16x16x32_bf16 v[108:111], v[72:75], v[44:47], v[108:111]
    ds_read_b128 v[72:75], v9 offset:2048
    s_waitcnt lgkmcnt(4)
    v_mfma_f32_16x16x32_bf16 v[112:115], v[76:79], v[40:43], v[112:115]
    v_mfma_f32_16x16x32_bf16 v[116:119], v[76:79], v[44:47], v[116:119]
    ds_read_b128 v[76:79], v9 offset:3072
    s_waitcnt lgkmcnt(4)
    v_mfma_f32_16x16x32_bf16 v[120:123], v[80:83], v[40:43], v[120:123]
    v_mfma_f32_16x16x32_bf16 v[124:127], v[80:83], v[44:47], v[124:127]
    ds_read_b128 v[80:83], v9 offset:4096
    s_add_u32 s55, s49, 40960
    s_add_u32 s56, s48, 40960
    buffer_load_dwordx4 v[32:35], v8, s[40:43], s55 offen sc1
    buffer_load_dwordx4 v[36:39], v8, s[40:43], s56 offen sc1
    s_waitcnt vmcnt(8)
    s_waitcnt lgkmcnt(4)
    v_mfma_f32_16x16x32_bf16 v[88:91], v[64:67], v[48:51], v[88:91]
    v_mfma_f32_16x16x32_bf16 v[92:95], v[64:67], v[52:55], v[92:95]
    ds_read_b128 v[64:67], v9 offset:10240
    s_waitcnt lgkmcnt(4)
    v_mfma_f32_16x16x32_bf16 v[96:99], v[68:71], v[48:51], v[96:99]
    v_mfma_f32_16x16x32_bf16 v[100:103], v[68:71], v[52:55], v[100:103]
    ds_read_b128 v[68:71], v9 offset:11264
    s_waitcnt lgkmcnt(4)
    v_mfma_f32_16x16x32_bf16 v[104:107], v[72:75], v[48:51], v[104:107]
    v_mfma_f32_16x16x32_bf16 v[108:111], v[72:75], v[52:55], v[108:111]
    ds_read_b128 v[72:75], v9 offset:12288
    s_waitcnt lgkmcnt(4)
    v_mfma_f32_16x16x32_bf16 v[112:115], v[76:79], v[48:51], v[112:115]
    v_mfma_f32_16x16x32_bf16 v[116:119], v[76:79], v[52:55], v[116:119]
    ds_read_b128 v[76:79], v9 offset:13312
    s_waitcnt lgkmcnt(4)
    v_mfma_f32_16x16x32_bf16 v[120:123], v[80:83], v[48:51], v[120:123]
    v_mfma_f32_16x16x32_bf16 v[124:127], v[80:83], v[52:55], v[124:127]
    ds_read_b128 v[80:83], v9 offset:14336
    s_add_u32 s55, s49, 43008
    s_add_u32 s56, s48, 43008
    buffer_load_dwordx4 v[40:43], v8, s[40:43], s55 offen sc1
    buffer_load_dwordx4 v[44:47], v8, s[40:43], s56 offen sc1
    s_waitcnt vmcnt(8)
    s_barrier
    s_waitcnt lgkmcnt(4)
    v_mfma_f32_16x16x32_bf16 v[88:91], v[64:67], v[56:59], v[88:91]
    v_mfma_f32_16x16x32_bf16 v[92:95], v[64:67], v[60:63], v[92:95]
    ds_read_b128 v[64:67], v9 offset:20480
    s_waitcnt lgkmcnt(4)
    v_mfma_f32_16x16x32_bf16 v[96:99], v[68:71], v[56:59], v[96:99]
    v_mfma_f32_16x16x32_bf16 v[100:103], v[68:71], v[60:63], v[100:103]
    ds_read_b128 v[68:71], v9 offset:21504
    s_waitcnt lgkmcnt(4)
    v_mfma_f32_16x16x32_bf16 v[104:107], v[72:75], v[56:59], v[104:107]
    v_mfma_f32_16x16x32_bf16 v[108:111], v[72:75], v[60:63], v[108:111]
    ds_read_b128 v[72:75], v9 offset:22528
    s_waitcnt lgkmcnt(4)
    v_mfma_f32_16x16x32_bf16 v[112:115], v[76:79], v[56:59], v[112:115]
    v_mfma_f32_16x16x32_bf16 v[116:119], v[76:79], v[60:63], v[116:119]
    ds_read_b128 v[76:79], v9 offset:23552
    s_waitcnt lgkmcnt(4)
    v_mfma_f32_16x16x32_bf16 v[120:123], v[80:83], v[56:59], v[120:123]
    v_mfma_f32_16x16x32_bf16 v[124:127], v[80:83], v[60:63], v[124:127]
    ds_read_b128 v[80:83], v9 offset:24576
    s_add_u32 s55, s49, 45056
    s_add_u32 s56, s48, 45056
    buffer_load_dwordx4 v[48:51], v8, s[40:43], s55 offen sc1
    buffer_load_dwordx4 v[52:55], v8, s[40:43], s56 offen sc1
    s_waitcnt vmcnt(8)
    s_waitcnt lgkmcnt(4)
    v_mfma_f32_16x16x32_bf16 v[88:91], v[64:67], v[16:19], v[88:91]
    v_mfma_f32_16x16x32_bf16 v[92:95], v[64:67], v[20:23], v[92:95]
    ds_read_b128 v[64:67], v9 offset:30720
    s_waitcnt lgkmcnt(4)
    v_mfma_f32_16x16x32_bf16 v[96:99], v[68:71], v[16:19], v[96:99]
    v_mfma_f32_16x16x32_bf16 v[100:103], v[68:71], v[20:23], v[100:103]
    ds_read_b128 v[68:71], v9 offset:31744
    s_waitcnt lgkmcnt(4)
    v_mfma_f32_16x16x32_bf16 v[104:107], v[72:75], v[16:19], v[104:107]
    v_mfma_f32_16x16x32_bf16 v[108:111], v[72:75], v[20:23], v[108:111]
    ds_read_b128 v[72:75], v9 offset:32768
    s_waitcnt lgkmcnt(4)
    v_mfma_f32_16x16x32_bf16 v[112:115], v[76:79], v[16:19], v[112:115]
    v_mfma_f32_16x16x32_bf16 v[116:119], v[76:79], v[20:23], v[116:119]
    ds_read_b128 v[76:79], v9 offset:33792
    s_waitcnt lgkmcnt(4)
    v_mfma_f32_16x16x32_bf16 v[120:123], v[80:83], v[16:19], v[120:123]
    v_mfma_f32_16x16x32_bf16 v[124:127], v[80:83], v[20:23], v[124:127]
    ds_read_b128 v[80:83], v9 offset:34816
    s_add_u32 s55, s49, 47104
    s_add_u32 s56, s48, 47104
    buffer_load_dwordx4 v[56:59], v8, s[40:43], s55 offen sc1
    buffer_load_dwordx4 v[60:63], v8, s[40:43], s56 offen sc1
    s_waitcnt vmcnt(8)
    s_barrier
    s_waitcnt lgkmcnt(4)
    v_mfma_f32_16x16x32_bf16 v[88:91], v[64:67], v[24:27], v[88:91]
    v_mfma_f32_16x16x32_bf16 v[92:95], v[64:67], v[28:31], v[92:95]
    ds_read_b128 v[64:67], v10 offset:0
    s_waitcnt lgkmcnt(4)
    v_mfma_f32_16x16x32_bf16 v[96:99], v[68:71], v[24:27], v[96:99]
    v_mfma_f32_16x16x32_bf16 v[100:103], v[68:71], v[28:31], v[100:103]
    ds_read_b128 v[68:71], v10 offset:1024
    s_waitcnt lgkmcnt(4)
    v_mfma_f32_16x16x32_bf16 v[104:107], v[72:75], v[24:27], v[104:107]
    v_mfma_f32_16x16x32_bf16 v[108:111], v[72:75], v[28:31], v[108:111]
    ds_read_b128 v[72:75], v10 offset:2048
    s_waitcnt lgkmcnt(4)
    v_mfma_f32_16x16x32_bf16 v[112:115], v[76:79], v[24:27], v[112:115]
    v_mfma_f32_16x16x32_bf16 v[116:119], v[76:79], v[28:31], v[116:119]
    ds_read_b128 v[76:79], v10 offset:3072
    s_waitcnt lgkmcnt(4)
    v_mfma_f32_16x16x32_bf16 v[120:123], v[80:83], v[24:27], v[120:123]
    v_mfma_f32_16x16x32_bf16 v[124:127], v[80:83], v[28:31], v[124:127]
    ds_read_b128 v[80:83], v10 offset:4096
    s_add_u32 s55, s49, 49152
    s_add_u32 s56, s48, 49152
    buffer_load_dwordx4 v[16:19], v8, s[40:43], s55 offen sc1
    buffer_load_dwordx4 v[20:23], v8, s[40:43], s56 offen sc1
    s_waitcnt vmcnt(8)
    s_waitcnt lgkmcnt(4)
    v_mfma_f32_16x16x32_bf16 v[88:91], v[64:67], v[32:35], v[88:91]
    v_mfma_f32_16x16x32_bf16 v[92:95], v[64:67], v[36:39], v[92:95]
    ds_read_b128 v[64:67], v10 offset:10240
    s_waitcnt lgkmcnt(4)
    v_mfma_f32_16x16x32_bf16 v[96:99], v[68:71], v[32:35], v[96:99]
    v_mfma_f32_16x16x32_bf16 v[100:103], v[68:71], v[36:39], v[100:103]
    ds_read_b128 v[68:71], v10 offset:11264
    s_waitcnt lgkmcnt(4)
    v_mfma_f32_16x16x32_bf16 v[104:107], v[72:75], v[32:35], v[104:107]
    v_mfma_f32_16x16x32_bf16 v[108:111], v[72:75], v[36:39], v[108:111]
    ds_read_b128 v[72:75], v10 offset:12288
    s_waitcnt lgkmcnt(4)
    v_mfma_f32_16x16x32_bf16 v[112:115], v[76:79], v[32:35], v[112:115]
    v_mfma_f32_16x16x32_bf16 v[116:119], v[76:79], v[36:39], v[116:119]
    ds_read_b128 v[76:79], v10 offset:13312
    s_waitcnt lgkmcnt(4)
    v_mfma_f32_16x16x32_bf16 v[120:123], v[80:83], v[32:35], v[120:123]
    v_mfma_f32_16x16x32_bf16 v[124:127], v[80:83], v[36:39], v[124:127]
    ds_read_b128 v[80:83], v10 offset:14336
    s_add_u32 s55, s49, 51200
    s_add_u32 s56, s48, 51200
    buffer_load_dwordx4 v[24:27], v8, s[40:43], s55 offen sc1
    buffer_load_dwordx4 v[28:31], v8, s[40:43], s56 offen sc1
    s_waitcnt vmcnt(8)
    s_barrier
    s_waitcnt lgkmcnt(4)
    v_mfma_f32_16x16x32_bf16 v[88:91], v[64:67], v[40:43], v[88:91]
    v_mfma_f32_16x16x32_bf16 v[92:95], v[64:67], v[44:47], v[92:95]
    ds_read_b128 v[64:67], v10 offset:20480
    s_waitcnt lgkmcnt(4)
    v_mfma_f32_16x16x32_bf16 v[96:99], v[68:71], v[40:43], v[96:99]
    v_mfma_f32_16x16x32_bf16 v[100:103], v[68:71], v[44:47], v[100:103]
    ds_read_b128 v[68:71], v10 offset:21504
    s_waitcnt lgkmcnt(4)
    v_mfma_f32_16x16x32_bf16 v[104:107], v[72:75], v[40:43], v[104:107]
    v_mfma_f32_16x16x32_bf16 v[108:111], v[72:75], v[44:47], v[108:111]
    ds_read_b128 v[72:75], v10 offset:22528
    s_waitcnt lgkmcnt(4)
    v_mfma_f32_16x16x32_bf16 v[112:115], v[76:79], v[40:43], v[112:115]
    v_mfma_f32_16x16x32_bf16 v[116:119], v[76:79], v[44:47], v[116:119]
    ds_read_b128 v[76:79], v10 offset:23552
    s_waitcnt lgkmcnt(4)
    v_mfma_f32_16x16x32_bf16 v[120:123], v[80:83], v[40:43], v[120:123]
    v_mfma_f32_16x16x32_bf16 v[124:127], v[80:83], v[44:47], v[124:127]
    ds_read_b128 v[80:83], v10 offset:24576
    s_add_u32 s55, s49, 53248
    s_add_u32 s56, s48, 53248
    buffer_load_dwordx4 v[32:35], v8, s[40:43], s55 offen sc1
    buffer_load_dwordx4 v[36:39], v8, s[40:43], s56 offen sc1
    s_waitcnt vmcnt(8)
    s_waitcnt lgkmcnt(4)
    v_mfma_f32_16x16x32_bf16 v[88:91], v[64:67], v[48:51], v[88:91]
    v_mfma_f32_16x16x32_bf16 v[92:95], v[64:67], v[52:55], v[92:95]
    ds_read_b128 v[64:67], v10 offset:30720
    s_waitcnt lgkmcnt(4)
    v_mfma_f32_16x16x32_bf16 v[96:99], v[68:71], v[48:51], v[96:99]
    v_mfma_f32_16x16x32_bf16 v[100:103], v[68:71], v[52:55], v[100:103]
    ds_read_b128 v[68:71], v10 offset:31744
    s_waitcnt lgkmcnt(4)
    v_mfma_f32_16x16x32_bf16 v[104:107], v[72:75], v[48:51], v[104:107]
    v_mfma_f32_16x16x32_bf16 v[108:111], v[72:75], v[52:55], v[108:111]
    ds_read_b128 v[72:75], v10 offset:32768
    s_waitcnt lgkmcnt(4)
    v_mfma_f32_16x16x32_bf16 v[112:115], v[76:79], v[48:51], v[112:115]
    v_mfma_f32_16x16x32_bf16 v[116:119], v[76:79], v[52:55], v[116:119]
    ds_read_b128 v[76:79], v10 offset:33792
    s_waitcnt lgkmcnt(4)
    v_mfma_f32_16x16x32_bf16 v[120:123], v[80:83], v[48:51], v[120:123]
    v_mfma_f32_16x16x32_bf16 v[124:127], v[80:83], v[52:55], v[124:127]
    ds_read_b128 v[80:83], v10 offset:34816
    s_waitcnt vmcnt(6)
    s_barrier
    s_waitcnt lgkmcnt(4)
    v_mfma_f32_16x16x32_bf16 v[88:91], v[64:67], v[56:59], v[88:91]
    v_mfma_f32_16x16x32_bf16 v[92:95], v[64:67], v[60:63], v[92:95]
    ds_read_b128 v[64:67], v9 offset:0
    s_waitcnt lgkmcnt(4)
    v_mfma_f32_16x16x32_bf16 v[96:99], v[68:71], v[56:59], v[96:99]
    v_mfma_f32_16x16x32_bf16 v[100:103], v[68:71], v[60:63], v[100:103]
    ds_read_b128 v[68:71], v9 offset:1024
    s_waitcnt lgkmcnt(4)
    v_mfma_f32_16x16x32_bf16 v[104:107], v[72:75], v[56:59], v[104:107]
    v_mfma_f32_16x16x32_bf16 v[108:111], v[72:75], v[60:63], v[108:111]
    ds_read_b128 v[72:75], v9 offset:2048
    s_waitcnt lgkmcnt(4)
    v_mfma_f32_16x16x32_bf16 v[112:115], v[76:79], v[56:59], v[112:115]
    v_mfma_f32_16x16x32_bf16 v[116:119], v[76:79], v[60:63], v[116:119]
    ds_read_b128 v[76:79], v9 offset:3072
    s_waitcnt lgkmcnt(4)
    v_mfma_f32_16x16x32_bf16 v[120:123], v[80:83], v[56:59], v[120:123]
    v_mfma_f32_16x16x32_bf16 v[124:127], v[80:83], v[60:63], v[124:127]
    ds_read_b128 v[80:83], v9 offset:4096
    s_waitcnt vmcnt(4)
    s_waitcnt lgkmcnt(4)
    v_mfma_f32_16x16x32_bf16 v[88:91], v[64:67], v[16:19], v[88:91]
    v_mfma_f32_16x16x32_bf16 v[92:95], v[64:67], v[20:23], v[92:95]
    ds_read_b128 v[64:67], v9 offset:10240
    s_waitcnt lgkmcnt(4)
    v_mfma_f32_16x16x32_bf16 v[96:99], v[68:71], v[16:19], v[96:99]
    v_mfma_f32_16x16x32_bf16 v[100:103], v[68:71], v[20:23], v[100:103]
    ds_read_b128 v[68:71], v9 offset:11264
    s_waitcnt lgkmcnt(4)
    v_mfma_f32_16x16x32_bf16 v[104:107], v[72:75], v[16:19], v[104:107]
    v_mfma_f32_16x16x32_bf16 v[108:111], v[72:75], v[20:23], v[108:111]
    ds_read_b128 v[72:75], v9 offset:12288
    s_waitcnt lgkmcnt(4)
    v_mfma_f32_16x16x32_bf16 v[112:115], v[76:79], v[16:19], v[112:115]
    v_mfma_f32_16x16x32_bf16 v[116:119], v[76:79], v[20:23], v[116:119]
    ds_read_b128 v[76:79], v9 offset:13312
    s_waitcnt lgkmcnt(4)
    v_mfma_f32_16x16x32_bf16 v[120:123], v[80:83], v[16:19], v[120:123]
    v_mfma_f32_16x16x32_bf16 v[124:127], v[80:83], v[20:23], v[124:127]
    ds_read_b128 v[80:83], v9 offset:14336
    s_waitcnt vmcnt(2)
    s_barrier
    s_waitcnt lgkmcnt(4)
    v_mfma_f32_16x16x32_bf16 v[88:91], v[64:67], v[24:27], v[88:91]
    v_mfma_f32_16x16x32_bf16 v[92:95], v[64:67], v[28:31], v[92:95]
    ds_read_b128 v[64:67], v9 offset:20480
    s_waitcnt lgkmcnt(4)
    v_mfma_f32_16x16x32_bf16 v[96:99], v[68:71], v[24:27], v[96:99]
    v_mfma_f32_16x16x32_bf16 v[100:103], v[68:71], v[28:31], v[100:103]
    ds_read_b128 v[68:71], v9 offset:21504
    s_waitcnt lgkmcnt(4)
    v_mfma_f32_16x16x32_bf16 v[104:107], v[72:75], v[24:27], v[104:107]
    v_mfma_f32_16x16x32_bf16 v[108:111], v[72:75], v[28:31], v[108:111]
    ds_read_b128 v[72:75], v9 offset:22528
    s_waitcnt lgkmcnt(4)
    v_mfma_f32_16x16x32_bf16 v[112:115], v[76:79], v[24:27], v[112:115]
    v_mfma_f32_16x16x32_bf16 v[116:119], v[76:79], v[28:31], v[116:119]
    ds_read_b128 v[76:79], v9 offset:23552
    s_waitcnt lgkmcnt(4)
    v_mfma_f32_16x16x32_bf16 v[120:123], v[80:83], v[24:27], v[120:123]
    v_mfma_f32_16x16x32_bf16 v[124:127], v[80:83], v[28:31], v[124:127]
    ds_read_b128 v[80:83], v9 offset:24576
    s_waitcnt vmcnt(0)
    s_barrier
    s_waitcnt lgkmcnt(4)
    v_mfma_f32_16x16x32_bf16 v[88:91], v[64:67], v[32:35], v[88:91]
    v_mfma_f32_16x16x32_bf16 v[92:95], v[64:67], v[36:39], v[92:95]
    ds_read_b128 v[64:67], v9 offset:30720
    s_waitcnt lgkmcnt(4)
    v_mfma_f32_16x16x32_bf16 v[96:99], v[68:71], v[32:35], v[96:99]
    v_mfma_f32_16x16x32_bf16 v[100:103], v[68:71], v[36:39], v[100:103]
    ds_read_b128 v[68:71], v9 offset:31744
    s_waitcnt lgkmcnt(4)
    v_mfma_f32_16x16x32_bf16 v[104:107], v[72:75], v[32:35], v[104:107]
    v_mfma_f32_16x16x32_bf16 v[108:111], v[72:75], v[36:39], v[108:111]
    ds_read_b128 v[72:75], v9 offset:32768
    s_waitcnt lgkmcnt(4)
    v_mfma_f32_16x16x32_bf16 v[112:115], v[76:79], v[32:35], v[112:115]
    v_mfma_f32_16x16x32_bf16 v[116:119], v[76:79], v[36:39], v[116:119]
    ds_read_b128 v[76:79], v9 offset:33792
    s_waitcnt lgkmcnt(4)
    v_mfma_f32_16x16x32_bf16 v[120:123], v[80:83], v[32:35], v[120:123]
    v_mfma_f32_16x16x32_bf16 v[124:127], v[80:83], v[36:39], v[124:127]
    ds_read_b128 v[80:83], v9 offset:34816
    s_setprio 2
    s_waitcnt lgkmcnt(0)
    s_barrier
    s_barrier
    s_add_u32 s55, s49, 55296
    s_add_u32 s56, s48, 55296
    buffer_load_dwordx4 v[40:43], v8, s[40:43], s55 offen sc1
    buffer_load_dwordx4 v[44:47], v8, s[40:43], s56 offen sc1
    s_add_u32 s55, s49, 57344
    s_add_u32 s56, s48, 57344
    buffer_load_dwordx4 v[48:51], v8, s[40:43], s55 offen sc1
    buffer_load_dwordx4 v[52:55], v8, s[40:43], s56 offen sc1
    s_add_u32 s55, s49, 59392
    s_add_u32 s56, s48, 59392
    buffer_load_dwordx2 v[56:57], v11, s[40:43], s55 offen sc1
    buffer_load_dwordx2 v[58:59], v12, s[40:43], s55 offen sc1
    buffer_load_dwordx2 v[60:61], v11, s[40:43], s56 offen sc1
    buffer_load_dwordx2 v[62:63], v12, s[40:43], s56 offen sc1
    s_add_u32 s55, s49, 61440
    s_add_u32 s56, s48, 61440
    buffer_load_dwordx4 v[16:19], v8, s[40:43], s55 offen sc1
    buffer_load_dwordx4 v[20:23], v8, s[40:43], s56 offen sc1
    s_add_u32 s55, s49, 63488
    s_add_u32 s56, s48, 63488
    buffer_load_dwordx2 v[24:25], v13, s[40:43], s55 offen sc1
    buffer_load_dwordx2 v[26:27], v14, s[40:43], s55 offen sc1
    buffer_load_dwordx2 v[28:29], v13, s[40:43], s56 offen sc1
    buffer_load_dwordx2 v[30:31], v14, s[40:43], s56 offen sc1
    v_sub_f32 v4, 1.0, v4
    v_sub_f32 v5, 1.0, v5
    v_mul_f32 v88, v88, v4
    v_mul_f32 v89, v89, v4
    v_mul_f32 v90, v90, v4
    v_mul_f32 v91, v91, v4
    v_mul_f32 v92, v92, v5
    v_mul_f32 v93, v93, v5
    v_mul_f32 v94, v94, v5
    v_mul_f32 v95, v95, v5
    v_mul_f32 v96, v96, v4
    v_mul_f32 v97, v97, v4
    v_mul_f32 v98, v98, v4
    v_mul_f32 v99, v99, v4
    v_mul_f32 v100, v100, v5
    v_mul_f32 v101, v101, v5
    v_mul_f32 v102, v102, v5
    v_mul_f32 v103, v103, v5
    v_mul_f32 v104, v104, v4
    v_mul_f32 v105, v105, v4
    v_mul_f32 v106, v106, v4
    v_mul_f32 v107, v107, v4
    v_mul_f32 v108, v108, v5
    v_mul_f32 v109, v109, v5
    v_mul_f32 v110, v110, v5
    v_mul_f32 v111, v111, v5
    v_mul_f32 v112, v112, v4
    v_mul_f32 v113, v113, v4
    v_mul_f32 v114, v114, v4
    v_mul_f32 v115, v115, v4
    v_mul_f32 v116, v116, v5
    v_mul_f32 v117, v117, v5
    v_mul_f32 v118, v118, v5
    v_mul_f32 v119, v119, v5
    v_mul_f32 v120, v120, v4
    v_mul_f32 v121, v121, v4
    v_mul_f32 v122, v122, v4
    v_mul_f32 v123, v123, v4
    v_mul_f32 v124, v124, v5
    v_mul_f32 v125, v125, v5
    v_mul_f32 v126, v126, v5
    v_mul_f32 v127, v127, v5
    s_waitcnt vmcnt(12)
    s_waitcnt lgkmcnt(4)
    v_mfma_f32_16x16x32_bf16 v[88:91], v[64:67], v[40:43], v[88:91]
    v_mfma_f32_16x16x32_bf16 v[92:95], v[64:67], v[44:47], v[92:95]
    ds_read_b128 v[64:67], v10 offset:0
    s_waitcnt lgkmcnt(4)
    v_mfma_f32_16x16x32_bf16 v[96:99], v[68:71], v[40:43], v[96:99]
    v_mfma_f32_16x16x32_bf16 v[100:103], v[68:71], v[44:47], v[100:103]
    ds_read_b128 v[68:71], v10 offset:1024
    s_waitcnt lgkmcnt(4)
    v_mfma_f32_16x16x32_bf16 v[104:107], v[72:75], v[40:43], v[104:107]
    v_mfma_f32_16x16x32_bf16 v[108:111], v[72:75], v[44:47], v[108:111]
    ds_read_b128 v[72:75], v10 offset:2048
    s_waitcnt lgkmcnt(4)
    v_mfma_f32_16x16x32_bf16 v[112:115], v[76:79], v[40:43], v[112:115]
    v_mfma_f32_16x16x32_bf16 v[116:119], v[76:79], v[44:47], v[116:119]
    ds_read_b128 v[76:79], v10 offset:3072
    s_waitcnt lgkmcnt(4)
    v_mfma_f32_16x16x32_bf16 v[120:123], v[80:83], v[40:43], v[120:123]
    v_mfma_f32_16x16x32_bf16 v[124:127], v[80:83], v[44:47], v[124:127]
    ds_read_b128 v[80:83], v10 offset:4096
    s_add_u32 s55, s49, 65536
    s_add_u32 s56, s48, 65536
    buffer_load_dwordx4 v[32:35], v8, s[40:43], s55 offen sc1
    buffer_load_dwordx4 v[36:39], v8, s[40:43], s56 offen sc1
    s_waitcnt vmcnt(12)
    s_waitcnt lgkmcnt(4)
    v_mfma_f32_16x16x32_bf16 v[88:91], v[64:67], v[48:51], v[88:91]
    v_mfma_f32_16x16x32_bf16 v[92:95], v[64:67], v[52:55], v[92:95]
    ds_read_b128 v[64:67], v10 offset:10240
    s_waitcnt lgkmcnt(4)
    v_mfma_f32_16x16x32_bf16 v[96:99], v[68:71], v[48:51], v[96:99]
    v_mfma_f32_16x16x32_bf16 v[100:103], v[68:71], v[52:55], v[100:103]
    ds_read_b128 v[68:71], v10 offset:11264
    s_waitcnt lgkmcnt(4)
    v_mfma_f32_16x16x32_bf16 v[104:107], v[72:75], v[48:51], v[104:107]
    v_mfma_f32_16x16x32_bf16 v[108:111], v[72:75], v[52:55], v[108:111]
    ds_read_b128 v[72:75], v10 offset:12288
    s_waitcnt lgkmcnt(4)
    v_mfma_f32_16x16x32_bf16 v[112:115], v[76:79], v[48:51], v[112:115]
    v_mfma_f32_16x16x32_bf16 v[116:119], v[76:79], v[52:55], v[116:119]
    ds_read_b128 v[76:79], v10 offset:13312
    s_waitcnt lgkmcnt(4)
    v_mfma_f32_16x16x32_bf16 v[120:123], v[80:83], v[48:51], v[120:123]
    v_mfma_f32_16x16x32_bf16 v[124:127], v[80:83], v[52:55], v[124:127]
    ds_read_b128 v[80:83], v10 offset:14336
    s_add_u32 s55, s49, 67584
    s_add_u32 s56, s48, 67584
    buffer_load_dwordx4 v[40:43], v8, s[40:43], s55 offen sc1
    buffer_load_dwordx4 v[44:47], v8, s[40:43], s56 offen sc1
    s_waitcnt vmcnt(10)
    s_barrier
    s_waitcnt lgkmcnt(4)
    v_mfma_f32_16x16x32_bf16 v[88:91], v[64:67], v[56:59], v[88:91]
    v_mfma_f32_16x16x32_bf16 v[92:95], v[64:67], v[60:63], v[92:95]
    ds_read_b128 v[64:67], v10 offset:20480
    s_waitcnt lgkmcnt(4)
    v_mfma_f32_16x16x32_bf16 v[96:99], v[68:71], v[56:59], v[96:99]
    v_mfma_f32_16x16x32_bf16 v[100:103], v[68:71], v[60:63], v[100:103]
    ds_read_b128 v[68:71], v10 offset:21504
    s_waitcnt lgkmcnt(4)
    v_mfma_f32_16x16x32_bf16 v[104:107], v[72:75], v[56:59], v[104:107]
    v_mfma_f32_16x16x32_bf16 v[108:111], v[72:75], v[60:63], v[108:111]
    ds_read_b128 v[72:75], v10 offset:22528
    s_waitcnt lgkmcnt(4)
    v_mfma_f32_16x16x32_bf16 v[112:115], v[76:79], v[56:59], v[112:115]
    v_mfma_f32_16x16x32_bf16 v[116:119], v[76:79], v[60:63], v[116:119]
    ds_read_b128 v[76:79], v10 offset:23552
    s_waitcnt lgkmcnt(4)
    v_mfma_f32_16x16x32_bf16 v[120:123], v[80:83], v[56:59], v[120:123]
    v_mfma_f32_16x16x32_bf16 v[124:127], v[80:83], v[60:63], v[124:127]
    ds_read_b128 v[80:83], v10 offset:24576
    s_add_u32 s55, s49, 69632
    s_add_u32 s56, s48, 69632
    buffer_load_dwordx2 v[48:49], v11, s[40:43], s55 offen sc1
    buffer_load_dwordx2 v[50:51], v12, s[40:43], s55 offen sc1
    buffer_load_dwordx2 v[52:53], v11, s[40:43], s56 offen sc1
    buffer_load_dwordx2 v[54:55], v12, s[40:43], s56 offen sc1
    s_waitcnt vmcnt(12)
    s_waitcnt lgkmcnt(4)
    v_mfma_f32_16x16x32_bf16 v[88:91], v[64:67], v[16:19], v[88:91]
    v_mfma_f32_16x16x32_bf16 v[92:95], v[64:67], v[20:23], v[92:95]
    ds_read_b128 v[64:67], v10 offset:30720
    s_waitcnt lgkmcnt(4)
    v_mfma_f32_16x16x32_bf16 v[96:99], v[68:71], v[16:19], v[96:99]
    v_mfma_f32_16x16x32_bf16 v[100:103], v[68:71], v[20:23], v[100:103]
    ds_read_b128 v[68:71], v10 offset:31744
    s_waitcnt lgkmcnt(4)
    v_mfma_f32_16x16x32_bf16 v[104:107], v[72:75], v[16:19], v[104:107]
    v_mfma_f32_16x16x32_bf16 v[108:111], v[72:75], v[20:23], v[108:111]
    ds_read_b128 v[72:75], v10 offset:32768
    s_waitcnt lgkmcnt(4)
    v_mfma_f32_16x16x32_bf16 v[112:115], v[76:79], v[16:19], v[112:115]
    v_mfma_f32_16x16x32_bf16 v[116:119], v[76:79], v[20:23], v[116:119]
    ds_read_b128 v[76:79], v10 offset:33792
    s_waitcnt lgkmcnt(4)
    v_mfma_f32_16x16x32_bf16 v[120:123], v[80:83], v[16:19], v[120:123]
    v_mfma_f32_16x16x32_bf16 v[124:127], v[80:83], v[20:23], v[124:127]
    ds_read_b128 v[80:83], v10 offset:34816
    s_add_u32 s55, s49, 71680
    s_add_u32 s56, s48, 71680
    buffer_load_dwordx4 v[56:59], v8, s[40:43], s55 offen sc1
    buffer_load_dwordx4 v[60:63], v8, s[40:43], s56 offen sc1
    s_waitcnt vmcnt(10)
    s_barrier
    s_waitcnt lgkmcnt(4)
    v_mfma_f32_16x16x32_bf16 v[88:91], v[64:67], v[24:27], v[88:91]
    v_mfma_f32_16x16x32_bf16 v[92:95], v[64:67], v[28:31], v[92:95]
    ds_read_b128 v[64:67], v9 offset:0
    s_waitcnt lgkmcnt(4)
    v_mfma_f32_16x16x32_bf16 v[96:99], v[68:71], v[24:27], v[96:99]
    v_mfma_f32_16x16x32_bf16 v[100:103], v[68:71], v[28:31], v[100:103]
    ds_read_b128 v[68:71], v9 offset:1024
    s_waitcnt lgkmcnt(4)
    v_mfma_f32_16x16x32_bf16 v[104:107], v[72:75], v[24:27], v[104:107]
    v_mfma_f32_16x16x32_bf16 v[108:111], v[72:75], v[28:31], v[108:111]
    ds_read_b128 v[72:75], v9 offset:2048
    s_waitcnt lgkmcnt(4)
    v_mfma_f32_16x16x32_bf16 v[112:115], v[76:79], v[24:27], v[112:115]
    v_mfma_f32_16x16x32_bf16 v[116:119], v[76:79], v[28:31], v[116:119]
    ds_read_b128 v[76:79], v9 offset:3072
    s_waitcnt lgkmcnt(4)
    v_mfma_f32_16x16x32_bf16 v[120:123], v[80:83], v[24:27], v[120:123]
    v_mfma_f32_16x16x32_bf16 v[124:127], v[80:83], v[28:31], v[124:127]
    ds_read_b128 v[80:83], v9 offset:4096
    s_add_u32 s55, s49, 73728
    s_add_u32 s56, s48, 73728
    buffer_load_dwordx2 v[16:17], v13, s[40:43], s55 offen sc1
    buffer_load_dwordx2 v[18:19], v14, s[40:43], s55 offen sc1
    buffer_load_dwordx2 v[20:21], v13, s[40:43], s56 offen sc1
    buffer_load_dwordx2 v[22:23], v14, s[40:43], s56 offen sc1
    s_waitcnt vmcnt(12)
    s_waitcnt lgkmcnt(4)
    v_mfma_f32_16x16x32_bf16 v[88:91], v[64:67], v[32:35], v[88:91]
    v_mfma_f32_16x16x32_bf16 v[92:95], v[64:67], v[36:39], v[92:95]
    ds_read_b128 v[64:67], v9 offset:10240
    s_waitcnt lgkmcnt(4)
    v_mfma_f32_16x16x32_bf16 v[96:99], v[68:71], v[32:35], v[96:99]
    v_mfma_f32_16x16x32_bf16 v[100:103], v[68:71], v[36:39], v[100:103]
    ds_read_b128 v[68:71], v9 offset:11264
    s_waitcnt lgkmcnt(4)
    v_mfma_f32_16x16x32_bf16 v[104:107], v[72:75], v[32:35], v[104:107]
    v_mfma_f32_16x16x32_bf16 v[108:111], v[72:75], v[36:39], v[108:111]
    ds_read_b128 v[72:75], v9 offset:12288
    s_waitcnt lgkmcnt(4)
    v_mfma_f32_16x16x32_bf16 v[112:115], v[76:79], v[32:35], v[112:115]
    v_mfma_f32_16x16x32_bf16 v[116:119], v[76:79], v[36:39], v[116:119]
    ds_read_b128 v[76:79], v9 offset:13312
    s_waitcnt lgkmcnt(4)
    v_mfma_f32_16x16x32_bf16 v[120:123], v[80:83], v[32:35], v[120:123]
    v_mfma_f32_16x16x32_bf16 v[124:127], v[80:83], v[36:39], v[124:127]
    ds_read_b128 v[80:83], v9 offset:14336
    s_waitcnt vmcnt(10)
    s_barrier
    s_waitcnt lgkmcnt(4)
    v_mfma_f32_16x16x32_bf16 v[88:91], v[64:67], v[40:43], v[88:91]
    v_mfma_f32_16x16x32_bf16 v[92:95], v[64:67], v[44:47], v[92:95]
    ds_read_b128 v[64:67], v9 offset:20480
    s_waitcnt lgkmcnt(4)
    v_mfma_f32_16x16x32_bf16 v[96:99], v[68:71], v[40:43], v[96:99]
    v_mfma_f32_16x16x32_bf16 v[100:103], v[68:71], v[44:47], v[100:103]
    ds_read_b128 v[68:71], v9 offset:21504
    s_waitcnt lgkmcnt(4)
    v_mfma_f32_16x16x32_bf16 v[104:107], v[72:75], v[40:43], v[104:107]
    v_mfma_f32_16x16x32_bf16 v[108:111], v[72:75], v[44:47], v[108:111]
    ds_read_b128 v[72:75], v9 offset:22528
    s_waitcnt lgkmcnt(4)
    v_mfma_f32_16x16x32_bf16 v[112:115], v[76:79], v[40:43], v[112:115]
    v_mfma_f32_16x16x32_bf16 v[116:119], v[76:79], v[44:47], v[116:119]
    ds_read_b128 v[76:79], v9 offset:23552
    s_waitcnt lgkmcnt(4)
    v_mfma_f32_16x16x32_bf16 v[120:123], v[80:83], v[40:43], v[120:123]
    v_mfma_f32_16x16x32_bf16 v[124:127], v[80:83], v[44:47], v[124:127]
    ds_read_b128 v[80:83], v9 offset:24576
    s_waitcnt vmcnt(6)
    s_waitcnt lgkmcnt(4)
    v_mfma_f32_16x16x32_bf16 v[88:91], v[64:67], v[48:51], v[88:91]
    v_mfma_f32_16x16x32_bf16 v[92:95], v[64:67], v[52:55], v[92:95]
    ds_read_b128 v[64:67], v9 offset:30720
    v_add_u32 v1, 0, v0
    v_mul_u32_u24 v12, 6554, v1
    s_waitcnt lgkmcnt(4)
    v_mfma_f32_16x16x32_bf16 v[96:99], v[68:71], v[48:51], v[96:99]
    v_mfma_f32_16x16x32_bf16 v[100:103], v[68:71], v[52:55], v[100:103]
    ds_read_b128 v[68:71], v9 offset:31744
    v_lshrrev_b32 v12, 16, v12
    v_mul_u32_u24 v11, 10, v12
    s_waitcnt lgkmcnt(4)
    v_mfma_f32_16x16x32_bf16 v[104:107], v[72:75], v[48:51], v[104:107]
    v_mfma_f32_16x16x32_bf16 v[108:111], v[72:75], v[52:55], v[108:111]
    ds_read_b128 v[72:75], v9 offset:32768
    v_sub_u32 v1, v1, v11
    v_mul_u32_u24 v11, 336, v12
    s_waitcnt lgkmcnt(4)
    v_mfma_f32_16x16x32_bf16 v[112:115], v[76:79], v[48:51], v[112:115]
    v_mfma_f32_16x16x32_bf16 v[116:119], v[76:79], v[52:55], v[116:119]
    ds_read_b128 v[76:79], v9 offset:33792
    v_lshl_add_u32 v11, v1, 5, v11
    v_mul_u32_u24 v12, 1280, v12
    s_waitcnt lgkmcnt(4)
    v_mfma_f32_16x16x32_bf16 v[120:123], v[80:83], v[48:51], v[120:123]
    v_mfma_f32_16x16x32_bf16 v[124:127], v[80:83], v[52:55], v[124:127]
    ds_read_b128 v[80:83], v9 offset:34816
    v_lshl_add_u32 v12, v1, 4, v12
    s_waitcnt vmcnt(4)
    s_barrier
    s_waitcnt lgkmcnt(4)
    v_mfma_f32_16x16x32_bf16 v[88:91], v[64:67], v[56:59], v[88:91]
    v_mfma_f32_16x16x32_bf16 v[92:95], v[64:67], v[60:63], v[92:95]
    ds_read_b128 v[64:67], v10 offset:0
    s_waitcnt lgkmcnt(4)
    v_mfma_f32_16x16x32_bf16 v[96:99], v[68:71], v[56:59], v[96:99]
    v_mfma_f32_16x16x32_bf16 v[100:103], v[68:71], v[60:63], v[100:103]
    ds_read_b128 v[68:71], v10 offset:1024
    s_waitcnt lgkmcnt(4)
    v_mfma_f32_16x16x32_bf16 v[104:107], v[72:75], v[56:59], v[104:107]
    v_mfma_f32_16x16x32_bf16 v[108:111], v[72:75], v[60:63], v[108:111]
    ds_read_b128 v[72:75], v10 offset:2048
    s_waitcnt lgkmcnt(4)
    v_mfma_f32_16x16x32_bf16 v[112:115], v[76:79], v[56:59], v[112:115]
    v_mfma_f32_16x16x32_bf16 v[116:119], v[76:79], v[60:63], v[116:119]
    ds_read_b128 v[76:79], v10 offset:3072
    s_waitcnt lgkmcnt(4)
    v_mfma_f32_16x16x32_bf16 v[120:123], v[80:83], v[56:59], v[120:123]
    v_mfma_f32_16x16x32_bf16 v[124:127], v[80:83], v[60:63], v[124:127]
    ds_read_b128 v[80:83], v10 offset:4096
    s_waitcnt vmcnt(0)
    s_waitcnt lgkmcnt(3)
    v_mfma_f32_16x16x32_bf16 v[88:91], v[64:67], v[16:19], v[88:91]
    v_mfma_f32_16x16x32_bf16 v[92:95], v[64:67], v[20:23], v[92:95]
    s_waitcnt lgkmcnt(2)
    v_mfma_f32_16x16x32_bf16 v[96:99], v[68:71], v[16:19], v[96:99]
    v_mfma_f32_16x16x32_bf16 v[100:103], v[68:71], v[20:23], v[100:103]
    s_waitcnt lgkmcnt(1)
    v_mfma_f32_16x16x32_bf16 v[104:107], v[72:75], v[16:19], v[104:107]
    v_mfma_f32_16x16x32_bf16 v[108:111], v[72:75], v[20:23], v[108:111]
    s_waitcnt lgkmcnt(0)
    v_mfma_f32_16x16x32_bf16 v[112:115], v[76:79], v[16:19], v[112:115]
    v_mfma_f32_16x16x32_bf16 v[116:119], v[76:79], v[20:23], v[116:119]
    ds_write_b128 v3, v[88:91] offset:0
    ds_write_b128 v3, v[92:95] offset:5376
    v_mfma_f32_16x16x32_bf16 v[120:123], v[80:83], v[16:19], v[120:123]
    v_mfma_f32_16x16x32_bf16 v[124:127], v[80:83], v[20:23], v[124:127]
    ds_write_b128 v3, v[96:99] offset:64
    ds_write_b128 v3, v[100:103] offset:5440
    ds_write_b128 v3, v[104:107] offset:128
    ds_write_b128 v3, v[108:111] offset:5504
    ds_write_b128 v3, v[112:115] offset:192
    ds_write_b128 v3, v[116:119] offset:5568
    s_nop 0
    ds_write_b128 v3, v[120:123] offset:256
    ds_write_b128 v3, v[124:127] offset:5632
Lg_fin:
    s_waitcnt lgkmcnt(0)
    s_barrier
    ds_read_b128 v[20:23], v11
    ds_read_b128 v[28:31], v11 offset:51200
    ds_read_b128 v[24:27], v11 offset:16
    ds_read_b128 v[32:35], v11 offset:51216
    s_cmp_ge_u32 s26, 6
    s_cbranch_scc1 Lg_two
    s_waitcnt lgkmcnt(2)
    v_pk_add_f32 v[20:21], v[20:21], v[28:29]
    v_pk_add_f32 v[22:23], v[22:23], v[30:31]
    v_cvt_pk_bf16_f32 v36, v20, v21
    v_cvt_pk_bf16_f32 v37, v22, v23
    s_waitcnt lgkmcnt(0)
    v_pk_add_f32 v[24:25], v[24:25], v[32:33]
    v_pk_add_f32 v[26:27], v[26:27], v[34:35]
    v_cvt_pk_bf16_f32 v38, v24, v25
    v_cvt_pk_bf16_f32 v39, v26, v27
    buffer_store_dwordx4 v[36:39], v12, s[36:39], s35 offen
    s_endpgm
Lg_two:
    ds_read_b128 v[40:43], v13
    ds_read_b128 v[48:51], v13 offset:51200
    ds_read_b128 v[44:47], v13 offset:16
    ds_read_b128 v[52:55], v13 offset:51216
    s_waitcnt lgkmcnt(6)
    v_pk_add_f32 v[20:21], v[20:21], v[28:29]
    v_pk_add_f32 v[22:23], v[22:23], v[30:31]
    v_cvt_pk_bf16_f32 v36, v20, v21
    v_cvt_pk_bf16_f32 v37, v22, v23
    s_waitcnt lgkmcnt(4)
    v_pk_add_f32 v[24:25], v[24:25], v[32:33]
    v_pk_add_f32 v[26:27], v[26:27], v[34:35]
    v_cvt_pk_bf16_f32 v38, v24, v25
    v_cvt_pk_bf16_f32 v39, v26, v27
    buffer_store_dwordx4 v[36:39], v12, s[36:39], s35 offen
    s_waitcnt lgkmcnt(2)
    v_pk_add_f32 v[40:41], v[40:41], v[48:49]
    v_pk_add_f32 v[42:43], v[42:43], v[50:51]
    v_cvt_pk_bf16_f32 v56, v40, v41
    v_cvt_pk_bf16_f32 v57, v42, v43
    s_waitcnt lgkmcnt(0)
    v_pk_add_f32 v[44:45], v[44:45], v[52:53]
    v_pk_add_f32 v[46:47], v[46:47], v[54:55]
    v_cvt_pk_bf16_f32 v58, v44, v45
    v_cvt_pk_bf16_f32 v59, v46, v47
    buffer_store_dwordx4 v[56:59], v14, s[36:39], s35 offen
Lg_end:
    s_endpgm
Lg_ld:
    s_add_u32 m0, s50, 61440
    s_add_u32 s46, s51, 61440
    buffer_load_dwordx4 v8, s[80:83], s46 offen offset:0 sc1 lds
    buffer_load_dwordx4 v8, s[80:83], s46 offen offset:1024 sc1 lds
    buffer_load_dwordx4 v8, s[80:83], s46 offen offset:2048 sc1 lds
    buffer_load_dwordx4 v8, s[80:83], s46 offen offset:3072 sc1 lds
    s_add_u32 m0, m0, 4096
    s_add_u32 s46, s46, 4096
    buffer_load_dwordx4 v8, s[80:83], s46 offen sc1 lds
    v_add_u32 v1, 0, v0
    v_mul_u32_u24 v12, 6554, v1
    v_lshrrev_b32 v12, 16, v12
    v_mul_u32_u24 v11, 10, v12
    v_sub_u32 v1, v1, v11
    v_mul_u32_u24 v11, 336, v12
    v_lshl_add_u32 v11, v1, 5, v11
    v_mul_u32_u24 v12, 1280, v12
    v_lshl_add_u32 v12, v1, 4, v12
    v_add_u32 v1, 128, v0
    v_mul_u32_u24 v14, 6554, v1
    v_lshrrev_b32 v14, 16, v14
    v_mul_u32_u24 v13, 10, v14
    v_sub_u32 v1, v1, v13
    v_mul_u32_u24 v13, 336, v14
    v_lshl_add_u32 v13, v1, 5, v13
    v_mul_u32_u24 v14, 1280, v14
    v_lshl_add_u32 v14, v1, 4, v14
    v_mov_b32 v7, 0
    s_waitcnt vmcnt(5)
    s_barrier
    s_waitcnt vmcnt(5)
    s_barrier
    s_add_u32 m0, s50, 0
    s_add_u32 s46, s51, 81920
    buffer_load_dwordx4 v8, s[80:83], s46 offen offset:0 sc1 lds
    buffer_load_dwordx4 v8, s[80:83], s46 offen offset:1024 sc1 lds
    buffer_load_dwordx4 v8, s[80:83], s46 offen offset:2048 sc1 lds
    buffer_load_dwordx4 v8, s[80:83], s46 offen offset:3072 sc1 lds
    s_add_u32 m0, m0, 4096
    s_add_u32 s46, s46, 4096
    buffer_load_dwordx4 v8, s[80:83], s46 offen sc1 lds
    s_waitcnt vmcnt(5)
    s_barrier
    s_add_u32 m0, s50, 20480
    s_add_u32 s46, s51, 102400
    buffer_load_dwordx4 v8, s[80:83], s46 offen offset:0 sc1 lds
    buffer_load_dwordx4 v8, s[80:83], s46 offen offset:1024 sc1 lds
    buffer_load_dwordx4 v8, s[80:83], s46 offen offset:2048 sc1 lds
    buffer_load_dwordx4 v8, s[80:83], s46 offen offset:3072 sc1 lds
    s_add_u32 m0, m0, 4096
    s_add_u32 s46, s46, 4096
    buffer_load_dwordx4 v8, s[80:83], s46 offen sc1 lds
    s_waitcnt vmcnt(5)
    s_barrier
    s_add_u32 m0, s50, 40960
    s_add_u32 s46, s51, 122880
    buffer_load_dwordx4 v8, s[80:83], s46 offen offset:0 sc1 lds
    buffer_load_dwordx4 v8, s[80:83], s46 offen offset:1024 sc1 lds
    buffer_load_dwordx4 v8, s[80:83], s46 offen offset:2048 sc1 lds
    buffer_load_dwordx4 v8, s[80:83], s46 offen offset:3072 sc1 lds
    s_add_u32 m0, m0, 4096
    s_add_u32 s46, s46, 4096
    buffer_load_dwordx4 v8, s[80:83], s46 offen sc1 lds
    s_waitcnt vmcnt(5)
    s_barrier
    s_add_u32 m0, s50, 61440
    s_add_u32 s46, s51, 143360
    buffer_load_dwordx4 v8, s[80:83], s46 offen offset:0 sc1 lds
    buffer_load_dwordx4 v8, s[80:83], s46 offen offset:1024 sc1 lds
    buffer_load_dwordx4 v8, s[80:83], s46 offen offset:2048 sc1 lds
    buffer_load_dwordx4 v8, s[80:83], s46 offen offset:3072 sc1 lds
    s_add_u32 m0, m0, 4096
    s_add_u32 s46, s46, 4096
    buffer_load_dwordx4 v8, s[80:83], s46 offen sc1 lds
    s_waitcnt vmcnt(5)
    s_barrier
    s_add_u32 m0, s50, 0
    s_add_u32 s46, s51, 163840
    buffer_load_dwordx4 v8, s[80:83], s46 offen offset:0 sc1 lds
    buffer_load_dwordx4 v8, s[80:83], s46 offen offset:1024 sc1 lds
    buffer_load_dwordx4 v8, s[80:83], s46 offen offset:2048 sc1 lds
    buffer_load_dwordx4 v8, s[80:83], s46 offen offset:3072 sc1 lds
    s_add_u32 m0, m0, 4096
    s_add_u32 s46, s46, 4096
    buffer_load_dwordx4 v8, s[80:83], s46 offen sc1 lds
    s_waitcnt vmcnt(5)
    s_barrier
    s_add_u32 m0, s50, 20480
    s_add_u32 s46, s51, 184320
    buffer_load_dwordx4 v8, s[80:83], s46 offen offset:0 sc1 lds
    buffer_load_dwordx4 v8, s[80:83], s46 offen offset:1024 sc1 lds
    buffer_load_dwordx4 v8, s[80:83], s46 offen offset:2048 sc1 lds
    buffer_load_dwordx4 v8, s[80:83], s46 offen offset:3072 sc1 lds
    s_add_u32 m0, m0, 4096
    s_add_u32 s46, s46, 4096
    buffer_load_dwordx4 v8, s[80:83], s46 offen sc1 lds
    s_waitcnt vmcnt(5)
    s_barrier
    s_add_u32 m0, s50, 40960
    s_add_u32 s46, s51, 204800
    buffer_load_dwordx4 v8, s[80:83], s46 offen offset:0 sc1 lds
    buffer_load_dwordx4 v8, s[80:83], s46 offen offset:1024 sc1 lds
    buffer_load_dwordx4 v8, s[80:83], s46 offen offset:2048 sc1 lds
    buffer_load_dwordx4 v8, s[80:83], s46 offen offset:3072 sc1 lds
    s_add_u32 m0, m0, 4096
    s_add_u32 s46, s46, 4096
    buffer_load_dwordx4 v8, s[80:83], s46 offen sc1 lds
    s_waitcnt vmcnt(5)
    s_barrier
    s_add_u32 m0, s50, 61440
    s_add_u32 s46, s51, 225280
    buffer_load_dwordx4 v8, s[80:83], s46 offen offset:0 sc1 lds
    buffer_load_dwordx4 v8, s[80:83], s46 offen offset:1024 sc1 lds
    buffer_load_dwordx4 v8, s[80:83], s46 offen offset:2048 sc1 lds
    buffer_load_dwordx4 v8, s[80:83], s46 offen offset:3072 sc1 lds
    s_add_u32 m0, m0, 4096
    s_add_u32 s46, s46, 4096
    buffer_load_dwordx4 v8, s[80:83], s46 offen sc1 lds
    s_waitcnt vmcnt(5)
    s_barrier
    s_add_u32 m0, s50, 0
    s_add_u32 s46, s51, 245760
    buffer_load_dwordx4 v8, s[80:83], s46 offen offset:0 sc1 lds
    buffer_load_dwordx4 v8, s[80:83], s46 offen offset:1024 sc1 lds
    buffer_load_dwordx4 v8, s[80:83], s46 offen offset:2048 sc1 lds
    buffer_load_dwordx4 v8, s[80:83], s46 offen offset:3072 sc1 lds
    s_add_u32 m0, m0, 4096
    s_add_u32 s46, s46, 4096
    buffer_load_dwordx4 v8, s[80:83], s46 offen sc1 lds
    s_waitcnt vmcnt(5)
    s_barrier
    s_add_u32 m0, s50, 20480
    s_add_u32 s46, s51, 266240
    buffer_load_dwordx4 v8, s[80:83], s46 offen offset:0 sc1 lds
    buffer_load_dwordx4 v8, s[80:83], s46 offen offset:1024 sc1 lds
    buffer_load_dwordx4 v8, s[80:83], s46 offen offset:2048 sc1 lds
    buffer_load_dwordx4 v8, s[80:83], s46 offen offset:3072 sc1 lds
    s_add_u32 m0, m0, 4096
    s_add_u32 s46, s46, 4096
    buffer_load_dwordx4 v8, s[80:83], s46 offen sc1 lds
    s_waitcnt vmcnt(5)
    s_barrier
    s_add_u32 m0, s50, 40960
    s_add_u32 s46, s51, 286720
    buffer_load_dwordx4 v8, s[80:83], s46 offen offset:0 sc1 lds
    buffer_load_dwordx4 v8, s[80:83], s46 offen offset:1024 sc1 lds
    buffer_load_dwordx4 v8, s[80:83], s46 offen offset:2048 sc1 lds
    buffer_load_dwordx4 v8, s[80:83], s46 offen offset:3072 sc1 lds
    s_add_u32 m0, m0, 4096
    s_add_u32 s46, s46, 4096
    buffer_load_dwordx4 v8, s[80:83], s46 offen sc1 lds
    s_waitcnt vmcnt(5)
    s_barrier
    buffer_load_dword v6, v7, s[76:79], s59 offen sc1
    s_add_u32 m0, s50, 61440
    s_add_u32 s46, s51, 307200
    buffer_load_dwordx4 v8, s[80:83], s46 offen offset:0 sc1 lds
    buffer_load_dwordx4 v8, s[80:83], s46 offen offset:1024 sc1 lds
    buffer_load_dwordx4 v8, s[80:83], s46 offen offset:2048 sc1 lds
    buffer_load_dwordx4 v8, s[80:83], s46 offen offset:3072 sc1 lds
    s_add_u32 m0, m0, 4096
    s_add_u32 s46, s46, 4096
    buffer_load_dwordx4 v8, s[80:83], s46 offen sc1 lds
    s_waitcnt vmcnt(11)
    s_barrier
    s_add_u32 m0, s50, 0
    s_add_u32 s46, s51, 327680
    buffer_load_dwordx4 v8, s[80:83], s46 offen offset:0 sc1 lds
    buffer_load_dwordx4 v8, s[80:83], s46 offen offset:1024 sc1 lds
    buffer_load_dwordx4 v8, s[80:83], s46 offen offset:2048 sc1 lds
    buffer_load_dwordx4 v8, s[80:83], s46 offen offset:3072 sc1 lds
    s_add_u32 m0, m0, 4096
    s_add_u32 s46, s46, 4096
    buffer_load_dwordx4 v8, s[80:83], s46 offen sc1 lds
    s_waitcnt vmcnt(10)
    v_readfirstlane_b32 s63, v6
    s_barrier
    s_cmp_ge_u32 s63, 32
    s_cbranch_scc1 Lg_oy
    s_add_u32 m0, s50, 20480
    s_add_u32 s46, s51, 348160
    buffer_load_dwordx4 v8, s[80:83], s46 offen offset:0 sc1 lds
    buffer_load_dwordx4 v8, s[80:83], s46 offen offset:1024 sc1 lds
    buffer_load_dwordx4 v8, s[80:83], s46 offen offset:2048 sc1 lds
    buffer_load_dwordx4 v8, s[80:83], s46 offen offset:3072 sc1 lds
    s_add_u32 m0, m0, 4096
    s_add_u32 s46, s46, 4096
    buffer_load_dwordx4 v8, s[80:83], s46 offen sc1 lds
    s_cmp_lg_u32 s26, 4
    s_cbranch_scc1 Lg_og
    s_mov_b32 s62, 0
Lg_op:
    buffer_load_dword v6, v7, s[76:79], s59 offen sc1
    s_add_u32 s62, s62, 1
    s_waitcnt vmcnt(0)
    v_readfirstlane_b32 s63, v6
    s_nop 0
    s_cmp_ge_u32 s63, 32
    s_cbranch_scc1 Lg_og
    s_cmp_lt_u32 s62, 0x200000
    s_cbranch_scc1 Lg_op
Lg_og:
    s_barrier
    s_branch Lg_oz
Lg_oy:
    s_barrier
    s_add_u32 m0, s50, 20480
    s_add_u32 s46, s51, 348160
    buffer_load_dwordx4 v8, s[80:83], s46 offen offset:0 sc1 lds
    buffer_load_dwordx4 v8, s[80:83], s46 offen offset:1024 sc1 lds
    buffer_load_dwordx4 v8, s[80:83], s46 offen offset:2048 sc1 lds
    buffer_load_dwordx4 v8, s[80:83], s46 offen offset:3072 sc1 lds
    s_add_u32 m0, m0, 4096
    s_add_u32 s46, s46, 4096
    buffer_load_dwordx4 v8, s[80:83], s46 offen sc1 lds
Lg_oz:
    s_waitcnt vmcnt(10)
    s_barrier
    s_lshr_b32 s47, s50, 1
    s_add_u32 m0, s47, 40960
    s_sub_u32 s46, s51, s47
    s_add_u32 s46, s46, 368640
    buffer_load_dwordx4 v8, s[80:83], s46 offen sc1 lds
    buffer_load_dwordx4 v8, s[80:83], s46 offen offset:1024 sc1 lds
    s_mov_b64 exec, s[98:99]
    buffer_load_dwordx4 v8, s[80:83], s46 offen offset:2048 sc1 lds
    s_mov_b64 exec, -1
    s_waitcnt vmcnt(8)
    s_barrier
    s_waitcnt vmcnt(3)
    s_barrier
    s_waitcnt vmcnt(0)
    s_barrier
    s_branch Lg_fin
Lm_end:
    s_endpgm
.section .rodata,"a"
.p2align 6
.amdhsa_kernel gated_mix__mha_block__glu_gated_bilinear__prompt_kernel
  .amdhsa_next_free_vgpr 128
  .amdhsa_next_free_sgpr 102
  .amdhsa_accum_offset 128
  .amdhsa_group_segment_fixed_size 0
  .amdhsa_kernarg_size 88
  .amdhsa_user_sgpr_count 2
  .amdhsa_user_sgpr_kernarg_segment_ptr 1
  .amdhsa_system_sgpr_workgroup_id_x 1
.end_amdhsa_kernel
```
